```python
import torch

def _softmax(x, axis=-1):
    return torch.softmax(x, dim=axis)

def _gelu(x):
    return torch.nn.functional.gelu(x, approximate='tanh')

def _silu(x):
    return torch.nn.functional.silu(x)

def _sigmoid(x):
    return torch.sigmoid(x)

def _layernorm(x, axis=-1, eps=1e-05):
    m = x.mean(dim=axis, keepdim=True)
    v = x.var(dim=axis, keepdim=True, unbiased=False)
    return (x - m) / torch.sqrt(v + eps)

def _scatter_add(tgt, idx, src, axis=0):
    return tgt.clone().index_add_(axis, idx, src)

def _segment_sum(src, seg, n):
    out = torch.zeros((n,) + src.shape[1:], dtype=src.dtype)
    return out.index_add_(0, seg, src)

def _pad(x, pw):
    flat = tuple((v for pair in reversed(pw) for v in pair))
    return torch.nn.functional.pad(x, flat)
kernel_name = 'sequential_preLN__linear_kernel_hedgehog__mixer_gmlp__prompt'

def setup_inputs():

    _w = lambda a: (lambda t: t.to(torch.bfloat16) if t.is_floating_point() else t)(torch.as_tensor(a))

    def _A_setup():
        B, S, D, H = (1, 2048, 512, 32)
        Dh = D // H
        return {'x': _w((lambda *s: torch.randn(*s, dtype=torch.bfloat16) * 0.05)(B, S, D)), 'wqkv': _w((lambda *s: torch.randn(*s, dtype=torch.bfloat16) * 0.2)(D, 3 * D)), 'w_phi': _w((lambda *s: torch.randn(*s, dtype=torch.bfloat16) * 0.2)(H, Dh, Dh) * Dh ** (-0.5)), 'wo': _w((lambda *s: torch.randn(*s, dtype=torch.bfloat16) * 0.05)(D, D))}
    _A_in = _A_setup()

    def _B_setup():
        B, S, D, F = (1, 2048, 512, 1376)
        Fh = F // 2
        return {'x': _w((lambda *s: torch.randn(*s, dtype=torch.bfloat16) * 0.05)(B, S, D)), 'w_in': _w((lambda *s: torch.randn(*s, dtype=torch.bfloat16) * 0.2)(D, 2 * Fh)), 'w_sp': _w(0.01 * (lambda *s: torch.randn(*s, dtype=torch.bfloat16) * 0.2)(S, S)), 'b_sp': _w(1.0 + 0.01 * (lambda *s: torch.randn(*s, dtype=torch.bfloat16) * 0.05)(S)), 'w_out': _w((lambda *s: torch.randn(*s, dtype=torch.bfloat16) * 0.05)(Fh, D))}
    _B_in = _B_setup()
    return {'A_x': _A_in['x'], 'A_wqkv': _A_in['wqkv'], 'A_w_phi': _A_in['w_phi'], 'A_wo': _A_in['wo'], 'B_x': _B_in['x'], 'B_w_in': _B_in['w_in'], 'B_w_sp': _B_in['w_sp'], 'B_b_sp': _B_in['b_sp'], 'B_w_out': _B_in['w_out']}

def reference(A_x, A_wqkv, A_w_phi, A_wo, B_x, B_w_in, B_w_sp, B_b_sp, B_w_out):

    def _A_ref(x, wqkv, w_phi, wo):
        B, S, D = x.shape
        H = 32
        Dh = D // H
        qkv = (lambda x, *d: x.permute(*d))((x @ wqkv).reshape(B, S, 3, H, Dh), 2, 0, 3, 1, 4)
        q, k, v = (qkv[0], qkv[1], qkv[2])
        pq = torch.einsum('bhsd,hdf->bhsf', q, w_phi)
        pk = torch.einsum('bhsd,hdf->bhsf', k, w_phi)
        phi_q = torch.concatenate([_softmax(pq, axis=-1), _softmax(-pq, axis=-1)], axis=-1)
        phi_k = torch.concatenate([_softmax(pk, axis=-1), _softmax(-pk, axis=-1)], axis=-1)
        kv = torch.einsum('bhsf,bhsd->bhfd', phi_k, v)
        z = torch.einsum('bhsf->bhf', phi_k)
        num = torch.einsum('bhqf,bhfd->bhqd', phi_q, kv)
        den = torch.einsum('bhqf,bhf->bhq', phi_q, z)[..., None] + 1e-06
        o = num / den
        return (lambda x, *d: x.permute(*d))(o, 0, 2, 1, 3).reshape(B, S, D) @ wo

    def _B_ref(x, w_in, w_sp, b_sp, w_out):
        B, S, D = x.shape
        F = w_in.shape[-1]
        Fh = F // 2
        z = _gelu(torch.einsum('bsd,df->bsf', x, w_in))
        z1 = z[..., :Fh].clone()
        z2 = _layernorm(z[..., Fh:], axis=-1)
        g = torch.einsum('ts,bsf->btf', w_sp, z2) + b_sp[None, :, None]
        return torch.einsum('bsf,fd->bsd', z1 * g, w_out)
    x = A_x
    h = x + _A_ref(_layernorm(x, axis=-1), A_wqkv, A_w_phi, A_wo)
    h2 = h + _B_ref(_layernorm(h, axis=-1), B_w_in, B_w_sp, B_b_sp, B_w_out)
    return h2
```

```asm
; @launch kernel=k1_kernel grid=(256,1,1) block=(256,1,1) lds=81920
; @launch kernel=k2a_kernel grid=(256,1,1) block=(256,1,1) lds=32768
; @launch kernel=k2b_kernel grid=(256,1,1) block=(256,1,1) lds=81920
; @launch kernel=k3_kernel grid=(256,1,1) block=(256,1,1) lds=122880
; @launch kernel=k4_kernel grid=(256,1,1) block=(256,1,1) lds=45056
.amdgcn_target "amdgcn-amd-amdhsa--gfx950"
.text
.globl k1_kernel
.p2align 8
.type k1_kernel,@function
k1_kernel:
    s_cmp_ge_u32 s2, 256
    s_cbranch_scc1 k1_kernel_end
    s_load_dwordx16 s[16:31], s[0:1], 0
    s_load_dwordx8 s[32:39], s[0:1], 64
    v_and_b32 v1, 63, v0
    v_lshrrev_b32 v2, 6, v0
    v_and_b32 v3, 15, v0
    v_readfirstlane_b32 s3, v2
    v_lshrrev_b32 v4, 4, v1
    s_bfe_u32 s4, s2, 0x20001
    s_lshl_b32 s4, s4, 2
    s_bfe_u32 s5, s2, 0x20003
    s_add_u32 s4, s4, s5
    s_and_b32 s5, s2, 1
    s_lshl_b32 s5, s5, 3
    s_lshr_b32 s7, s2, 5
    s_add_u32 s5, s5, s7
    s_lshl_b32 s6, s4, 7
    s_lshl_b32 s7, s3, 5
    s_add_u32 s6, s6, s7
    s_waitcnt lgkmcnt(0)
    s_mov_b32 s40, s16
    s_mov_b32 s41, s17
    s_mov_b32 s42, 2097152
    s_mov_b32 s43, 0x20000
    s_mov_b32 s44, s18
    s_mov_b32 s45, s19
    s_mov_b32 s46, 1572864
    s_mov_b32 s47, 0x20000
    s_mov_b32 s48, s20
    s_mov_b32 s49, s21
    s_mov_b32 s50, 16384
    s_mov_b32 s51, 0x20000
    s_mov_b32 s52, s38
    s_mov_b32 s53, s39
    s_mov_b32 s54, 2097152
    s_mov_b32 s55, 0x20000
    s_add_u32 s56, s38, 2097152
    s_addc_u32 s57, s39, 0
    s_mov_b32 s58, 2097152
    s_mov_b32 s59, 0x20000
    s_mov_b32 s60, s36
    s_mov_b32 s61, s37
    s_mov_b32 s62, 256
    s_mov_b32 s63, 0x20000
    v_and_b32 v10, 12, v1
    v_add_u32 v10, s6, v10
    s_movk_i32 s7, 1024
    v_mul_lo_u32 v10, v10, s7
    v_lshl_add_u32 v10, v4, 6, v10
    v_and_b32 v11, 3, v1
    v_lshl_add_u32 v10, v11, 4, v10
    v_add_u32 v11, 16384, v10
    s_lshl_b32 s64, s5, 6
    s_add_u32 s65, s64, 1024
    s_add_u32 s66, s64, 1056
    v_bfe_u32 v6, v1, 2, 3
    v_and_b32 v7, 32, v1
    v_add_u32 v6, v6, v7
    s_movk_i32 s7, 3072
    v_mul_lo_u32 v6, v6, s7
    v_and_b32 v7, 1, v1
    v_lshl_add_u32 v6, v7, 4, v6
    v_lshrrev_b32 v7, 4, v1
    v_xor_b32 v7, v7, v1
    v_and_b32 v7, 2, v7
    v_cmp_eq_u32 vcc, 0, v7
    v_mov_b32 v8, s66
    v_mov_b32 v9, s65
    v_cndmask_b32 v8, v8, v9, vcc
    v_add_u32 v12, v6, v8
    s_add_u32 s65, s64, 2048
    s_add_u32 s66, s64, 2080
    v_bfe_u32 v6, v1, 2, 3
    v_and_b32 v7, 32, v1
    v_add_u32 v6, v6, v7
    s_movk_i32 s7, 3072
    v_mul_lo_u32 v6, v6, s7
    v_and_b32 v7, 1, v1
    v_lshl_add_u32 v6, v7, 4, v6
    v_lshrrev_b32 v7, 4, v1
    v_xor_b32 v7, v7, v1
    v_and_b32 v7, 2, v7
    v_cmp_eq_u32 vcc, 0, v7
    v_mov_b32 v8, s66
    v_mov_b32 v9, s65
    v_cndmask_b32 v8, v8, v9, vcc
    v_add_u32 v13, v6, v8
    s_add_u32 s65, s64, 0
    s_add_u32 s66, s64, 32
    v_bfe_u32 v6, v1, 2, 3
    v_and_b32 v7, 32, v1
    v_add_u32 v6, v6, v7
    s_movk_i32 s7, 3072
    v_mul_lo_u32 v6, v6, s7
    v_and_b32 v7, 1, v1
    v_lshl_add_u32 v6, v7, 4, v6
    v_lshrrev_b32 v7, 4, v1
    v_xor_b32 v7, v7, v1
    v_and_b32 v7, 2, v7
    v_cmp_eq_u32 vcc, 0, v7
    v_mov_b32 v8, s66
    v_mov_b32 v9, s65
    v_cndmask_b32 v8, v8, v9, vcc
    v_add_u32 v14, v6, v8
    s_lshl_b32 s9, s3, 10
    s_and_b32 s10, s3, 1
    s_lshl_b32 s10, s10, 3
    s_lshr_b32 s7, s3, 1
    s_add_u32 s10, s10, s7
    s_mul_i32 s10, s10, 24576
    s_lshl_b32 s15, s5, 10
    v_lshlrev_b32 v15, 7, v4
    v_lshl_add_u32 v15, v3, 1, v15
    s_mov_b32 s14, 0x3fb8aa3b
    buffer_load_dwordx4 v[128:131], v10, s[40:43], 0 offen offset:0
    buffer_load_dwordx4 v[136:139], v10, s[40:43], 0 offen offset:1024
    buffer_load_dwordx4 v[144:147], v10, s[40:43], 0 offen offset:2048
    buffer_load_dwordx4 v[152:155], v10, s[40:43], 0 offen offset:3072
    s_add_u32 m0, s9, 0
    s_add_u32 s8, s10, 0
    buffer_load_dwordx4 v12, s[44:47], s8 offen lds
    s_add_u32 m0, s9, 32768
    s_add_u32 s8, s10, 0
    buffer_load_dwordx4 v13, s[44:47], s8 offen lds
    buffer_load_dwordx4 v[132:135], v11, s[40:43], 0 offen offset:0
    buffer_load_dwordx4 v[140:143], v11, s[40:43], 0 offen offset:1024
    buffer_load_dwordx4 v[148:151], v11, s[40:43], 0 offen offset:2048
    buffer_load_dwordx4 v[156:159], v11, s[40:43], 0 offen offset:3072
    s_add_u32 m0, s9, 4096
    s_add_u32 s8, s10, 49152
    buffer_load_dwordx4 v12, s[44:47], s8 offen lds
    s_add_u32 m0, s9, 36864
    s_add_u32 s8, s10, 49152
    buffer_load_dwordx4 v13, s[44:47], s8 offen lds
    buffer_load_dwordx4 v[160:163], v10, s[40:43], 0 offen offset:256
    buffer_load_dwordx4 v[168:171], v10, s[40:43], 0 offen offset:1280
    buffer_load_dwordx4 v[176:179], v10, s[40:43], 0 offen offset:2304
    buffer_load_dwordx4 v[184:187], v10, s[40:43], 0 offen offset:3328
    s_add_u32 m0, s9, 8192
    s_add_u32 s8, s10, 393216
    buffer_load_dwordx4 v12, s[44:47], s8 offen lds
    s_add_u32 m0, s9, 40960
    s_add_u32 s8, s10, 393216
    buffer_load_dwordx4 v13, s[44:47], s8 offen lds
    buffer_load_dwordx4 v[164:167], v11, s[40:43], 0 offen offset:256
    buffer_load_dwordx4 v[172:175], v11, s[40:43], 0 offen offset:1280
    buffer_load_dwordx4 v[180:183], v11, s[40:43], 0 offen offset:2304
    buffer_load_dwordx4 v[188:191], v11, s[40:43], 0 offen offset:3328
    s_add_u32 m0, s9, 12288
    s_add_u32 s8, s10, 442368
    buffer_load_dwordx4 v12, s[44:47], s8 offen lds
    s_add_u32 m0, s9, 45056
    s_add_u32 s8, s10, 442368
    buffer_load_dwordx4 v13, s[44:47], s8 offen lds
    s_mov_b32 s68, 0x55555555
    s_mov_b32 s69, 0x55555555
    s_mov_b32 s70, 0xaaaaaaaa
    s_mov_b32 s71, 0xaaaaaaaa
    s_mov_b32 s72, 0x33333333
    s_mov_b32 s73, 0x33333333
    s_mov_b32 s74, 0xcccccccc
    s_mov_b32 s75, 0xcccccccc
    v_bfe_u32 v5, v1, 2, 2
    v_lshl_add_u32 v5, v4, 3, v5
    v_lshlrev_b32 v5, 6, v5
    v_and_b32 v6, 3, v1
    v_lshl_add_u32 v5, v6, 3, v5
    v_and_b32 v6, 1, v4
    v_lshl_add_u32 v16, v6, 5, v5
    v_xor_b32 v17, 32, v16
    v_add_u32 v18, 0x10000, v16
    v_add_u32 v19, 0x10000, v17
    s_mov_b32 s11, 0x3f803f80
    v_mov_b32 v34, s11
    v_mov_b32 v35, s11
    v_mov_b32 v36, s11
    v_mov_b32 v37, s11
    s_waitcnt vmcnt(20)
    s_mov_b64 vcc, s[68:69]
    v_cndmask_b32_dpp v56, v136, v128, vcc quad_perm:[1,0,3,2] row_mask:0xf bank_mask:0xf
    v_cndmask_b32_dpp v57, v137, v129, vcc quad_perm:[1,0,3,2] row_mask:0xf bank_mask:0xf
    v_cndmask_b32_dpp v60, v152, v144, vcc quad_perm:[1,0,3,2] row_mask:0xf bank_mask:0xf
    v_cndmask_b32_dpp v61, v153, v145, vcc quad_perm:[1,0,3,2] row_mask:0xf bank_mask:0xf
    s_mov_b64 vcc, s[70:71]
    v_cndmask_b32_dpp v58, v128, v136, vcc quad_perm:[1,0,3,2] row_mask:0xf bank_mask:0xf
    v_cndmask_b32_dpp v59, v129, v137, vcc quad_perm:[1,0,3,2] row_mask:0xf bank_mask:0xf
    v_cndmask_b32_dpp v62, v144, v152, vcc quad_perm:[1,0,3,2] row_mask:0xf bank_mask:0xf
    v_cndmask_b32_dpp v63, v145, v153, vcc quad_perm:[1,0,3,2] row_mask:0xf bank_mask:0xf
    s_mov_b64 vcc, s[72:73]
    v_cndmask_b32_dpp v128, v60, v56, vcc quad_perm:[2,3,0,1] row_mask:0xf bank_mask:0xf
    v_cndmask_b32_dpp v129, v61, v57, vcc quad_perm:[2,3,0,1] row_mask:0xf bank_mask:0xf
    v_cndmask_b32_dpp v136, v62, v58, vcc quad_perm:[2,3,0,1] row_mask:0xf bank_mask:0xf
    v_cndmask_b32_dpp v137, v63, v59, vcc quad_perm:[2,3,0,1] row_mask:0xf bank_mask:0xf
    s_mov_b64 vcc, s[74:75]
    v_cndmask_b32_dpp v144, v56, v60, vcc quad_perm:[2,3,0,1] row_mask:0xf bank_mask:0xf
    v_cndmask_b32_dpp v145, v57, v61, vcc quad_perm:[2,3,0,1] row_mask:0xf bank_mask:0xf
    v_cndmask_b32_dpp v152, v58, v62, vcc quad_perm:[2,3,0,1] row_mask:0xf bank_mask:0xf
    v_cndmask_b32_dpp v153, v59, v63, vcc quad_perm:[2,3,0,1] row_mask:0xf bank_mask:0xf
    s_mov_b64 vcc, s[68:69]
    v_cndmask_b32_dpp v56, v138, v130, vcc quad_perm:[1,0,3,2] row_mask:0xf bank_mask:0xf
    v_cndmask_b32_dpp v57, v139, v131, vcc quad_perm:[1,0,3,2] row_mask:0xf bank_mask:0xf
    v_cndmask_b32_dpp v60, v154, v146, vcc quad_perm:[1,0,3,2] row_mask:0xf bank_mask:0xf
    v_cndmask_b32_dpp v61, v155, v147, vcc quad_perm:[1,0,3,2] row_mask:0xf bank_mask:0xf
    s_mov_b64 vcc, s[70:71]
    v_cndmask_b32_dpp v58, v130, v138, vcc quad_perm:[1,0,3,2] row_mask:0xf bank_mask:0xf
    v_cndmask_b32_dpp v59, v131, v139, vcc quad_perm:[1,0,3,2] row_mask:0xf bank_mask:0xf
    v_cndmask_b32_dpp v62, v146, v154, vcc quad_perm:[1,0,3,2] row_mask:0xf bank_mask:0xf
    v_cndmask_b32_dpp v63, v147, v155, vcc quad_perm:[1,0,3,2] row_mask:0xf bank_mask:0xf
    s_mov_b64 vcc, s[72:73]
    v_cndmask_b32_dpp v130, v60, v56, vcc quad_perm:[2,3,0,1] row_mask:0xf bank_mask:0xf
    v_cndmask_b32_dpp v131, v61, v57, vcc quad_perm:[2,3,0,1] row_mask:0xf bank_mask:0xf
    v_cndmask_b32_dpp v138, v62, v58, vcc quad_perm:[2,3,0,1] row_mask:0xf bank_mask:0xf
    v_cndmask_b32_dpp v139, v63, v59, vcc quad_perm:[2,3,0,1] row_mask:0xf bank_mask:0xf
    s_mov_b64 vcc, s[74:75]
    v_cndmask_b32_dpp v146, v56, v60, vcc quad_perm:[2,3,0,1] row_mask:0xf bank_mask:0xf
    v_cndmask_b32_dpp v147, v57, v61, vcc quad_perm:[2,3,0,1] row_mask:0xf bank_mask:0xf
    v_cndmask_b32_dpp v154, v58, v62, vcc quad_perm:[2,3,0,1] row_mask:0xf bank_mask:0xf
    v_cndmask_b32_dpp v155, v59, v63, vcc quad_perm:[2,3,0,1] row_mask:0xf bank_mask:0xf
    s_waitcnt vmcnt(14)
    s_mov_b64 vcc, s[68:69]
    v_cndmask_b32_dpp v56, v140, v132, vcc quad_perm:[1,0,3,2] row_mask:0xf bank_mask:0xf
    v_cndmask_b32_dpp v57, v141, v133, vcc quad_perm:[1,0,3,2] row_mask:0xf bank_mask:0xf
    v_cndmask_b32_dpp v60, v156, v148, vcc quad_perm:[1,0,3,2] row_mask:0xf bank_mask:0xf
    v_cndmask_b32_dpp v61, v157, v149, vcc quad_perm:[1,0,3,2] row_mask:0xf bank_mask:0xf
    s_mov_b64 vcc, s[70:71]
    v_cndmask_b32_dpp v58, v132, v140, vcc quad_perm:[1,0,3,2] row_mask:0xf bank_mask:0xf
    v_cndmask_b32_dpp v59, v133, v141, vcc quad_perm:[1,0,3,2] row_mask:0xf bank_mask:0xf
    v_cndmask_b32_dpp v62, v148, v156, vcc quad_perm:[1,0,3,2] row_mask:0xf bank_mask:0xf
    v_cndmask_b32_dpp v63, v149, v157, vcc quad_perm:[1,0,3,2] row_mask:0xf bank_mask:0xf
    s_mov_b64 vcc, s[72:73]
    v_cndmask_b32_dpp v132, v60, v56, vcc quad_perm:[2,3,0,1] row_mask:0xf bank_mask:0xf
    v_cndmask_b32_dpp v133, v61, v57, vcc quad_perm:[2,3,0,1] row_mask:0xf bank_mask:0xf
    v_cndmask_b32_dpp v140, v62, v58, vcc quad_perm:[2,3,0,1] row_mask:0xf bank_mask:0xf
    v_cndmask_b32_dpp v141, v63, v59, vcc quad_perm:[2,3,0,1] row_mask:0xf bank_mask:0xf
    s_mov_b64 vcc, s[74:75]
    v_cndmask_b32_dpp v148, v56, v60, vcc quad_perm:[2,3,0,1] row_mask:0xf bank_mask:0xf
    v_cndmask_b32_dpp v149, v57, v61, vcc quad_perm:[2,3,0,1] row_mask:0xf bank_mask:0xf
    v_cndmask_b32_dpp v156, v58, v62, vcc quad_perm:[2,3,0,1] row_mask:0xf bank_mask:0xf
    v_cndmask_b32_dpp v157, v59, v63, vcc quad_perm:[2,3,0,1] row_mask:0xf bank_mask:0xf
    s_mov_b64 vcc, s[68:69]
    v_cndmask_b32_dpp v56, v142, v134, vcc quad_perm:[1,0,3,2] row_mask:0xf bank_mask:0xf
    v_cndmask_b32_dpp v57, v143, v135, vcc quad_perm:[1,0,3,2] row_mask:0xf bank_mask:0xf
    v_cndmask_b32_dpp v60, v158, v150, vcc quad_perm:[1,0,3,2] row_mask:0xf bank_mask:0xf
    v_cndmask_b32_dpp v61, v159, v151, vcc quad_perm:[1,0,3,2] row_mask:0xf bank_mask:0xf
    s_mov_b64 vcc, s[70:71]
    v_cndmask_b32_dpp v58, v134, v142, vcc quad_perm:[1,0,3,2] row_mask:0xf bank_mask:0xf
    v_cndmask_b32_dpp v59, v135, v143, vcc quad_perm:[1,0,3,2] row_mask:0xf bank_mask:0xf
    v_cndmask_b32_dpp v62, v150, v158, vcc quad_perm:[1,0,3,2] row_mask:0xf bank_mask:0xf
    v_cndmask_b32_dpp v63, v151, v159, vcc quad_perm:[1,0,3,2] row_mask:0xf bank_mask:0xf
    s_mov_b64 vcc, s[72:73]
    v_cndmask_b32_dpp v134, v60, v56, vcc quad_perm:[2,3,0,1] row_mask:0xf bank_mask:0xf
    v_cndmask_b32_dpp v135, v61, v57, vcc quad_perm:[2,3,0,1] row_mask:0xf bank_mask:0xf
    v_cndmask_b32_dpp v142, v62, v58, vcc quad_perm:[2,3,0,1] row_mask:0xf bank_mask:0xf
    v_cndmask_b32_dpp v143, v63, v59, vcc quad_perm:[2,3,0,1] row_mask:0xf bank_mask:0xf
    s_mov_b64 vcc, s[74:75]
    v_cndmask_b32_dpp v150, v56, v60, vcc quad_perm:[2,3,0,1] row_mask:0xf bank_mask:0xf
    v_cndmask_b32_dpp v151, v57, v61, vcc quad_perm:[2,3,0,1] row_mask:0xf bank_mask:0xf
    v_cndmask_b32_dpp v158, v58, v62, vcc quad_perm:[2,3,0,1] row_mask:0xf bank_mask:0xf
    v_cndmask_b32_dpp v159, v59, v63, vcc quad_perm:[2,3,0,1] row_mask:0xf bank_mask:0xf
    s_waitcnt vmcnt(12)
    s_barrier
    ds_read_b64_tr_b16 v[64:65], v16 offset:0
    ds_read_b64_tr_b16 v[66:67], v16 offset:256
    ds_read_b64_tr_b16 v[68:69], v17 offset:0
    ds_read_b64_tr_b16 v[70:71], v17 offset:256
    ds_read_b64_tr_b16 v[72:73], v16 offset:32768
    ds_read_b64_tr_b16 v[74:75], v16 offset:33024
    ds_read_b64_tr_b16 v[76:77], v17 offset:32768
    ds_read_b64_tr_b16 v[78:79], v17 offset:33024
    v_mfma_f32_16x16x32_bf16 v[20:23], v[34:37], v[128:131], 0
    v_mfma_f32_16x16x32_bf16 v[28:31], v[128:131], v[128:131], 0
    v_mfma_f32_16x16x32_bf16 v[24:27], v[34:37], v[132:135], 0
    v_mfma_f32_16x16x32_bf16 v[6:9], v[132:135], v[132:135], 0
    s_waitcnt lgkmcnt(0)
    v_mfma_f32_16x16x32_bf16 v[96:99], v[64:67], v[128:131], 0
    ds_read_b64_tr_b16 v[80:81], v16 offset:2048
    v_mfma_f32_16x16x32_bf16 v[100:103], v[64:67], v[132:135], 0
    ds_read_b64_tr_b16 v[82:83], v16 offset:2304
    v_mfma_f32_16x16x32_bf16 v[40:43], v[64:67], v[34:37], 0
    ds_read_b64_tr_b16 v[84:85], v17 offset:2048
    v_mfma_f32_16x16x32_bf16 v[104:107], v[68:71], v[128:131], 0
    ds_read_b64_tr_b16 v[86:87], v17 offset:2304
    v_mfma_f32_16x16x32_bf16 v[108:111], v[68:71], v[132:135], 0
    ds_read_b64_tr_b16 v[88:89], v16 offset:34816
    v_mfma_f32_16x16x32_bf16 v[44:47], v[68:71], v[34:37], 0
    ds_read_b64_tr_b16 v[90:91], v16 offset:35072
    ds_read_b64_tr_b16 v[92:93], v17 offset:34816
    v_mfma_f32_16x16x32_bf16 v[112:115], v[128:131], v[72:75], 0
    ds_read_b64_tr_b16 v[94:95], v17 offset:35072
    v_mfma_f32_16x16x32_bf16 v[116:119], v[132:135], v[72:75], 0
    buffer_load_dwordx4 v[192:195], v10, s[40:43], 0 offen offset:512
    v_mfma_f32_16x16x32_bf16 v[48:51], v[34:37], v[72:75], 0
    buffer_load_dwordx4 v[200:203], v10, s[40:43], 0 offen offset:1536
    v_mfma_f32_16x16x32_bf16 v[120:123], v[128:131], v[76:79], 0
    buffer_load_dwordx4 v[208:211], v10, s[40:43], 0 offen offset:2560
    v_mfma_f32_16x16x32_bf16 v[124:127], v[132:135], v[76:79], 0
    buffer_load_dwordx4 v[216:219], v10, s[40:43], 0 offen offset:3584
    v_mfma_f32_16x16x32_bf16 v[52:55], v[34:37], v[76:79], 0
    s_add_u32 m0, s9, 16384
    s_add_u32 s8, s10, 786432
    buffer_load_dwordx4 v12, s[44:47], s8 offen lds
    s_add_u32 m0, s9, 49152
    s_add_u32 s8, s10, 786432
    buffer_load_dwordx4 v13, s[44:47], s8 offen lds
    s_nop 1
    v_mfma_f32_16x16x32_bf16 v[20:23], v[34:37], v[136:139], v[20:23]
    v_mfma_f32_16x16x32_bf16 v[28:31], v[136:139], v[136:139], v[28:31]
    v_mfma_f32_16x16x32_bf16 v[24:27], v[34:37], v[140:143], v[24:27]
    v_mfma_f32_16x16x32_bf16 v[6:9], v[140:143], v[140:143], v[6:9]
    s_waitcnt lgkmcnt(0)
    v_mfma_f32_16x16x32_bf16 v[96:99], v[80:83], v[136:139], v[96:99]
    ds_read_b64_tr_b16 v[64:65], v16 offset:4096
    v_mfma_f32_16x16x32_bf16 v[100:103], v[80:83], v[140:143], v[100:103]
    ds_read_b64_tr_b16 v[66:67], v16 offset:4352
    v_mfma_f32_16x16x32_bf16 v[40:43], v[80:83], v[34:37], v[40:43]
    ds_read_b64_tr_b16 v[68:69], v17 offset:4096
    v_mfma_f32_16x16x32_bf16 v[104:107], v[84:87], v[136:139], v[104:107]
    ds_read_b64_tr_b16 v[70:71], v17 offset:4352
    v_mfma_f32_16x16x32_bf16 v[108:111], v[84:87], v[140:143], v[108:111]
    ds_read_b64_tr_b16 v[72:73], v16 offset:36864
    v_mfma_f32_16x16x32_bf16 v[44:47], v[84:87], v[34:37], v[44:47]
    ds_read_b64_tr_b16 v[74:75], v16 offset:37120
    ds_read_b64_tr_b16 v[76:77], v17 offset:36864
    v_mfma_f32_16x16x32_bf16 v[112:115], v[136:139], v[88:91], v[112:115]
    ds_read_b64_tr_b16 v[78:79], v17 offset:37120
    v_mfma_f32_16x16x32_bf16 v[116:119], v[140:143], v[88:91], v[116:119]
    buffer_load_dwordx4 v[196:199], v11, s[40:43], 0 offen offset:512
    v_mfma_f32_16x16x32_bf16 v[48:51], v[34:37], v[88:91], v[48:51]
    buffer_load_dwordx4 v[204:207], v11, s[40:43], 0 offen offset:1536
    v_mfma_f32_16x16x32_bf16 v[120:123], v[136:139], v[92:95], v[120:123]
    buffer_load_dwordx4 v[212:215], v11, s[40:43], 0 offen offset:2560
    v_mfma_f32_16x16x32_bf16 v[124:127], v[140:143], v[92:95], v[124:127]
    buffer_load_dwordx4 v[220:223], v11, s[40:43], 0 offen offset:3584
    v_mfma_f32_16x16x32_bf16 v[52:55], v[34:37], v[92:95], v[52:55]
    s_add_u32 m0, s9, 20480
    s_add_u32 s8, s10, 835584
    buffer_load_dwordx4 v12, s[44:47], s8 offen lds
    s_add_u32 m0, s9, 53248
    s_add_u32 s8, s10, 835584
    buffer_load_dwordx4 v13, s[44:47], s8 offen lds
    s_nop 1
    v_mfma_f32_16x16x32_bf16 v[20:23], v[34:37], v[144:147], v[20:23]
    v_mfma_f32_16x16x32_bf16 v[28:31], v[144:147], v[144:147], v[28:31]
    v_mfma_f32_16x16x32_bf16 v[24:27], v[34:37], v[148:151], v[24:27]
    v_mfma_f32_16x16x32_bf16 v[6:9], v[148:151], v[148:151], v[6:9]
    s_waitcnt lgkmcnt(0)
    v_mfma_f32_16x16x32_bf16 v[96:99], v[64:67], v[144:147], v[96:99]
    ds_read_b64_tr_b16 v[80:81], v16 offset:6144
    ds_read_b64_tr_b16 v[82:83], v16 offset:6400
    ds_read_b64_tr_b16 v[84:85], v17 offset:6144
    ds_read_b64_tr_b16 v[86:87], v17 offset:6400
    v_mfma_f32_16x16x32_bf16 v[100:103], v[64:67], v[148:151], v[100:103]
    ds_read_b64_tr_b16 v[88:89], v16 offset:38912
    ds_read_b64_tr_b16 v[90:91], v16 offset:39168
    ds_read_b64_tr_b16 v[92:93], v17 offset:38912
    ds_read_b64_tr_b16 v[94:95], v17 offset:39168
    v_mfma_f32_16x16x32_bf16 v[40:43], v[64:67], v[34:37], v[40:43]
    s_waitcnt vmcnt(20)
    s_mov_b64 vcc, s[68:69]
    v_cndmask_b32_dpp v56, v168, v160, vcc quad_perm:[1,0,3,2] row_mask:0xf bank_mask:0xf
    v_cndmask_b32_dpp v57, v169, v161, vcc quad_perm:[1,0,3,2] row_mask:0xf bank_mask:0xf
    v_mfma_f32_16x16x32_bf16 v[104:107], v[68:71], v[144:147], v[104:107]
    v_cndmask_b32_dpp v60, v184, v176, vcc quad_perm:[1,0,3,2] row_mask:0xf bank_mask:0xf
    v_cndmask_b32_dpp v61, v185, v177, vcc quad_perm:[1,0,3,2] row_mask:0xf bank_mask:0xf
    s_mov_b64 vcc, s[70:71]
    v_cndmask_b32_dpp v58, v160, v168, vcc quad_perm:[1,0,3,2] row_mask:0xf bank_mask:0xf
    v_mfma_f32_16x16x32_bf16 v[108:111], v[68:71], v[148:151], v[108:111]
    v_cndmask_b32_dpp v59, v161, v169, vcc quad_perm:[1,0,3,2] row_mask:0xf bank_mask:0xf
    v_cndmask_b32_dpp v62, v176, v184, vcc quad_perm:[1,0,3,2] row_mask:0xf bank_mask:0xf
    v_cndmask_b32_dpp v63, v177, v185, vcc quad_perm:[1,0,3,2] row_mask:0xf bank_mask:0xf
    s_mov_b64 vcc, s[72:73]
    v_mfma_f32_16x16x32_bf16 v[44:47], v[68:71], v[34:37], v[44:47]
    v_cndmask_b32_dpp v160, v60, v56, vcc quad_perm:[2,3,0,1] row_mask:0xf bank_mask:0xf
    v_cndmask_b32_dpp v161, v61, v57, vcc quad_perm:[2,3,0,1] row_mask:0xf bank_mask:0xf
    v_cndmask_b32_dpp v168, v62, v58, vcc quad_perm:[2,3,0,1] row_mask:0xf bank_mask:0xf
    v_cndmask_b32_dpp v169, v63, v59, vcc quad_perm:[2,3,0,1] row_mask:0xf bank_mask:0xf
    v_mfma_f32_16x16x32_bf16 v[112:115], v[144:147], v[72:75], v[112:115]
    s_mov_b64 vcc, s[74:75]
    v_cndmask_b32_dpp v176, v56, v60, vcc quad_perm:[2,3,0,1] row_mask:0xf bank_mask:0xf
    v_cndmask_b32_dpp v177, v57, v61, vcc quad_perm:[2,3,0,1] row_mask:0xf bank_mask:0xf
    v_cndmask_b32_dpp v184, v58, v62, vcc quad_perm:[2,3,0,1] row_mask:0xf bank_mask:0xf
    v_mfma_f32_16x16x32_bf16 v[116:119], v[148:151], v[72:75], v[116:119]
    v_cndmask_b32_dpp v185, v59, v63, vcc quad_perm:[2,3,0,1] row_mask:0xf bank_mask:0xf
    s_mov_b64 vcc, s[68:69]
    v_cndmask_b32_dpp v56, v170, v162, vcc quad_perm:[1,0,3,2] row_mask:0xf bank_mask:0xf
    v_cndmask_b32_dpp v57, v171, v163, vcc quad_perm:[1,0,3,2] row_mask:0xf bank_mask:0xf
    v_mfma_f32_16x16x32_bf16 v[48:51], v[34:37], v[72:75], v[48:51]
    v_cndmask_b32_dpp v60, v186, v178, vcc quad_perm:[1,0,3,2] row_mask:0xf bank_mask:0xf
    v_cndmask_b32_dpp v61, v187, v179, vcc quad_perm:[1,0,3,2] row_mask:0xf bank_mask:0xf
    s_mov_b64 vcc, s[70:71]
    v_cndmask_b32_dpp v58, v162, v170, vcc quad_perm:[1,0,3,2] row_mask:0xf bank_mask:0xf
    v_mfma_f32_16x16x32_bf16 v[120:123], v[144:147], v[76:79], v[120:123]
    v_cndmask_b32_dpp v59, v163, v171, vcc quad_perm:[1,0,3,2] row_mask:0xf bank_mask:0xf
    v_cndmask_b32_dpp v62, v178, v186, vcc quad_perm:[1,0,3,2] row_mask:0xf bank_mask:0xf
    v_cndmask_b32_dpp v63, v179, v187, vcc quad_perm:[1,0,3,2] row_mask:0xf bank_mask:0xf
    s_mov_b64 vcc, s[72:73]
    v_mfma_f32_16x16x32_bf16 v[124:127], v[148:151], v[76:79], v[124:127]
    v_cndmask_b32_dpp v162, v60, v56, vcc quad_perm:[2,3,0,1] row_mask:0xf bank_mask:0xf
    v_cndmask_b32_dpp v163, v61, v57, vcc quad_perm:[2,3,0,1] row_mask:0xf bank_mask:0xf
    v_cndmask_b32_dpp v170, v62, v58, vcc quad_perm:[2,3,0,1] row_mask:0xf bank_mask:0xf
    v_cndmask_b32_dpp v171, v63, v59, vcc quad_perm:[2,3,0,1] row_mask:0xf bank_mask:0xf
    v_mfma_f32_16x16x32_bf16 v[52:55], v[34:37], v[76:79], v[52:55]
    s_mov_b64 vcc, s[74:75]
    v_cndmask_b32_dpp v178, v56, v60, vcc quad_perm:[2,3,0,1] row_mask:0xf bank_mask:0xf
    v_cndmask_b32_dpp v179, v57, v61, vcc quad_perm:[2,3,0,1] row_mask:0xf bank_mask:0xf
    v_cndmask_b32_dpp v186, v58, v62, vcc quad_perm:[2,3,0,1] row_mask:0xf bank_mask:0xf
    v_cndmask_b32_dpp v187, v59, v63, vcc quad_perm:[2,3,0,1] row_mask:0xf bank_mask:0xf
    s_nop 1
    v_mfma_f32_16x16x32_bf16 v[20:23], v[34:37], v[152:155], v[20:23]
    v_mfma_f32_16x16x32_bf16 v[28:31], v[152:155], v[152:155], v[28:31]
    v_mfma_f32_16x16x32_bf16 v[24:27], v[34:37], v[156:159], v[24:27]
    v_mfma_f32_16x16x32_bf16 v[6:9], v[156:159], v[156:159], v[6:9]
    s_waitcnt lgkmcnt(0)
    v_mfma_f32_16x16x32_bf16 v[96:99], v[80:83], v[152:155], v[96:99]
    s_waitcnt vmcnt(14)
    s_mov_b64 vcc, s[68:69]
    v_cndmask_b32_dpp v56, v172, v164, vcc quad_perm:[1,0,3,2] row_mask:0xf bank_mask:0xf
    v_cndmask_b32_dpp v57, v173, v165, vcc quad_perm:[1,0,3,2] row_mask:0xf bank_mask:0xf
    v_mfma_f32_16x16x32_bf16 v[100:103], v[80:83], v[156:159], v[100:103]
    v_cndmask_b32_dpp v60, v188, v180, vcc quad_perm:[1,0,3,2] row_mask:0xf bank_mask:0xf
    v_cndmask_b32_dpp v61, v189, v181, vcc quad_perm:[1,0,3,2] row_mask:0xf bank_mask:0xf
    s_mov_b64 vcc, s[70:71]
    v_cndmask_b32_dpp v58, v164, v172, vcc quad_perm:[1,0,3,2] row_mask:0xf bank_mask:0xf
    v_mfma_f32_16x16x32_bf16 v[40:43], v[80:83], v[34:37], v[40:43]
    v_cndmask_b32_dpp v59, v165, v173, vcc quad_perm:[1,0,3,2] row_mask:0xf bank_mask:0xf
    v_cndmask_b32_dpp v62, v180, v188, vcc quad_perm:[1,0,3,2] row_mask:0xf bank_mask:0xf
    v_cndmask_b32_dpp v63, v181, v189, vcc quad_perm:[1,0,3,2] row_mask:0xf bank_mask:0xf
    s_mov_b64 vcc, s[72:73]
    v_mfma_f32_16x16x32_bf16 v[104:107], v[84:87], v[152:155], v[104:107]
    v_cndmask_b32_dpp v164, v60, v56, vcc quad_perm:[2,3,0,1] row_mask:0xf bank_mask:0xf
    v_cndmask_b32_dpp v165, v61, v57, vcc quad_perm:[2,3,0,1] row_mask:0xf bank_mask:0xf
    v_cndmask_b32_dpp v172, v62, v58, vcc quad_perm:[2,3,0,1] row_mask:0xf bank_mask:0xf
    v_cndmask_b32_dpp v173, v63, v59, vcc quad_perm:[2,3,0,1] row_mask:0xf bank_mask:0xf
    s_mov_b64 vcc, s[74:75]
    v_mfma_f32_16x16x32_bf16 v[108:111], v[84:87], v[156:159], v[108:111]
    v_cndmask_b32_dpp v180, v56, v60, vcc quad_perm:[2,3,0,1] row_mask:0xf bank_mask:0xf
    v_cndmask_b32_dpp v181, v57, v61, vcc quad_perm:[2,3,0,1] row_mask:0xf bank_mask:0xf
    v_cndmask_b32_dpp v188, v58, v62, vcc quad_perm:[2,3,0,1] row_mask:0xf bank_mask:0xf
    v_cndmask_b32_dpp v189, v59, v63, vcc quad_perm:[2,3,0,1] row_mask:0xf bank_mask:0xf
    v_mfma_f32_16x16x32_bf16 v[44:47], v[84:87], v[34:37], v[44:47]
    s_mov_b64 vcc, s[68:69]
    v_cndmask_b32_dpp v56, v174, v166, vcc quad_perm:[1,0,3,2] row_mask:0xf bank_mask:0xf
    v_cndmask_b32_dpp v57, v175, v167, vcc quad_perm:[1,0,3,2] row_mask:0xf bank_mask:0xf
    v_cndmask_b32_dpp v60, v190, v182, vcc quad_perm:[1,0,3,2] row_mask:0xf bank_mask:0xf
    v_mfma_f32_16x16x32_bf16 v[112:115], v[152:155], v[88:91], v[112:115]
    v_cndmask_b32_dpp v61, v191, v183, vcc quad_perm:[1,0,3,2] row_mask:0xf bank_mask:0xf
    s_mov_b64 vcc, s[70:71]
    v_cndmask_b32_dpp v58, v166, v174, vcc quad_perm:[1,0,3,2] row_mask:0xf bank_mask:0xf
    v_cndmask_b32_dpp v59, v167, v175, vcc quad_perm:[1,0,3,2] row_mask:0xf bank_mask:0xf
    v_mfma_f32_16x16x32_bf16 v[116:119], v[156:159], v[88:91], v[116:119]
    v_cndmask_b32_dpp v62, v182, v190, vcc quad_perm:[1,0,3,2] row_mask:0xf bank_mask:0xf
    v_cndmask_b32_dpp v63, v183, v191, vcc quad_perm:[1,0,3,2] row_mask:0xf bank_mask:0xf
    s_mov_b64 vcc, s[72:73]
    v_cndmask_b32_dpp v166, v60, v56, vcc quad_perm:[2,3,0,1] row_mask:0xf bank_mask:0xf
    v_cndmask_b32_dpp v167, v61, v57, vcc quad_perm:[2,3,0,1] row_mask:0xf bank_mask:0xf
    v_mfma_f32_16x16x32_bf16 v[48:51], v[34:37], v[88:91], v[48:51]
    v_cndmask_b32_dpp v174, v62, v58, vcc quad_perm:[2,3,0,1] row_mask:0xf bank_mask:0xf
    v_cndmask_b32_dpp v175, v63, v59, vcc quad_perm:[2,3,0,1] row_mask:0xf bank_mask:0xf
    s_mov_b64 vcc, s[74:75]
    v_cndmask_b32_dpp v182, v56, v60, vcc quad_perm:[2,3,0,1] row_mask:0xf bank_mask:0xf
    v_mfma_f32_16x16x32_bf16 v[120:123], v[152:155], v[92:95], v[120:123]
    v_cndmask_b32_dpp v183, v57, v61, vcc quad_perm:[2,3,0,1] row_mask:0xf bank_mask:0xf
    v_cndmask_b32_dpp v190, v58, v62, vcc quad_perm:[2,3,0,1] row_mask:0xf bank_mask:0xf
    v_cndmask_b32_dpp v191, v59, v63, vcc quad_perm:[2,3,0,1] row_mask:0xf bank_mask:0xf
    s_waitcnt vmcnt(12)
    v_mfma_f32_16x16x32_bf16 v[124:127], v[156:159], v[92:95], v[124:127]
    s_barrier
    ds_read_b64_tr_b16 v[64:65], v16 offset:8192
    ds_read_b64_tr_b16 v[66:67], v16 offset:8448
    ds_read_b64_tr_b16 v[68:69], v17 offset:8192
    v_mfma_f32_16x16x32_bf16 v[52:55], v[34:37], v[92:95], v[52:55]
    ds_read_b64_tr_b16 v[70:71], v17 offset:8448
    ds_read_b64_tr_b16 v[72:73], v16 offset:40960
    ds_read_b64_tr_b16 v[74:75], v16 offset:41216
    ds_read_b64_tr_b16 v[76:77], v17 offset:40960
    ds_read_b64_tr_b16 v[78:79], v17 offset:41216
    s_nop 1
    v_mfma_f32_16x16x32_bf16 v[20:23], v[34:37], v[160:163], v[20:23]
    v_mfma_f32_16x16x32_bf16 v[28:31], v[160:163], v[160:163], v[28:31]
    v_mfma_f32_16x16x32_bf16 v[24:27], v[34:37], v[164:167], v[24:27]
    v_mfma_f32_16x16x32_bf16 v[6:9], v[164:167], v[164:167], v[6:9]
    s_waitcnt lgkmcnt(0)
    v_mfma_f32_16x16x32_bf16 v[96:99], v[64:67], v[160:163], v[96:99]
    ds_read_b64_tr_b16 v[80:81], v16 offset:10240
    v_mfma_f32_16x16x32_bf16 v[100:103], v[64:67], v[164:167], v[100:103]
    ds_read_b64_tr_b16 v[82:83], v16 offset:10496
    v_mfma_f32_16x16x32_bf16 v[40:43], v[64:67], v[34:37], v[40:43]
    ds_read_b64_tr_b16 v[84:85], v17 offset:10240
    v_mfma_f32_16x16x32_bf16 v[104:107], v[68:71], v[160:163], v[104:107]
    ds_read_b64_tr_b16 v[86:87], v17 offset:10496
    v_mfma_f32_16x16x32_bf16 v[108:111], v[68:71], v[164:167], v[108:111]
    ds_read_b64_tr_b16 v[88:89], v16 offset:43008
    v_mfma_f32_16x16x32_bf16 v[44:47], v[68:71], v[34:37], v[44:47]
    ds_read_b64_tr_b16 v[90:91], v16 offset:43264
    ds_read_b64_tr_b16 v[92:93], v17 offset:43008
    v_mfma_f32_16x16x32_bf16 v[112:115], v[160:163], v[72:75], v[112:115]
    ds_read_b64_tr_b16 v[94:95], v17 offset:43264
    v_mfma_f32_16x16x32_bf16 v[116:119], v[164:167], v[72:75], v[116:119]
    buffer_load_dwordx4 v[224:227], v10, s[40:43], 0 offen offset:768
    v_mfma_f32_16x16x32_bf16 v[48:51], v[34:37], v[72:75], v[48:51]
    buffer_load_dwordx4 v[232:235], v10, s[40:43], 0 offen offset:1792
    v_mfma_f32_16x16x32_bf16 v[120:123], v[160:163], v[76:79], v[120:123]
    buffer_load_dwordx4 v[240:243], v10, s[40:43], 0 offen offset:2816
    v_mfma_f32_16x16x32_bf16 v[124:127], v[164:167], v[76:79], v[124:127]
    buffer_load_dwordx4 v[248:251], v10, s[40:43], 0 offen offset:3840
    v_mfma_f32_16x16x32_bf16 v[52:55], v[34:37], v[76:79], v[52:55]
    s_add_u32 m0, s9, 24576
    s_add_u32 s8, s10, 1179648
    buffer_load_dwordx4 v12, s[44:47], s8 offen lds
    s_add_u32 m0, s9, 57344
    s_add_u32 s8, s10, 1179648
    buffer_load_dwordx4 v13, s[44:47], s8 offen lds
    s_nop 1
    v_mfma_f32_16x16x32_bf16 v[20:23], v[34:37], v[168:171], v[20:23]
    v_mfma_f32_16x16x32_bf16 v[28:31], v[168:171], v[168:171], v[28:31]
    v_mfma_f32_16x16x32_bf16 v[24:27], v[34:37], v[172:175], v[24:27]
    v_mfma_f32_16x16x32_bf16 v[6:9], v[172:175], v[172:175], v[6:9]
    s_waitcnt lgkmcnt(0)
    v_mfma_f32_16x16x32_bf16 v[96:99], v[80:83], v[168:171], v[96:99]
    ds_read_b64_tr_b16 v[64:65], v16 offset:12288
    v_mfma_f32_16x16x32_bf16 v[100:103], v[80:83], v[172:175], v[100:103]
    ds_read_b64_tr_b16 v[66:67], v16 offset:12544
    v_mfma_f32_16x16x32_bf16 v[40:43], v[80:83], v[34:37], v[40:43]
    ds_read_b64_tr_b16 v[68:69], v17 offset:12288
    v_mfma_f32_16x16x32_bf16 v[104:107], v[84:87], v[168:171], v[104:107]
    ds_read_b64_tr_b16 v[70:71], v17 offset:12544
    v_mfma_f32_16x16x32_bf16 v[108:111], v[84:87], v[172:175], v[108:111]
    ds_read_b64_tr_b16 v[72:73], v16 offset:45056
    v_mfma_f32_16x16x32_bf16 v[44:47], v[84:87], v[34:37], v[44:47]
    ds_read_b64_tr_b16 v[74:75], v16 offset:45312
    ds_read_b64_tr_b16 v[76:77], v17 offset:45056
    v_mfma_f32_16x16x32_bf16 v[112:115], v[168:171], v[88:91], v[112:115]
    ds_read_b64_tr_b16 v[78:79], v17 offset:45312
    v_mfma_f32_16x16x32_bf16 v[116:119], v[172:175], v[88:91], v[116:119]
    buffer_load_dwordx4 v[228:231], v11, s[40:43], 0 offen offset:768
    v_mfma_f32_16x16x32_bf16 v[48:51], v[34:37], v[88:91], v[48:51]
    buffer_load_dwordx4 v[236:239], v11, s[40:43], 0 offen offset:1792
    v_mfma_f32_16x16x32_bf16 v[120:123], v[168:171], v[92:95], v[120:123]
    buffer_load_dwordx4 v[244:247], v11, s[40:43], 0 offen offset:2816
    v_mfma_f32_16x16x32_bf16 v[124:127], v[172:175], v[92:95], v[124:127]
    buffer_load_dwordx4 v[252:255], v11, s[40:43], 0 offen offset:3840
    v_mfma_f32_16x16x32_bf16 v[52:55], v[34:37], v[92:95], v[52:55]
    s_add_u32 m0, s9, 28672
    s_add_u32 s8, s10, 1228800
    buffer_load_dwordx4 v12, s[44:47], s8 offen lds
    s_add_u32 m0, s9, 61440
    s_add_u32 s8, s10, 1228800
    buffer_load_dwordx4 v13, s[44:47], s8 offen lds
    s_nop 1
    v_mfma_f32_16x16x32_bf16 v[20:23], v[34:37], v[176:179], v[20:23]
    v_mfma_f32_16x16x32_bf16 v[28:31], v[176:179], v[176:179], v[28:31]
    v_mfma_f32_16x16x32_bf16 v[24:27], v[34:37], v[180:183], v[24:27]
    v_mfma_f32_16x16x32_bf16 v[6:9], v[180:183], v[180:183], v[6:9]
    s_waitcnt lgkmcnt(0)
    v_mfma_f32_16x16x32_bf16 v[96:99], v[64:67], v[176:179], v[96:99]
    ds_read_b64_tr_b16 v[80:81], v16 offset:14336
    ds_read_b64_tr_b16 v[82:83], v16 offset:14592
    ds_read_b64_tr_b16 v[84:85], v17 offset:14336
    ds_read_b64_tr_b16 v[86:87], v17 offset:14592
    v_mfma_f32_16x16x32_bf16 v[100:103], v[64:67], v[180:183], v[100:103]
    ds_read_b64_tr_b16 v[88:89], v16 offset:47104
    ds_read_b64_tr_b16 v[90:91], v16 offset:47360
    ds_read_b64_tr_b16 v[92:93], v17 offset:47104
    ds_read_b64_tr_b16 v[94:95], v17 offset:47360
    v_mfma_f32_16x16x32_bf16 v[40:43], v[64:67], v[34:37], v[40:43]
    s_waitcnt vmcnt(20)
    s_mov_b64 vcc, s[68:69]
    v_cndmask_b32_dpp v56, v200, v192, vcc quad_perm:[1,0,3,2] row_mask:0xf bank_mask:0xf
    v_cndmask_b32_dpp v57, v201, v193, vcc quad_perm:[1,0,3,2] row_mask:0xf bank_mask:0xf
    v_mfma_f32_16x16x32_bf16 v[104:107], v[68:71], v[176:179], v[104:107]
    v_cndmask_b32_dpp v60, v216, v208, vcc quad_perm:[1,0,3,2] row_mask:0xf bank_mask:0xf
    v_cndmask_b32_dpp v61, v217, v209, vcc quad_perm:[1,0,3,2] row_mask:0xf bank_mask:0xf
    s_mov_b64 vcc, s[70:71]
    v_cndmask_b32_dpp v58, v192, v200, vcc quad_perm:[1,0,3,2] row_mask:0xf bank_mask:0xf
    v_mfma_f32_16x16x32_bf16 v[108:111], v[68:71], v[180:183], v[108:111]
    v_cndmask_b32_dpp v59, v193, v201, vcc quad_perm:[1,0,3,2] row_mask:0xf bank_mask:0xf
    v_cndmask_b32_dpp v62, v208, v216, vcc quad_perm:[1,0,3,2] row_mask:0xf bank_mask:0xf
    v_cndmask_b32_dpp v63, v209, v217, vcc quad_perm:[1,0,3,2] row_mask:0xf bank_mask:0xf
    s_mov_b64 vcc, s[72:73]
    v_mfma_f32_16x16x32_bf16 v[44:47], v[68:71], v[34:37], v[44:47]
    v_cndmask_b32_dpp v192, v60, v56, vcc quad_perm:[2,3,0,1] row_mask:0xf bank_mask:0xf
    v_cndmask_b32_dpp v193, v61, v57, vcc quad_perm:[2,3,0,1] row_mask:0xf bank_mask:0xf
    v_cndmask_b32_dpp v200, v62, v58, vcc quad_perm:[2,3,0,1] row_mask:0xf bank_mask:0xf
    v_cndmask_b32_dpp v201, v63, v59, vcc quad_perm:[2,3,0,1] row_mask:0xf bank_mask:0xf
    v_mfma_f32_16x16x32_bf16 v[112:115], v[176:179], v[72:75], v[112:115]
    s_mov_b64 vcc, s[74:75]
    v_cndmask_b32_dpp v208, v56, v60, vcc quad_perm:[2,3,0,1] row_mask:0xf bank_mask:0xf
    v_cndmask_b32_dpp v209, v57, v61, vcc quad_perm:[2,3,0,1] row_mask:0xf bank_mask:0xf
    v_cndmask_b32_dpp v216, v58, v62, vcc quad_perm:[2,3,0,1] row_mask:0xf bank_mask:0xf
    v_mfma_f32_16x16x32_bf16 v[116:119], v[180:183], v[72:75], v[116:119]
    v_cndmask_b32_dpp v217, v59, v63, vcc quad_perm:[2,3,0,1] row_mask:0xf bank_mask:0xf
    s_mov_b64 vcc, s[68:69]
    v_cndmask_b32_dpp v56, v202, v194, vcc quad_perm:[1,0,3,2] row_mask:0xf bank_mask:0xf
    v_cndmask_b32_dpp v57, v203, v195, vcc quad_perm:[1,0,3,2] row_mask:0xf bank_mask:0xf
    v_mfma_f32_16x16x32_bf16 v[48:51], v[34:37], v[72:75], v[48:51]
    v_cndmask_b32_dpp v60, v218, v210, vcc quad_perm:[1,0,3,2] row_mask:0xf bank_mask:0xf
    v_cndmask_b32_dpp v61, v219, v211, vcc quad_perm:[1,0,3,2] row_mask:0xf bank_mask:0xf
    s_mov_b64 vcc, s[70:71]
    v_cndmask_b32_dpp v58, v194, v202, vcc quad_perm:[1,0,3,2] row_mask:0xf bank_mask:0xf
    v_mfma_f32_16x16x32_bf16 v[120:123], v[176:179], v[76:79], v[120:123]
    v_cndmask_b32_dpp v59, v195, v203, vcc quad_perm:[1,0,3,2] row_mask:0xf bank_mask:0xf
    v_cndmask_b32_dpp v62, v210, v218, vcc quad_perm:[1,0,3,2] row_mask:0xf bank_mask:0xf
    v_cndmask_b32_dpp v63, v211, v219, vcc quad_perm:[1,0,3,2] row_mask:0xf bank_mask:0xf
    s_mov_b64 vcc, s[72:73]
    v_mfma_f32_16x16x32_bf16 v[124:127], v[180:183], v[76:79], v[124:127]
    v_cndmask_b32_dpp v194, v60, v56, vcc quad_perm:[2,3,0,1] row_mask:0xf bank_mask:0xf
    v_cndmask_b32_dpp v195, v61, v57, vcc quad_perm:[2,3,0,1] row_mask:0xf bank_mask:0xf
    v_cndmask_b32_dpp v202, v62, v58, vcc quad_perm:[2,3,0,1] row_mask:0xf bank_mask:0xf
    v_cndmask_b32_dpp v203, v63, v59, vcc quad_perm:[2,3,0,1] row_mask:0xf bank_mask:0xf
    v_mfma_f32_16x16x32_bf16 v[52:55], v[34:37], v[76:79], v[52:55]
    s_mov_b64 vcc, s[74:75]
    v_cndmask_b32_dpp v210, v56, v60, vcc quad_perm:[2,3,0,1] row_mask:0xf bank_mask:0xf
    v_cndmask_b32_dpp v211, v57, v61, vcc quad_perm:[2,3,0,1] row_mask:0xf bank_mask:0xf
    v_cndmask_b32_dpp v218, v58, v62, vcc quad_perm:[2,3,0,1] row_mask:0xf bank_mask:0xf
    v_cndmask_b32_dpp v219, v59, v63, vcc quad_perm:[2,3,0,1] row_mask:0xf bank_mask:0xf
    s_nop 1
    v_mfma_f32_16x16x32_bf16 v[20:23], v[34:37], v[184:187], v[20:23]
    v_mfma_f32_16x16x32_bf16 v[28:31], v[184:187], v[184:187], v[28:31]
    v_mfma_f32_16x16x32_bf16 v[24:27], v[34:37], v[188:191], v[24:27]
    v_mfma_f32_16x16x32_bf16 v[6:9], v[188:191], v[188:191], v[6:9]
    s_waitcnt lgkmcnt(0)
    v_mfma_f32_16x16x32_bf16 v[96:99], v[80:83], v[184:187], v[96:99]
    s_waitcnt vmcnt(14)
    s_mov_b64 vcc, s[68:69]
    v_cndmask_b32_dpp v56, v204, v196, vcc quad_perm:[1,0,3,2] row_mask:0xf bank_mask:0xf
    v_cndmask_b32_dpp v57, v205, v197, vcc quad_perm:[1,0,3,2] row_mask:0xf bank_mask:0xf
    v_mfma_f32_16x16x32_bf16 v[100:103], v[80:83], v[188:191], v[100:103]
    v_cndmask_b32_dpp v60, v220, v212, vcc quad_perm:[1,0,3,2] row_mask:0xf bank_mask:0xf
    v_cndmask_b32_dpp v61, v221, v213, vcc quad_perm:[1,0,3,2] row_mask:0xf bank_mask:0xf
    s_mov_b64 vcc, s[70:71]
    v_cndmask_b32_dpp v58, v196, v204, vcc quad_perm:[1,0,3,2] row_mask:0xf bank_mask:0xf
    v_mfma_f32_16x16x32_bf16 v[40:43], v[80:83], v[34:37], v[40:43]
    v_cndmask_b32_dpp v59, v197, v205, vcc quad_perm:[1,0,3,2] row_mask:0xf bank_mask:0xf
    v_cndmask_b32_dpp v62, v212, v220, vcc quad_perm:[1,0,3,2] row_mask:0xf bank_mask:0xf
    v_cndmask_b32_dpp v63, v213, v221, vcc quad_perm:[1,0,3,2] row_mask:0xf bank_mask:0xf
    s_mov_b64 vcc, s[72:73]
    v_mfma_f32_16x16x32_bf16 v[104:107], v[84:87], v[184:187], v[104:107]
    v_cndmask_b32_dpp v196, v60, v56, vcc quad_perm:[2,3,0,1] row_mask:0xf bank_mask:0xf
    v_cndmask_b32_dpp v197, v61, v57, vcc quad_perm:[2,3,0,1] row_mask:0xf bank_mask:0xf
    v_cndmask_b32_dpp v204, v62, v58, vcc quad_perm:[2,3,0,1] row_mask:0xf bank_mask:0xf
    v_cndmask_b32_dpp v205, v63, v59, vcc quad_perm:[2,3,0,1] row_mask:0xf bank_mask:0xf
    s_mov_b64 vcc, s[74:75]
    v_mfma_f32_16x16x32_bf16 v[108:111], v[84:87], v[188:191], v[108:111]
    v_cndmask_b32_dpp v212, v56, v60, vcc quad_perm:[2,3,0,1] row_mask:0xf bank_mask:0xf
    v_cndmask_b32_dpp v213, v57, v61, vcc quad_perm:[2,3,0,1] row_mask:0xf bank_mask:0xf
    v_cndmask_b32_dpp v220, v58, v62, vcc quad_perm:[2,3,0,1] row_mask:0xf bank_mask:0xf
    v_cndmask_b32_dpp v221, v59, v63, vcc quad_perm:[2,3,0,1] row_mask:0xf bank_mask:0xf
    v_mfma_f32_16x16x32_bf16 v[44:47], v[84:87], v[34:37], v[44:47]
    s_mov_b64 vcc, s[68:69]
    v_cndmask_b32_dpp v56, v206, v198, vcc quad_perm:[1,0,3,2] row_mask:0xf bank_mask:0xf
    v_cndmask_b32_dpp v57, v207, v199, vcc quad_perm:[1,0,3,2] row_mask:0xf bank_mask:0xf
    v_cndmask_b32_dpp v60, v222, v214, vcc quad_perm:[1,0,3,2] row_mask:0xf bank_mask:0xf
    v_mfma_f32_16x16x32_bf16 v[112:115], v[184:187], v[88:91], v[112:115]
    v_cndmask_b32_dpp v61, v223, v215, vcc quad_perm:[1,0,3,2] row_mask:0xf bank_mask:0xf
    s_mov_b64 vcc, s[70:71]
    v_cndmask_b32_dpp v58, v198, v206, vcc quad_perm:[1,0,3,2] row_mask:0xf bank_mask:0xf
    v_cndmask_b32_dpp v59, v199, v207, vcc quad_perm:[1,0,3,2] row_mask:0xf bank_mask:0xf
    v_mfma_f32_16x16x32_bf16 v[116:119], v[188:191], v[88:91], v[116:119]
    v_cndmask_b32_dpp v62, v214, v222, vcc quad_perm:[1,0,3,2] row_mask:0xf bank_mask:0xf
    v_cndmask_b32_dpp v63, v215, v223, vcc quad_perm:[1,0,3,2] row_mask:0xf bank_mask:0xf
    s_mov_b64 vcc, s[72:73]
    v_cndmask_b32_dpp v198, v60, v56, vcc quad_perm:[2,3,0,1] row_mask:0xf bank_mask:0xf
    v_cndmask_b32_dpp v199, v61, v57, vcc quad_perm:[2,3,0,1] row_mask:0xf bank_mask:0xf
    v_mfma_f32_16x16x32_bf16 v[48:51], v[34:37], v[88:91], v[48:51]
    v_cndmask_b32_dpp v206, v62, v58, vcc quad_perm:[2,3,0,1] row_mask:0xf bank_mask:0xf
    v_cndmask_b32_dpp v207, v63, v59, vcc quad_perm:[2,3,0,1] row_mask:0xf bank_mask:0xf
    s_mov_b64 vcc, s[74:75]
    v_cndmask_b32_dpp v214, v56, v60, vcc quad_perm:[2,3,0,1] row_mask:0xf bank_mask:0xf
    v_mfma_f32_16x16x32_bf16 v[120:123], v[184:187], v[92:95], v[120:123]
    v_cndmask_b32_dpp v215, v57, v61, vcc quad_perm:[2,3,0,1] row_mask:0xf bank_mask:0xf
    v_cndmask_b32_dpp v222, v58, v62, vcc quad_perm:[2,3,0,1] row_mask:0xf bank_mask:0xf
    v_cndmask_b32_dpp v223, v59, v63, vcc quad_perm:[2,3,0,1] row_mask:0xf bank_mask:0xf
    s_waitcnt vmcnt(12)
    v_mfma_f32_16x16x32_bf16 v[124:127], v[188:191], v[92:95], v[124:127]
    s_barrier
    ds_read_b64_tr_b16 v[64:65], v16 offset:16384
    ds_read_b64_tr_b16 v[66:67], v16 offset:16640
    ds_read_b64_tr_b16 v[68:69], v17 offset:16384
    v_mfma_f32_16x16x32_bf16 v[52:55], v[34:37], v[92:95], v[52:55]
    ds_read_b64_tr_b16 v[70:71], v17 offset:16640
    ds_read_b64_tr_b16 v[72:73], v16 offset:49152
    ds_read_b64_tr_b16 v[74:75], v16 offset:49408
    ds_read_b64_tr_b16 v[76:77], v17 offset:49152
    ds_read_b64_tr_b16 v[78:79], v17 offset:49408
    s_nop 1
    v_mfma_f32_16x16x32_bf16 v[20:23], v[34:37], v[192:195], v[20:23]
    v_mfma_f32_16x16x32_bf16 v[28:31], v[192:195], v[192:195], v[28:31]
    v_mfma_f32_16x16x32_bf16 v[24:27], v[34:37], v[196:199], v[24:27]
    v_mfma_f32_16x16x32_bf16 v[6:9], v[196:199], v[196:199], v[6:9]
    s_waitcnt lgkmcnt(0)
    v_mfma_f32_16x16x32_bf16 v[96:99], v[64:67], v[192:195], v[96:99]
    v_mfma_f32_16x16x32_bf16 v[100:103], v[64:67], v[196:199], v[100:103]
    ds_read_b64_tr_b16 v[80:81], v16 offset:18432
    v_mfma_f32_16x16x32_bf16 v[40:43], v[64:67], v[34:37], v[40:43]
    ds_read_b64_tr_b16 v[82:83], v16 offset:18688
    v_mfma_f32_16x16x32_bf16 v[104:107], v[68:71], v[192:195], v[104:107]
    ds_read_b64_tr_b16 v[84:85], v17 offset:18432
    v_mfma_f32_16x16x32_bf16 v[108:111], v[68:71], v[196:199], v[108:111]
    ds_read_b64_tr_b16 v[86:87], v17 offset:18688
    v_mfma_f32_16x16x32_bf16 v[44:47], v[68:71], v[34:37], v[44:47]
    ds_read_b64_tr_b16 v[88:89], v16 offset:51200
    v_mfma_f32_16x16x32_bf16 v[112:115], v[192:195], v[72:75], v[112:115]
    v_mfma_f32_16x16x32_bf16 v[116:119], v[196:199], v[72:75], v[116:119]
    ds_read_b64_tr_b16 v[90:91], v16 offset:51456
    v_mfma_f32_16x16x32_bf16 v[48:51], v[34:37], v[72:75], v[48:51]
    ds_read_b64_tr_b16 v[92:93], v17 offset:51200
    v_mfma_f32_16x16x32_bf16 v[120:123], v[192:195], v[76:79], v[120:123]
    ds_read_b64_tr_b16 v[94:95], v17 offset:51456
    v_mfma_f32_16x16x32_bf16 v[124:127], v[196:199], v[76:79], v[124:127]
    s_add_u32 m0, s9, 65536
    s_add_u32 s8, s10, 0
    buffer_load_dwordx4 v14, s[44:47], s8 offen lds
    v_mfma_f32_16x16x32_bf16 v[52:55], v[34:37], v[76:79], v[52:55]
    s_add_u32 m0, s9, 69632
    s_add_u32 s8, s10, 49152
    buffer_load_dwordx4 v14, s[44:47], s8 offen lds
    s_nop 1
    v_mfma_f32_16x16x32_bf16 v[20:23], v[34:37], v[200:203], v[20:23]
    v_mfma_f32_16x16x32_bf16 v[28:31], v[200:203], v[200:203], v[28:31]
    v_mfma_f32_16x16x32_bf16 v[24:27], v[34:37], v[204:207], v[24:27]
    v_mfma_f32_16x16x32_bf16 v[6:9], v[204:207], v[204:207], v[6:9]
    s_waitcnt lgkmcnt(0)
    v_mfma_f32_16x16x32_bf16 v[96:99], v[80:83], v[200:203], v[96:99]
    v_mfma_f32_16x16x32_bf16 v[100:103], v[80:83], v[204:207], v[100:103]
    ds_read_b64_tr_b16 v[64:65], v16 offset:20480
    v_mfma_f32_16x16x32_bf16 v[40:43], v[80:83], v[34:37], v[40:43]
    ds_read_b64_tr_b16 v[66:67], v16 offset:20736
    v_mfma_f32_16x16x32_bf16 v[104:107], v[84:87], v[200:203], v[104:107]
    ds_read_b64_tr_b16 v[68:69], v17 offset:20480
    v_mfma_f32_16x16x32_bf16 v[108:111], v[84:87], v[204:207], v[108:111]
    ds_read_b64_tr_b16 v[70:71], v17 offset:20736
    v_mfma_f32_16x16x32_bf16 v[44:47], v[84:87], v[34:37], v[44:47]
    ds_read_b64_tr_b16 v[72:73], v16 offset:53248
    v_mfma_f32_16x16x32_bf16 v[112:115], v[200:203], v[88:91], v[112:115]
    v_mfma_f32_16x16x32_bf16 v[116:119], v[204:207], v[88:91], v[116:119]
    ds_read_b64_tr_b16 v[74:75], v16 offset:53504
    v_mfma_f32_16x16x32_bf16 v[48:51], v[34:37], v[88:91], v[48:51]
    ds_read_b64_tr_b16 v[76:77], v17 offset:53248
    v_mfma_f32_16x16x32_bf16 v[120:123], v[200:203], v[92:95], v[120:123]
    ds_read_b64_tr_b16 v[78:79], v17 offset:53504
    v_mfma_f32_16x16x32_bf16 v[124:127], v[204:207], v[92:95], v[124:127]
    s_add_u32 m0, s9, 73728
    s_add_u32 s8, s10, 393216
    buffer_load_dwordx4 v14, s[44:47], s8 offen lds
    v_mfma_f32_16x16x32_bf16 v[52:55], v[34:37], v[92:95], v[52:55]
    s_add_u32 m0, s9, 77824
    s_add_u32 s8, s10, 442368
    buffer_load_dwordx4 v14, s[44:47], s8 offen lds
    s_nop 1
    v_mfma_f32_16x16x32_bf16 v[20:23], v[34:37], v[208:211], v[20:23]
    v_mfma_f32_16x16x32_bf16 v[28:31], v[208:211], v[208:211], v[28:31]
    v_mfma_f32_16x16x32_bf16 v[24:27], v[34:37], v[212:215], v[24:27]
    v_mfma_f32_16x16x32_bf16 v[6:9], v[212:215], v[212:215], v[6:9]
    s_waitcnt lgkmcnt(0)
    v_mfma_f32_16x16x32_bf16 v[96:99], v[64:67], v[208:211], v[96:99]
    ds_read_b64_tr_b16 v[80:81], v16 offset:22528
    ds_read_b64_tr_b16 v[82:83], v16 offset:22784
    ds_read_b64_tr_b16 v[84:85], v17 offset:22528
    ds_read_b64_tr_b16 v[86:87], v17 offset:22784
    v_mfma_f32_16x16x32_bf16 v[100:103], v[64:67], v[212:215], v[100:103]
    ds_read_b64_tr_b16 v[88:89], v16 offset:55296
    ds_read_b64_tr_b16 v[90:91], v16 offset:55552
    ds_read_b64_tr_b16 v[92:93], v17 offset:55296
    ds_read_b64_tr_b16 v[94:95], v17 offset:55552
    v_mfma_f32_16x16x32_bf16 v[40:43], v[64:67], v[34:37], v[40:43]
    s_waitcnt vmcnt(12)
    s_mov_b64 vcc, s[68:69]
    v_cndmask_b32_dpp v56, v232, v224, vcc quad_perm:[1,0,3,2] row_mask:0xf bank_mask:0xf
    v_cndmask_b32_dpp v57, v233, v225, vcc quad_perm:[1,0,3,2] row_mask:0xf bank_mask:0xf
    v_mfma_f32_16x16x32_bf16 v[104:107], v[68:71], v[208:211], v[104:107]
    v_cndmask_b32_dpp v60, v248, v240, vcc quad_perm:[1,0,3,2] row_mask:0xf bank_mask:0xf
    v_cndmask_b32_dpp v61, v249, v241, vcc quad_perm:[1,0,3,2] row_mask:0xf bank_mask:0xf
    s_mov_b64 vcc, s[70:71]
    v_cndmask_b32_dpp v58, v224, v232, vcc quad_perm:[1,0,3,2] row_mask:0xf bank_mask:0xf
    v_mfma_f32_16x16x32_bf16 v[108:111], v[68:71], v[212:215], v[108:111]
    v_cndmask_b32_dpp v59, v225, v233, vcc quad_perm:[1,0,3,2] row_mask:0xf bank_mask:0xf
    v_cndmask_b32_dpp v62, v240, v248, vcc quad_perm:[1,0,3,2] row_mask:0xf bank_mask:0xf
    v_cndmask_b32_dpp v63, v241, v249, vcc quad_perm:[1,0,3,2] row_mask:0xf bank_mask:0xf
    s_mov_b64 vcc, s[72:73]
    v_mfma_f32_16x16x32_bf16 v[44:47], v[68:71], v[34:37], v[44:47]
    v_cndmask_b32_dpp v224, v60, v56, vcc quad_perm:[2,3,0,1] row_mask:0xf bank_mask:0xf
    v_cndmask_b32_dpp v225, v61, v57, vcc quad_perm:[2,3,0,1] row_mask:0xf bank_mask:0xf
    v_cndmask_b32_dpp v232, v62, v58, vcc quad_perm:[2,3,0,1] row_mask:0xf bank_mask:0xf
    v_cndmask_b32_dpp v233, v63, v59, vcc quad_perm:[2,3,0,1] row_mask:0xf bank_mask:0xf
    v_mfma_f32_16x16x32_bf16 v[112:115], v[208:211], v[72:75], v[112:115]
    s_mov_b64 vcc, s[74:75]
    v_cndmask_b32_dpp v240, v56, v60, vcc quad_perm:[2,3,0,1] row_mask:0xf bank_mask:0xf
    v_cndmask_b32_dpp v241, v57, v61, vcc quad_perm:[2,3,0,1] row_mask:0xf bank_mask:0xf
    v_cndmask_b32_dpp v248, v58, v62, vcc quad_perm:[2,3,0,1] row_mask:0xf bank_mask:0xf
    v_mfma_f32_16x16x32_bf16 v[116:119], v[212:215], v[72:75], v[116:119]
    v_cndmask_b32_dpp v249, v59, v63, vcc quad_perm:[2,3,0,1] row_mask:0xf bank_mask:0xf
    s_mov_b64 vcc, s[68:69]
    v_cndmask_b32_dpp v56, v234, v226, vcc quad_perm:[1,0,3,2] row_mask:0xf bank_mask:0xf
    v_cndmask_b32_dpp v57, v235, v227, vcc quad_perm:[1,0,3,2] row_mask:0xf bank_mask:0xf
    v_mfma_f32_16x16x32_bf16 v[48:51], v[34:37], v[72:75], v[48:51]
    v_cndmask_b32_dpp v60, v250, v242, vcc quad_perm:[1,0,3,2] row_mask:0xf bank_mask:0xf
    v_cndmask_b32_dpp v61, v251, v243, vcc quad_perm:[1,0,3,2] row_mask:0xf bank_mask:0xf
    s_mov_b64 vcc, s[70:71]
    v_cndmask_b32_dpp v58, v226, v234, vcc quad_perm:[1,0,3,2] row_mask:0xf bank_mask:0xf
    v_mfma_f32_16x16x32_bf16 v[120:123], v[208:211], v[76:79], v[120:123]
    v_cndmask_b32_dpp v59, v227, v235, vcc quad_perm:[1,0,3,2] row_mask:0xf bank_mask:0xf
    v_cndmask_b32_dpp v62, v242, v250, vcc quad_perm:[1,0,3,2] row_mask:0xf bank_mask:0xf
    v_cndmask_b32_dpp v63, v243, v251, vcc quad_perm:[1,0,3,2] row_mask:0xf bank_mask:0xf
    s_mov_b64 vcc, s[72:73]
    v_mfma_f32_16x16x32_bf16 v[124:127], v[212:215], v[76:79], v[124:127]
    v_cndmask_b32_dpp v226, v60, v56, vcc quad_perm:[2,3,0,1] row_mask:0xf bank_mask:0xf
    v_cndmask_b32_dpp v227, v61, v57, vcc quad_perm:[2,3,0,1] row_mask:0xf bank_mask:0xf
    v_cndmask_b32_dpp v234, v62, v58, vcc quad_perm:[2,3,0,1] row_mask:0xf bank_mask:0xf
    v_cndmask_b32_dpp v235, v63, v59, vcc quad_perm:[2,3,0,1] row_mask:0xf bank_mask:0xf
    v_mfma_f32_16x16x32_bf16 v[52:55], v[34:37], v[76:79], v[52:55]
    s_mov_b64 vcc, s[74:75]
    v_cndmask_b32_dpp v242, v56, v60, vcc quad_perm:[2,3,0,1] row_mask:0xf bank_mask:0xf
    v_cndmask_b32_dpp v243, v57, v61, vcc quad_perm:[2,3,0,1] row_mask:0xf bank_mask:0xf
    v_cndmask_b32_dpp v250, v58, v62, vcc quad_perm:[2,3,0,1] row_mask:0xf bank_mask:0xf
    v_cndmask_b32_dpp v251, v59, v63, vcc quad_perm:[2,3,0,1] row_mask:0xf bank_mask:0xf
    s_nop 1
    v_mfma_f32_16x16x32_bf16 v[20:23], v[34:37], v[216:219], v[20:23]
    v_mfma_f32_16x16x32_bf16 v[28:31], v[216:219], v[216:219], v[28:31]
    v_mfma_f32_16x16x32_bf16 v[24:27], v[34:37], v[220:223], v[24:27]
    v_mfma_f32_16x16x32_bf16 v[6:9], v[220:223], v[220:223], v[6:9]
    s_waitcnt lgkmcnt(0)
    v_mfma_f32_16x16x32_bf16 v[96:99], v[80:83], v[216:219], v[96:99]
    s_waitcnt vmcnt(6)
    s_mov_b64 vcc, s[68:69]
    v_cndmask_b32_dpp v56, v236, v228, vcc quad_perm:[1,0,3,2] row_mask:0xf bank_mask:0xf
    v_cndmask_b32_dpp v57, v237, v229, vcc quad_perm:[1,0,3,2] row_mask:0xf bank_mask:0xf
    v_mfma_f32_16x16x32_bf16 v[100:103], v[80:83], v[220:223], v[100:103]
    v_cndmask_b32_dpp v60, v252, v244, vcc quad_perm:[1,0,3,2] row_mask:0xf bank_mask:0xf
    v_cndmask_b32_dpp v61, v253, v245, vcc quad_perm:[1,0,3,2] row_mask:0xf bank_mask:0xf
    s_mov_b64 vcc, s[70:71]
    v_cndmask_b32_dpp v58, v228, v236, vcc quad_perm:[1,0,3,2] row_mask:0xf bank_mask:0xf
    v_mfma_f32_16x16x32_bf16 v[40:43], v[80:83], v[34:37], v[40:43]
    v_cndmask_b32_dpp v59, v229, v237, vcc quad_perm:[1,0,3,2] row_mask:0xf bank_mask:0xf
    v_cndmask_b32_dpp v62, v244, v252, vcc quad_perm:[1,0,3,2] row_mask:0xf bank_mask:0xf
    v_cndmask_b32_dpp v63, v245, v253, vcc quad_perm:[1,0,3,2] row_mask:0xf bank_mask:0xf
    s_mov_b64 vcc, s[72:73]
    v_mfma_f32_16x16x32_bf16 v[104:107], v[84:87], v[216:219], v[104:107]
    v_cndmask_b32_dpp v228, v60, v56, vcc quad_perm:[2,3,0,1] row_mask:0xf bank_mask:0xf
    v_cndmask_b32_dpp v229, v61, v57, vcc quad_perm:[2,3,0,1] row_mask:0xf bank_mask:0xf
    v_cndmask_b32_dpp v236, v62, v58, vcc quad_perm:[2,3,0,1] row_mask:0xf bank_mask:0xf
    v_cndmask_b32_dpp v237, v63, v59, vcc quad_perm:[2,3,0,1] row_mask:0xf bank_mask:0xf
    s_mov_b64 vcc, s[74:75]
    v_mfma_f32_16x16x32_bf16 v[108:111], v[84:87], v[220:223], v[108:111]
    v_cndmask_b32_dpp v244, v56, v60, vcc quad_perm:[2,3,0,1] row_mask:0xf bank_mask:0xf
    v_cndmask_b32_dpp v245, v57, v61, vcc quad_perm:[2,3,0,1] row_mask:0xf bank_mask:0xf
    v_cndmask_b32_dpp v252, v58, v62, vcc quad_perm:[2,3,0,1] row_mask:0xf bank_mask:0xf
    v_cndmask_b32_dpp v253, v59, v63, vcc quad_perm:[2,3,0,1] row_mask:0xf bank_mask:0xf
    v_mfma_f32_16x16x32_bf16 v[44:47], v[84:87], v[34:37], v[44:47]
    s_mov_b64 vcc, s[68:69]
    v_cndmask_b32_dpp v56, v238, v230, vcc quad_perm:[1,0,3,2] row_mask:0xf bank_mask:0xf
    v_cndmask_b32_dpp v57, v239, v231, vcc quad_perm:[1,0,3,2] row_mask:0xf bank_mask:0xf
    v_cndmask_b32_dpp v60, v254, v246, vcc quad_perm:[1,0,3,2] row_mask:0xf bank_mask:0xf
    v_mfma_f32_16x16x32_bf16 v[112:115], v[216:219], v[88:91], v[112:115]
    v_cndmask_b32_dpp v61, v255, v247, vcc quad_perm:[1,0,3,2] row_mask:0xf bank_mask:0xf
    s_mov_b64 vcc, s[70:71]
    v_cndmask_b32_dpp v58, v230, v238, vcc quad_perm:[1,0,3,2] row_mask:0xf bank_mask:0xf
    v_cndmask_b32_dpp v59, v231, v239, vcc quad_perm:[1,0,3,2] row_mask:0xf bank_mask:0xf
    v_mfma_f32_16x16x32_bf16 v[116:119], v[220:223], v[88:91], v[116:119]
    v_cndmask_b32_dpp v62, v246, v254, vcc quad_perm:[1,0,3,2] row_mask:0xf bank_mask:0xf
    v_cndmask_b32_dpp v63, v247, v255, vcc quad_perm:[1,0,3,2] row_mask:0xf bank_mask:0xf
    s_mov_b64 vcc, s[72:73]
    v_cndmask_b32_dpp v230, v60, v56, vcc quad_perm:[2,3,0,1] row_mask:0xf bank_mask:0xf
    v_cndmask_b32_dpp v231, v61, v57, vcc quad_perm:[2,3,0,1] row_mask:0xf bank_mask:0xf
    v_mfma_f32_16x16x32_bf16 v[48:51], v[34:37], v[88:91], v[48:51]
    v_cndmask_b32_dpp v238, v62, v58, vcc quad_perm:[2,3,0,1] row_mask:0xf bank_mask:0xf
    v_cndmask_b32_dpp v239, v63, v59, vcc quad_perm:[2,3,0,1] row_mask:0xf bank_mask:0xf
    s_mov_b64 vcc, s[74:75]
    v_cndmask_b32_dpp v246, v56, v60, vcc quad_perm:[2,3,0,1] row_mask:0xf bank_mask:0xf
    v_mfma_f32_16x16x32_bf16 v[120:123], v[216:219], v[92:95], v[120:123]
    v_cndmask_b32_dpp v247, v57, v61, vcc quad_perm:[2,3,0,1] row_mask:0xf bank_mask:0xf
    v_cndmask_b32_dpp v254, v58, v62, vcc quad_perm:[2,3,0,1] row_mask:0xf bank_mask:0xf
    v_cndmask_b32_dpp v255, v59, v63, vcc quad_perm:[2,3,0,1] row_mask:0xf bank_mask:0xf
    s_waitcnt vmcnt(4)
    v_mfma_f32_16x16x32_bf16 v[124:127], v[220:223], v[92:95], v[124:127]
    s_barrier
    ds_read_b64_tr_b16 v[64:65], v16 offset:24576
    ds_read_b64_tr_b16 v[66:67], v16 offset:24832
    ds_read_b64_tr_b16 v[68:69], v17 offset:24576
    v_mfma_f32_16x16x32_bf16 v[52:55], v[34:37], v[92:95], v[52:55]
    ds_read_b64_tr_b16 v[70:71], v17 offset:24832
    ds_read_b64_tr_b16 v[72:73], v16 offset:57344
    ds_read_b64_tr_b16 v[74:75], v16 offset:57600
    ds_read_b64_tr_b16 v[76:77], v17 offset:57344
    ds_read_b64_tr_b16 v[78:79], v17 offset:57600
    s_nop 1
    v_mfma_f32_16x16x32_bf16 v[20:23], v[34:37], v[224:227], v[20:23]
    v_mfma_f32_16x16x32_bf16 v[28:31], v[224:227], v[224:227], v[28:31]
    v_mfma_f32_16x16x32_bf16 v[24:27], v[34:37], v[228:231], v[24:27]
    v_mfma_f32_16x16x32_bf16 v[6:9], v[228:231], v[228:231], v[6:9]
    s_waitcnt lgkmcnt(0)
    v_mfma_f32_16x16x32_bf16 v[96:99], v[64:67], v[224:227], v[96:99]
    ds_read_b64_tr_b16 v[80:81], v16 offset:26624
    v_mfma_f32_16x16x32_bf16 v[100:103], v[64:67], v[228:231], v[100:103]
    ds_read_b64_tr_b16 v[82:83], v16 offset:26880
    v_mfma_f32_16x16x32_bf16 v[40:43], v[64:67], v[34:37], v[40:43]
    ds_read_b64_tr_b16 v[84:85], v17 offset:26624
    ds_read_b64_tr_b16 v[86:87], v17 offset:26880
    v_mfma_f32_16x16x32_bf16 v[104:107], v[68:71], v[224:227], v[104:107]
    ds_read_b64_tr_b16 v[88:89], v16 offset:59392
    v_mfma_f32_16x16x32_bf16 v[108:111], v[68:71], v[228:231], v[108:111]
    ds_read_b64_tr_b16 v[90:91], v16 offset:59648
    v_mfma_f32_16x16x32_bf16 v[44:47], v[68:71], v[34:37], v[44:47]
    ds_read_b64_tr_b16 v[92:93], v17 offset:59392
    ds_read_b64_tr_b16 v[94:95], v17 offset:59648
    v_mfma_f32_16x16x32_bf16 v[112:115], v[224:227], v[72:75], v[112:115]
    buffer_load_ushort v56, v15, s[48:51], s15 offen offset:0
    v_mfma_f32_16x16x32_bf16 v[116:119], v[228:231], v[72:75], v[116:119]
    buffer_load_ushort v57, v15, s[48:51], s15 offen offset:32
    v_mfma_f32_16x16x32_bf16 v[48:51], v[34:37], v[72:75], v[48:51]
    buffer_load_ushort v58, v15, s[48:51], s15 offen offset:64
    buffer_load_ushort v59, v15, s[48:51], s15 offen offset:96
    v_mfma_f32_16x16x32_bf16 v[120:123], v[224:227], v[76:79], v[120:123]
    buffer_load_ushort v60, v15, s[48:51], s15 offen offset:512
    v_mfma_f32_16x16x32_bf16 v[124:127], v[228:231], v[76:79], v[124:127]
    buffer_load_ushort v61, v15, s[48:51], s15 offen offset:544
    v_mfma_f32_16x16x32_bf16 v[52:55], v[34:37], v[76:79], v[52:55]
    buffer_load_ushort v62, v15, s[48:51], s15 offen offset:576
    buffer_load_ushort v63, v15, s[48:51], s15 offen offset:608
    s_nop 1
    v_mfma_f32_16x16x32_bf16 v[20:23], v[34:37], v[232:235], v[20:23]
    v_mfma_f32_16x16x32_bf16 v[28:31], v[232:235], v[232:235], v[28:31]
    v_mfma_f32_16x16x32_bf16 v[24:27], v[34:37], v[236:239], v[24:27]
    v_mfma_f32_16x16x32_bf16 v[6:9], v[236:239], v[236:239], v[6:9]
    s_waitcnt lgkmcnt(0)
    v_mfma_f32_16x16x32_bf16 v[96:99], v[80:83], v[232:235], v[96:99]
    v_mfma_f32_16x16x32_bf16 v[100:103], v[80:83], v[236:239], v[100:103]
    ds_read_b64_tr_b16 v[64:65], v16 offset:28672
    v_mfma_f32_16x16x32_bf16 v[40:43], v[80:83], v[34:37], v[40:43]
    ds_read_b64_tr_b16 v[66:67], v16 offset:28928
    v_mfma_f32_16x16x32_bf16 v[104:107], v[84:87], v[232:235], v[104:107]
    v_mfma_f32_16x16x32_bf16 v[108:111], v[84:87], v[236:239], v[108:111]
    ds_read_b64_tr_b16 v[68:69], v17 offset:28672
    v_mfma_f32_16x16x32_bf16 v[44:47], v[84:87], v[34:37], v[44:47]
    ds_read_b64_tr_b16 v[70:71], v17 offset:28928
    v_mfma_f32_16x16x32_bf16 v[112:115], v[232:235], v[88:91], v[112:115]
    v_mfma_f32_16x16x32_bf16 v[116:119], v[236:239], v[88:91], v[116:119]
    ds_read_b64_tr_b16 v[72:73], v16 offset:61440
    v_mfma_f32_16x16x32_bf16 v[48:51], v[34:37], v[88:91], v[48:51]
    ds_read_b64_tr_b16 v[74:75], v16 offset:61696
    v_mfma_f32_16x16x32_bf16 v[120:123], v[232:235], v[92:95], v[120:123]
    v_mfma_f32_16x16x32_bf16 v[124:127], v[236:239], v[92:95], v[124:127]
    ds_read_b64_tr_b16 v[76:77], v17 offset:61440
    v_mfma_f32_16x16x32_bf16 v[52:55], v[34:37], v[92:95], v[52:55]
    ds_read_b64_tr_b16 v[78:79], v17 offset:61696
    s_nop 1
    v_mfma_f32_16x16x32_bf16 v[20:23], v[34:37], v[240:243], v[20:23]
    v_mfma_f32_16x16x32_bf16 v[28:31], v[240:243], v[240:243], v[28:31]
    v_mfma_f32_16x16x32_bf16 v[24:27], v[34:37], v[244:247], v[24:27]
    v_mfma_f32_16x16x32_bf16 v[6:9], v[244:247], v[244:247], v[6:9]
    s_waitcnt lgkmcnt(0)
    v_mfma_f32_16x16x32_bf16 v[96:99], v[64:67], v[240:243], v[96:99]
    v_mfma_f32_16x16x32_bf16 v[100:103], v[64:67], v[244:247], v[100:103]
    ds_read_b64_tr_b16 v[80:81], v16 offset:30720
    v_mfma_f32_16x16x32_bf16 v[40:43], v[64:67], v[34:37], v[40:43]
    ds_read_b64_tr_b16 v[82:83], v16 offset:30976
    v_mfma_f32_16x16x32_bf16 v[104:107], v[68:71], v[240:243], v[104:107]
    v_mfma_f32_16x16x32_bf16 v[108:111], v[68:71], v[244:247], v[108:111]
    ds_read_b64_tr_b16 v[84:85], v17 offset:30720
    v_mfma_f32_16x16x32_bf16 v[44:47], v[68:71], v[34:37], v[44:47]
    ds_read_b64_tr_b16 v[86:87], v17 offset:30976
    v_mfma_f32_16x16x32_bf16 v[112:115], v[240:243], v[72:75], v[112:115]
    v_mfma_f32_16x16x32_bf16 v[116:119], v[244:247], v[72:75], v[116:119]
    ds_read_b64_tr_b16 v[88:89], v16 offset:63488
    v_mfma_f32_16x16x32_bf16 v[48:51], v[34:37], v[72:75], v[48:51]
    ds_read_b64_tr_b16 v[90:91], v16 offset:63744
    v_mfma_f32_16x16x32_bf16 v[120:123], v[240:243], v[76:79], v[120:123]
    v_mfma_f32_16x16x32_bf16 v[124:127], v[244:247], v[76:79], v[124:127]
    ds_read_b64_tr_b16 v[92:93], v17 offset:63488
    v_mfma_f32_16x16x32_bf16 v[52:55], v[34:37], v[76:79], v[52:55]
    ds_read_b64_tr_b16 v[94:95], v17 offset:63744
    s_nop 1
    v_mfma_f32_16x16x32_bf16 v[20:23], v[34:37], v[248:251], v[20:23]
    v_mfma_f32_16x16x32_bf16 v[28:31], v[248:251], v[248:251], v[28:31]
    v_mfma_f32_16x16x32_bf16 v[24:27], v[34:37], v[252:255], v[24:27]
    v_mfma_f32_16x16x32_bf16 v[6:9], v[252:255], v[252:255], v[6:9]
    s_waitcnt lgkmcnt(0)
    v_mfma_f32_16x16x32_bf16 v[96:99], v[80:83], v[248:251], v[96:99]
    v_mfma_f32_16x16x32_bf16 v[100:103], v[80:83], v[252:255], v[100:103]
    v_mfma_f32_16x16x32_bf16 v[40:43], v[80:83], v[34:37], v[40:43]
    v_mfma_f32_16x16x32_bf16 v[104:107], v[84:87], v[248:251], v[104:107]
    v_mfma_f32_16x16x32_bf16 v[108:111], v[84:87], v[252:255], v[108:111]
    v_mfma_f32_16x16x32_bf16 v[44:47], v[84:87], v[34:37], v[44:47]
    v_mfma_f32_16x16x32_bf16 v[112:115], v[248:251], v[88:91], v[112:115]
    v_mfma_f32_16x16x32_bf16 v[116:119], v[252:255], v[88:91], v[116:119]
    v_mfma_f32_16x16x32_bf16 v[48:51], v[34:37], v[88:91], v[48:51]
    v_mfma_f32_16x16x32_bf16 v[120:123], v[248:251], v[92:95], v[120:123]
    v_mfma_f32_16x16x32_bf16 v[124:127], v[252:255], v[92:95], v[124:127]
    v_mfma_f32_16x16x32_bf16 v[52:55], v[34:37], v[92:95], v[52:55]
    s_nop 1
    s_waitcnt vmcnt(0)
    s_barrier
    s_add_u32 m0, s9, 0
    s_add_u32 s8, s10, 786432
    buffer_load_dwordx4 v14, s[44:47], s8 offen lds
    s_add_u32 m0, s9, 4096
    s_add_u32 s8, s10, 835584
    buffer_load_dwordx4 v14, s[44:47], s8 offen lds
    s_add_u32 m0, s9, 8192
    s_add_u32 s8, s10, 1179648
    buffer_load_dwordx4 v14, s[44:47], s8 offen lds
    s_add_u32 m0, s9, 12288
    s_add_u32 s8, s10, 1228800
    buffer_load_dwordx4 v14, s[44:47], s8 offen lds
    v_lshlrev_b32 v5, 2, v4
    v_sub_u32 v5, v3, v5
    v_mov_b32 v21, 0
    v_mov_b32 v23, 0
    v_mul_f32 v26, 0x3b000000, v20
    v_mul_f32 v27, 0x3b000000, v24
    v_cmp_eq_u32 s[68:69], 0, v5
    v_cmp_eq_u32 s[70:71], 1, v5
    v_cmp_eq_u32 s[72:73], 2, v5
    v_cmp_eq_u32 s[74:75], 3, v5
    s_nop 0
    v_cndmask_b32 v21, v21, v28, s[68:69]
    v_cndmask_b32 v23, v23, v6, s[68:69]
    v_cndmask_b32 v21, v21, v29, s[70:71]
    v_cndmask_b32 v23, v23, v7, s[70:71]
    v_cndmask_b32 v21, v21, v30, s[72:73]
    v_cndmask_b32 v23, v23, v8, s[72:73]
    v_cndmask_b32 v21, v21, v31, s[74:75]
    v_cndmask_b32 v23, v23, v9, s[74:75]
    s_nop 1
    v_permlane32_swap_b32 v21, v23
    v_add_f32 v21, v21, v23
    v_mov_b32 v25, v21
    s_nop 1
    v_permlane16_swap_b32 v21, v25
    v_add_f32 v21, v21, v25
    v_mov_b32 v23, v21
    s_nop 1
    v_permlane32_swap_b32 v21, v23
    v_mul_f32 v21, 0x3b000000, v21
    v_mul_f32 v23, 0x3b000000, v23
    v_fma_f32 v21, -v26, v26, v21
    v_fma_f32 v23, -v27, v27, v23
    v_max_f32 v21, 0, v21
    v_max_f32 v23, 0, v23
    v_add_f32 v21, 0x3727c5ac, v21
    v_add_f32 v23, 0x3727c5ac, v23
    v_rsq_f32 v20, v21
    v_rsq_f32 v22, v23
    v_mul_f32_e64 v21, -v26, v20
    v_mul_f32_e64 v23, -v27, v22
    v_lshl_or_b32 v28, v57, 16, v56
    v_lshl_or_b32 v29, v59, 16, v58
    v_lshl_or_b32 v30, v61, 16, v60
    v_lshl_or_b32 v31, v63, 16, v62
    s_lshl_b32 s7, s3, 13
    v_lshl_add_u32 v5, v3, 2, s7
    v_lshl_add_u32 v6, v4, 4, s7
    ds_write_b32 v5, v20 offset:32768
    ds_write_b32 v5, v21 offset:32832
    ds_write_b32 v5, v22 offset:32896
    ds_write_b32 v5, v23 offset:32960
    ds_read_b128 v[64:67], v6 offset:32768
    ds_read_b128 v[68:71], v6 offset:32832
    ds_read_b128 v[72:75], v6 offset:32896
    ds_read_b128 v[76:79], v6 offset:32960
    v_mul_f32 v96, v96, v20
    v_mul_f32 v97, v97, v20
    v_mul_f32 v98, v98, v20
    v_mul_f32 v99, v99, v20
    v_fmac_f32 v96, v40, v21
    v_fmac_f32 v97, v41, v21
    v_fmac_f32 v98, v42, v21
    v_fmac_f32 v99, v43, v21
    v_mul_f32 v100, v100, v22
    v_mul_f32 v101, v101, v22
    v_mul_f32 v102, v102, v22
    v_mul_f32 v103, v103, v22
    v_fmac_f32 v100, v40, v23
    v_fmac_f32 v101, v41, v23
    v_fmac_f32 v102, v42, v23
    v_fmac_f32 v103, v43, v23
    v_mul_f32 v104, v104, v20
    v_mul_f32 v105, v105, v20
    v_mul_f32 v106, v106, v20
    v_mul_f32 v107, v107, v20
    v_fmac_f32 v104, v44, v21
    v_fmac_f32 v105, v45, v21
    v_fmac_f32 v106, v46, v21
    v_fmac_f32 v107, v47, v21
    v_mul_f32 v108, v108, v22
    v_mul_f32 v109, v109, v22
    v_mul_f32 v110, v110, v22
    v_mul_f32 v111, v111, v22
    v_fmac_f32 v108, v44, v23
    v_fmac_f32 v109, v45, v23
    v_fmac_f32 v110, v46, v23
    v_fmac_f32 v111, v47, v23
    v_mov_b32 v6, 0x3f80
    v_mov_b32 v7, 0x3f800000
    v_cndmask_b32 v56, 0, v6, s[68:69]
    v_cndmask_b32 v57, 0, v7, s[70:71]
    v_cndmask_b32 v58, 0, v6, s[72:73]
    v_cndmask_b32 v59, 0, v7, s[74:75]
    v_or_b32 v32, v56, v57
    v_or_b32 v33, v58, v59
    s_waitcnt lgkmcnt(0)
    v_mul_f32 v112, v112, v64
    v_fmac_f32 v112, v48, v68
    v_mul_f32 v113, v113, v65
    v_fmac_f32 v113, v48, v69
    v_mul_f32 v114, v114, v66
    v_fmac_f32 v114, v48, v70
    v_mul_f32 v115, v115, v67
    v_fmac_f32 v115, v48, v71
    v_mul_f32 v116, v116, v72
    v_fmac_f32 v116, v48, v76
    v_mul_f32 v117, v117, v73
    v_fmac_f32 v117, v48, v77
    v_mul_f32 v118, v118, v74
    v_fmac_f32 v118, v48, v78
    v_mul_f32 v119, v119, v75
    v_fmac_f32 v119, v48, v79
    v_mul_f32 v120, v120, v64
    v_fmac_f32 v120, v52, v68
    v_mul_f32 v121, v121, v65
    v_fmac_f32 v121, v52, v69
    v_mul_f32 v122, v122, v66
    v_fmac_f32 v122, v52, v70
    v_mul_f32 v123, v123, v67
    v_fmac_f32 v123, v52, v71
    v_mul_f32 v124, v124, v72
    v_fmac_f32 v124, v52, v76
    v_mul_f32 v125, v125, v73
    v_fmac_f32 v125, v52, v77
    v_mul_f32 v126, v126, v74
    v_fmac_f32 v126, v52, v78
    v_mul_f32 v127, v127, v75
    v_fmac_f32 v127, v52, v79
    s_nop 7
    v_cvt_pk_bf16_f32 v64, v96, v97
    v_cvt_pk_bf16_f32 v72, v100, v101
    v_cvt_pk_bf16_f32 v80, v104, v105
    v_cvt_pk_bf16_f32 v88, v108, v109
    v_cvt_pk_bf16_f32 v65, v98, v99
    v_cvt_pk_bf16_f32 v73, v102, v103
    v_cvt_pk_bf16_f32 v81, v106, v107
    v_cvt_pk_bf16_f32 v89, v110, v111
    v_mfma_f32_16x16x16_bf16 v[96:99], v[28:29], v[64:65], 0
    v_mfma_f32_16x16x16_bf16 v[100:103], v[28:29], v[72:73], 0
    v_mfma_f32_16x16x16_bf16 v[104:107], v[30:31], v[80:81], 0
    v_mfma_f32_16x16x16_bf16 v[108:111], v[30:31], v[88:89], 0
    s_nop 7
    v_max3_f32 v64, v96, v97, v98
    v_max3_f32 v72, v100, v101, v102
    v_max3_f32 v80, v104, v105, v106
    v_max3_f32 v88, v108, v109, v110
    v_max3_f32 v65, -v96, -v97, -v98
    v_max3_f32 v73, -v100, -v101, -v102
    v_max3_f32 v81, -v104, -v105, -v106
    v_max3_f32 v89, -v108, -v109, -v110
    v_max_f32 v64, v64, v99
    v_max_f32 v72, v72, v103
    v_max_f32 v80, v80, v107
    v_max_f32 v88, v88, v111
    v_max_f32_e64 v65, v65, -v99
    v_max_f32_e64 v73, v73, -v103
    v_max_f32_e64 v81, v81, -v107
    v_max_f32_e64 v89, v89, -v111
    v_permlane32_swap_b32 v64, v65
    v_permlane32_swap_b32 v72, v73
    v_permlane32_swap_b32 v80, v81
    v_permlane32_swap_b32 v88, v89
    v_max_f32 v64, v64, v65
    v_max_f32 v72, v72, v73
    v_max_f32 v80, v80, v81
    v_max_f32 v88, v88, v89
    v_mov_b32 v66, v64
    v_mov_b32 v74, v72
    v_mov_b32 v82, v80
    v_mov_b32 v90, v88
    v_permlane16_swap_b32 v64, v66
    v_permlane16_swap_b32 v72, v74
    v_permlane16_swap_b32 v80, v82
    v_permlane16_swap_b32 v88, v90
    v_max_f32 v64, v64, v66
    v_max_f32 v72, v72, v74
    v_max_f32 v80, v80, v82
    v_max_f32 v88, v88, v90
    v_mov_b32 v65, v64
    v_mov_b32 v73, v72
    v_mov_b32 v81, v80
    v_mov_b32 v89, v88
    v_permlane32_swap_b32 v64, v65
    v_permlane32_swap_b32 v72, v73
    v_permlane32_swap_b32 v80, v81
    v_permlane32_swap_b32 v88, v89
    v_mul_f32 v64, s14, v64
    v_mul_f32 v72, s14, v72
    v_mul_f32 v80, s14, v80
    v_mul_f32 v88, s14, v88
    v_mul_f32 v65, s14, v65
    v_mul_f32 v73, s14, v73
    v_mul_f32 v81, s14, v81
    v_mul_f32 v89, s14, v89
    v_fma_f32 v68, -v96, s14, -v65
    v_fma_f32 v76, -v100, s14, -v73
    v_fma_f32 v84, -v104, s14, -v81
    v_fma_f32 v92, -v108, s14, -v89
    v_fma_f32 v96, v96, s14, -v64
    v_fma_f32 v100, v100, s14, -v72
    v_fma_f32 v104, v104, s14, -v80
    v_fma_f32 v108, v108, s14, -v88
    v_fma_f32 v69, -v97, s14, -v65
    v_fma_f32 v77, -v101, s14, -v73
    v_fma_f32 v85, -v105, s14, -v81
    v_fma_f32 v93, -v109, s14, -v89
    v_fma_f32 v97, v97, s14, -v64
    v_fma_f32 v101, v101, s14, -v72
    v_fma_f32 v105, v105, s14, -v80
    v_fma_f32 v109, v109, s14, -v88
    v_fma_f32 v70, -v98, s14, -v65
    v_fma_f32 v78, -v102, s14, -v73
    v_fma_f32 v86, -v106, s14, -v81
    v_fma_f32 v94, -v110, s14, -v89
    v_fma_f32 v98, v98, s14, -v64
    v_fma_f32 v102, v102, s14, -v72
    v_fma_f32 v106, v106, s14, -v80
    v_fma_f32 v110, v110, s14, -v88
    v_fma_f32 v71, -v99, s14, -v65
    v_fma_f32 v79, -v103, s14, -v73
    v_fma_f32 v87, -v107, s14, -v81
    v_fma_f32 v95, -v111, s14, -v89
    v_fma_f32 v99, v99, s14, -v64
    v_fma_f32 v103, v103, s14, -v72
    v_fma_f32 v107, v107, s14, -v80
    v_fma_f32 v111, v111, s14, -v88
    v_exp_f32 v68, v68
    v_exp_f32 v76, v76
    v_exp_f32 v84, v84
    v_exp_f32 v92, v92
    v_exp_f32 v96, v96
    v_exp_f32 v100, v100
    v_exp_f32 v104, v104
    v_exp_f32 v108, v108
    v_exp_f32 v69, v69
    v_exp_f32 v77, v77
    v_exp_f32 v85, v85
    v_exp_f32 v93, v93
    v_exp_f32 v97, v97
    v_exp_f32 v101, v101
    v_exp_f32 v105, v105
    v_exp_f32 v109, v109
    v_exp_f32 v70, v70
    v_exp_f32 v78, v78
    v_exp_f32 v86, v86
    v_exp_f32 v94, v94
    v_exp_f32 v98, v98
    v_exp_f32 v102, v102
    v_exp_f32 v106, v106
    v_exp_f32 v110, v110
    v_exp_f32 v71, v71
    v_exp_f32 v79, v79
    v_exp_f32 v87, v87
    v_exp_f32 v95, v95
    v_exp_f32 v99, v99
    v_exp_f32 v103, v103
    v_exp_f32 v107, v107
    v_exp_f32 v111, v111
    v_add_f32 v64, v96, v97
    v_add_f32 v72, v100, v101
    v_add_f32 v80, v104, v105
    v_add_f32 v88, v108, v109
    v_add_f32 v65, v68, v69
    v_add_f32 v73, v76, v77
    v_add_f32 v81, v84, v85
    v_add_f32 v89, v92, v93
    v_add_f32 v66, v98, v99
    v_add_f32 v74, v102, v103
    v_add_f32 v82, v106, v107
    v_add_f32 v90, v110, v111
    v_add_f32 v64, v64, v66
    v_add_f32 v72, v72, v74
    v_add_f32 v80, v80, v82
    v_add_f32 v88, v88, v90
    v_add_f32 v66, v70, v71
    v_add_f32 v74, v78, v79
    v_add_f32 v82, v86, v87
    v_add_f32 v90, v94, v95
    v_add_f32 v65, v65, v66
    v_add_f32 v73, v73, v74
    v_add_f32 v81, v81, v82
    v_add_f32 v89, v89, v90
    v_permlane32_swap_b32 v64, v65
    v_permlane32_swap_b32 v72, v73
    v_permlane32_swap_b32 v80, v81
    v_permlane32_swap_b32 v88, v89
    v_add_f32 v64, v64, v65
    v_add_f32 v72, v72, v73
    v_add_f32 v80, v80, v81
    v_add_f32 v88, v88, v89
    v_mov_b32 v66, v64
    v_mov_b32 v74, v72
    v_mov_b32 v82, v80
    v_mov_b32 v90, v88
    v_permlane16_swap_b32 v64, v66
    v_permlane16_swap_b32 v72, v74
    v_permlane16_swap_b32 v80, v82
    v_permlane16_swap_b32 v88, v90
    v_add_f32 v64, v64, v66
    v_add_f32 v72, v72, v74
    v_add_f32 v80, v80, v82
    v_add_f32 v88, v88, v90
    v_mov_b32 v65, v64
    v_mov_b32 v73, v72
    v_mov_b32 v81, v80
    v_mov_b32 v89, v88
    v_permlane32_swap_b32 v64, v65
    v_permlane32_swap_b32 v72, v73
    v_permlane32_swap_b32 v80, v81
    v_permlane32_swap_b32 v88, v89
    v_rcp_f32 v64, v64
    v_rcp_f32 v72, v72
    v_rcp_f32 v80, v80
    v_rcp_f32 v88, v88
    v_rcp_f32 v65, v65
    v_rcp_f32 v73, v73
    v_rcp_f32 v81, v81
    v_rcp_f32 v89, v89
    v_mul_f32 v96, v96, v64
    v_mul_f32 v100, v100, v72
    v_mul_f32 v104, v104, v80
    v_mul_f32 v108, v108, v88
    v_mul_f32 v68, v68, v65
    v_mul_f32 v76, v76, v73
    v_mul_f32 v84, v84, v81
    v_mul_f32 v92, v92, v89
    v_mul_f32 v97, v97, v64
    v_mul_f32 v101, v101, v72
    v_mul_f32 v105, v105, v80
    v_mul_f32 v109, v109, v88
    v_mul_f32 v69, v69, v65
    v_mul_f32 v77, v77, v73
    v_mul_f32 v85, v85, v81
    v_mul_f32 v93, v93, v89
    v_mul_f32 v98, v98, v64
    v_mul_f32 v102, v102, v72
    v_mul_f32 v106, v106, v80
    v_mul_f32 v110, v110, v88
    v_mul_f32 v70, v70, v65
    v_mul_f32 v78, v78, v73
    v_mul_f32 v86, v86, v81
    v_mul_f32 v94, v94, v89
    v_mul_f32 v99, v99, v64
    v_mul_f32 v103, v103, v72
    v_mul_f32 v107, v107, v80
    v_mul_f32 v111, v111, v88
    v_mul_f32 v71, v71, v65
    v_mul_f32 v79, v79, v73
    v_mul_f32 v87, v87, v81
    v_mul_f32 v95, v95, v89
    v_cvt_pk_bf16_f32 v40, v96, v97
    v_cvt_pk_bf16_f32 v44, v100, v101
    v_cvt_pk_bf16_f32 v48, v104, v105
    v_cvt_pk_bf16_f32 v52, v108, v109
    v_cvt_pk_bf16_f32 v41, v98, v99
    v_cvt_pk_bf16_f32 v45, v102, v103
    v_cvt_pk_bf16_f32 v49, v106, v107
    v_cvt_pk_bf16_f32 v53, v110, v111
    v_cvt_pk_bf16_f32 v42, v68, v69
    v_cvt_pk_bf16_f32 v46, v76, v77
    v_cvt_pk_bf16_f32 v50, v84, v85
    v_cvt_pk_bf16_f32 v54, v92, v93
    v_cvt_pk_bf16_f32 v43, v70, v71
    v_cvt_pk_bf16_f32 v47, v78, v79
    v_cvt_pk_bf16_f32 v51, v86, v87
    v_cvt_pk_bf16_f32 v55, v94, v95
    v_cvt_pk_bf16_f32 v56, v112, v113
    v_cvt_pk_bf16_f32 v57, v114, v115
    v_cvt_pk_bf16_f32 v58, v116, v117
    v_cvt_pk_bf16_f32 v59, v118, v119
    v_cvt_pk_bf16_f32 v60, v120, v121
    v_cvt_pk_bf16_f32 v61, v122, v123
    v_cvt_pk_bf16_f32 v62, v124, v125
    v_cvt_pk_bf16_f32 v63, v126, v127
    v_mfma_f32_16x16x16_bf16 v[64:67], v[40:41], v[32:33], 0
    v_mfma_f32_16x16x16_bf16 v[68:71], v[44:45], v[32:33], 0
    v_mfma_f32_16x16x16_bf16 v[72:75], v[42:43], v[32:33], 0
    v_mfma_f32_16x16x16_bf16 v[76:79], v[46:47], v[32:33], 0
    v_mfma_f32_16x16x16_bf16 v[80:83], v[48:49], v[32:33], 0
    v_mfma_f32_16x16x16_bf16 v[84:87], v[52:53], v[32:33], 0
    v_mfma_f32_16x16x16_bf16 v[88:91], v[50:51], v[32:33], 0
    v_mfma_f32_16x16x16_bf16 v[92:95], v[54:55], v[32:33], 0
    s_nop 7
    v_cvt_pk_bf16_f32 v96, v64, v65
    v_cvt_pk_bf16_f32 v97, v66, v67
    v_cvt_pk_bf16_f32 v98, v68, v69
    v_cvt_pk_bf16_f32 v99, v70, v71
    v_cvt_pk_bf16_f32 v100, v72, v73
    v_cvt_pk_bf16_f32 v101, v74, v75
    v_cvt_pk_bf16_f32 v102, v76, v77
    v_cvt_pk_bf16_f32 v103, v78, v79
    v_cvt_pk_bf16_f32 v104, v80, v81
    v_cvt_pk_bf16_f32 v105, v82, v83
    v_cvt_pk_bf16_f32 v106, v84, v85
    v_cvt_pk_bf16_f32 v107, v86, v87
    v_cvt_pk_bf16_f32 v108, v88, v89
    v_cvt_pk_bf16_f32 v109, v90, v91
    v_cvt_pk_bf16_f32 v110, v92, v93
    v_cvt_pk_bf16_f32 v111, v94, v95
    s_nop 1
    v_mfma_f32_16x16x32_bf16 v[64:67], v[96:99], v[56:59], 0
    v_mfma_f32_16x16x32_bf16 v[68:71], v[96:99], v[34:37], 0
    v_mfma_f32_16x16x32_bf16 v[72:75], v[100:103], v[56:59], 0
    v_mfma_f32_16x16x32_bf16 v[76:79], v[100:103], v[34:37], 0
    v_mfma_f32_16x16x32_bf16 v[80:83], v[104:107], v[60:63], 0
    v_mfma_f32_16x16x32_bf16 v[84:87], v[104:107], v[34:37], 0
    v_mfma_f32_16x16x32_bf16 v[88:91], v[108:111], v[60:63], 0
    v_mfma_f32_16x16x32_bf16 v[92:95], v[108:111], v[34:37], 0
    s_lshl_b32 s7, s3, 13
    v_lshlrev_b32 v8, 4, v1
    v_add_u32 v5, s7, v8
    s_lshl_b32 s7, s3, 11
    v_add_u32 v6, s7, v8
    s_nop 7
    ds_write_b128 v5, v[64:67] offset:32768
    ds_write_b128 v5, v[68:71] offset:33792
    ds_write_b128 v5, v[72:75] offset:34816
    ds_write_b128 v5, v[76:79] offset:35840
    ds_write_b128 v5, v[80:83] offset:36864
    ds_write_b128 v5, v[84:87] offset:37888
    ds_write_b128 v5, v[88:91] offset:38912
    ds_write_b128 v5, v[92:95] offset:39936
    s_waitcnt lgkmcnt(0)
    s_barrier
    ds_read_b128 v[64:67], v6 offset:32768
    ds_read_b128 v[68:71], v6 offset:33792
    ds_read_b128 v[72:75], v6 offset:40960
    ds_read_b128 v[76:79], v6 offset:41984
    ds_read_b128 v[80:83], v6 offset:49152
    ds_read_b128 v[84:87], v6 offset:50176
    ds_read_b128 v[88:91], v6 offset:57344
    ds_read_b128 v[92:95], v6 offset:58368
    s_lshl_b32 s64, s5, 17
    s_lshl_b32 s65, s3, 11
    s_add_u32 s64, s64, s65
    s_lshl_b32 s65, s4, 13
    s_add_u32 s65, s65, s64
    v_lshlrev_b32 v9, 4, v4
    s_waitcnt lgkmcnt(0)
    v_add_f32 v112, v64, v72
    v_add_f32 v120, v80, v88
    v_add_f32 v113, v65, v73
    v_add_f32 v121, v81, v89
    v_add_f32 v114, v66, v74
    v_add_f32 v122, v82, v90
    v_add_f32 v115, v67, v75
    v_add_f32 v123, v83, v91
    v_add_f32 v116, v68, v76
    v_add_f32 v124, v84, v92
    v_add_f32 v117, v69, v77
    v_add_f32 v125, v85, v93
    v_add_f32 v118, v70, v78
    v_add_f32 v126, v86, v94
    v_add_f32 v119, v71, v79
    v_add_f32 v127, v87, v95
    v_add_f32 v112, v112, v120
    v_add_f32 v113, v113, v121
    v_add_f32 v114, v114, v122
    v_add_f32 v115, v115, v123
    v_add_f32 v116, v116, v124
    v_add_f32 v117, v117, v125
    v_add_f32 v118, v118, v126
    v_add_f32 v119, v119, v127
    buffer_store_dwordx4 v[112:115], v8, s[52:55], s65 offen sc1
    buffer_store_dwordx4 v[116:119], v9, s[52:55], s65 offen offset:1024 sc1
    ds_read_b64_tr_b16 v[64:65], v18 offset:0
    ds_read_b64_tr_b16 v[66:67], v18 offset:256
    ds_read_b64_tr_b16 v[68:69], v19 offset:0
    ds_read_b64_tr_b16 v[70:71], v19 offset:256
    s_waitcnt lgkmcnt(0)
    ds_read_b64_tr_b16 v[72:73], v18 offset:2048
    ds_read_b64_tr_b16 v[74:75], v18 offset:2304
    v_mfma_f32_16x16x32_bf16 v[96:99], v[64:67], v[128:131], 0
    v_mfma_f32_16x16x32_bf16 v[100:103], v[64:67], v[132:135], 0
    v_mfma_f32_16x16x32_bf16 v[120:123], v[64:67], v[34:37], 0
    ds_read_b64_tr_b16 v[76:77], v19 offset:2048
    v_mfma_f32_16x16x32_bf16 v[104:107], v[68:71], v[128:131], 0
    v_mfma_f32_16x16x32_bf16 v[108:111], v[68:71], v[132:135], 0
    v_mfma_f32_16x16x32_bf16 v[124:127], v[68:71], v[34:37], 0
    ds_read_b64_tr_b16 v[78:79], v19 offset:2304
    s_waitcnt lgkmcnt(0)
    ds_read_b64_tr_b16 v[64:65], v18 offset:4096
    ds_read_b64_tr_b16 v[66:67], v18 offset:4352
    v_mfma_f32_16x16x32_bf16 v[96:99], v[72:75], v[136:139], v[96:99]
    v_mfma_f32_16x16x32_bf16 v[100:103], v[72:75], v[140:143], v[100:103]
    v_mfma_f32_16x16x32_bf16 v[120:123], v[72:75], v[34:37], v[120:123]
    ds_read_b64_tr_b16 v[68:69], v19 offset:4096
    v_mfma_f32_16x16x32_bf16 v[104:107], v[76:79], v[136:139], v[104:107]
    v_mfma_f32_16x16x32_bf16 v[108:111], v[76:79], v[140:143], v[108:111]
    v_mfma_f32_16x16x32_bf16 v[124:127], v[76:79], v[34:37], v[124:127]
    ds_read_b64_tr_b16 v[70:71], v19 offset:4352
    s_waitcnt lgkmcnt(0)
    ds_read_b64_tr_b16 v[72:73], v18 offset:6144
    ds_read_b64_tr_b16 v[74:75], v18 offset:6400
    v_mfma_f32_16x16x32_bf16 v[96:99], v[64:67], v[144:147], v[96:99]
    v_mfma_f32_16x16x32_bf16 v[100:103], v[64:67], v[148:151], v[100:103]
    v_mfma_f32_16x16x32_bf16 v[120:123], v[64:67], v[34:37], v[120:123]
    ds_read_b64_tr_b16 v[76:77], v19 offset:6144
    v_mfma_f32_16x16x32_bf16 v[104:107], v[68:71], v[144:147], v[104:107]
    v_mfma_f32_16x16x32_bf16 v[108:111], v[68:71], v[148:151], v[108:111]
    v_mfma_f32_16x16x32_bf16 v[124:127], v[68:71], v[34:37], v[124:127]
    ds_read_b64_tr_b16 v[78:79], v19 offset:6400
    s_waitcnt lgkmcnt(0)
    ds_read_b64_tr_b16 v[64:65], v18 offset:8192
    ds_read_b64_tr_b16 v[66:67], v18 offset:8448
    v_mfma_f32_16x16x32_bf16 v[96:99], v[72:75], v[152:155], v[96:99]
    v_mfma_f32_16x16x32_bf16 v[100:103], v[72:75], v[156:159], v[100:103]
    v_mfma_f32_16x16x32_bf16 v[120:123], v[72:75], v[34:37], v[120:123]
    ds_read_b64_tr_b16 v[68:69], v19 offset:8192
    v_mfma_f32_16x16x32_bf16 v[104:107], v[76:79], v[152:155], v[104:107]
    v_mfma_f32_16x16x32_bf16 v[108:111], v[76:79], v[156:159], v[108:111]
    v_mfma_f32_16x16x32_bf16 v[124:127], v[76:79], v[34:37], v[124:127]
    ds_read_b64_tr_b16 v[70:71], v19 offset:8448
    s_waitcnt lgkmcnt(0)
    ds_read_b64_tr_b16 v[72:73], v18 offset:10240
    ds_read_b64_tr_b16 v[74:75], v18 offset:10496
    v_mfma_f32_16x16x32_bf16 v[96:99], v[64:67], v[160:163], v[96:99]
    v_mfma_f32_16x16x32_bf16 v[100:103], v[64:67], v[164:167], v[100:103]
    v_mfma_f32_16x16x32_bf16 v[120:123], v[64:67], v[34:37], v[120:123]
    ds_read_b64_tr_b16 v[76:77], v19 offset:10240
    v_mfma_f32_16x16x32_bf16 v[104:107], v[68:71], v[160:163], v[104:107]
    v_mfma_f32_16x16x32_bf16 v[108:111], v[68:71], v[164:167], v[108:111]
    v_mfma_f32_16x16x32_bf16 v[124:127], v[68:71], v[34:37], v[124:127]
    ds_read_b64_tr_b16 v[78:79], v19 offset:10496
    s_waitcnt lgkmcnt(0)
    ds_read_b64_tr_b16 v[64:65], v18 offset:12288
    ds_read_b64_tr_b16 v[66:67], v18 offset:12544
    v_mfma_f32_16x16x32_bf16 v[96:99], v[72:75], v[168:171], v[96:99]
    v_mfma_f32_16x16x32_bf16 v[100:103], v[72:75], v[172:175], v[100:103]
    v_mfma_f32_16x16x32_bf16 v[120:123], v[72:75], v[34:37], v[120:123]
    ds_read_b64_tr_b16 v[68:69], v19 offset:12288
    v_mfma_f32_16x16x32_bf16 v[104:107], v[76:79], v[168:171], v[104:107]
    v_mfma_f32_16x16x32_bf16 v[108:111], v[76:79], v[172:175], v[108:111]
    v_mfma_f32_16x16x32_bf16 v[124:127], v[76:79], v[34:37], v[124:127]
    ds_read_b64_tr_b16 v[70:71], v19 offset:12544
    s_waitcnt lgkmcnt(0)
    ds_read_b64_tr_b16 v[72:73], v18 offset:14336
    ds_read_b64_tr_b16 v[74:75], v18 offset:14592
    v_mfma_f32_16x16x32_bf16 v[96:99], v[64:67], v[176:179], v[96:99]
    v_mfma_f32_16x16x32_bf16 v[100:103], v[64:67], v[180:183], v[100:103]
    v_mfma_f32_16x16x32_bf16 v[120:123], v[64:67], v[34:37], v[120:123]
    ds_read_b64_tr_b16 v[76:77], v19 offset:14336
    v_mfma_f32_16x16x32_bf16 v[104:107], v[68:71], v[176:179], v[104:107]
    v_mfma_f32_16x16x32_bf16 v[108:111], v[68:71], v[180:183], v[108:111]
    v_mfma_f32_16x16x32_bf16 v[124:127], v[68:71], v[34:37], v[124:127]
    ds_read_b64_tr_b16 v[78:79], v19 offset:14592
    s_waitcnt lgkmcnt(0)
    v_mfma_f32_16x16x32_bf16 v[96:99], v[72:75], v[184:187], v[96:99]
    v_mfma_f32_16x16x32_bf16 v[100:103], v[72:75], v[188:191], v[100:103]
    v_mfma_f32_16x16x32_bf16 v[120:123], v[72:75], v[34:37], v[120:123]
    v_mfma_f32_16x16x32_bf16 v[104:107], v[76:79], v[184:187], v[104:107]
    v_mfma_f32_16x16x32_bf16 v[108:111], v[76:79], v[188:191], v[108:111]
    v_mfma_f32_16x16x32_bf16 v[124:127], v[76:79], v[34:37], v[124:127]
    s_waitcnt vmcnt(0)
    s_barrier
    s_cmp_lg_u32 s3, 0
    s_cbranch_scc1 Lsig1561
    v_mov_b32 v5, 1
    s_lshl_b32 s7, s5, 4
    v_mov_b32 v6, s7
    s_mov_b64 s[12:13], exec
    s_mov_b64 exec, 1
    buffer_atomic_add v5, v6, s[60:63], 0 offen sc1
    s_mov_b64 exec, s[12:13]
Lsig1561:
    s_mov_b32 s40, s26
    s_mov_b32 s41, s27
    s_mov_b32 s42, 1409024
    s_mov_b32 s43, 0x20000
    s_mov_b32 s44, s22
    s_mov_b32 s45, s23
    s_mov_b32 s46, 524288
    s_mov_b32 s47, 0x20000
    s_mov_b32 s48, s32
    s_mov_b32 s49, s33
    s_mov_b32 s50, 704512
    s_mov_b32 s51, 0x20000
    s_lshl_b32 s67, s2, 2
    s_add_u32 s67, s67, s3
    s_and_b32 s68, s67, 31
    s_lshr_b32 s69, s67, 6
    s_min_u32 s70, s69, 14
    s_bfe_u32 s71, s67, 0x10005
    s_mul_i32 s72, s70, 96
    s_lshl_b32 s73, s71, 5
    s_add_u32 s76, s72, s73
    s_add_u32 s76, s76, s68
    s_lshl_b32 s76, s76, 10
    s_lshl_b32 s73, s71, 6
    s_add_u32 s73, s73, s72
    s_add_u32 s73, s73, 1376
    s_min_u32 s73, s73, 2720
    s_add_u32 s74, s72, 1408
    s_min_u32 s74, s74, 2720
    s_cmp_eq_u32 s71, 0
    s_cselect_b32 s74, s74, s72
    s_mul_i32 s75, s68, 44032
    v_lshrrev_b32 v24, 2, v1
    s_movk_i32 s7, 2752
    v_mul_lo_u32 v24, v24, s7
    v_and_b32 v25, 1, v1
    v_lshl_add_u32 v24, v25, 4, v24
    v_lshrrev_b32 v25, 4, v1
    v_xor_b32 v25, v25, v1
    v_and_b32 v25, 2, v25
    v_cmp_eq_u32 vcc, 0, v25
    v_mov_b32 v26, s74
    v_mov_b32 v27, s73
    v_cndmask_b32 v26, v26, v27, vcc
    v_add_u32 v12, v24, v26
    buffer_load_dwordx4 v[128:131], v12, s[40:43], s75 offen
    s_bfe_u32 s71, s67, 0x40005
    s_min_u32 s70, s71, 14
    s_mul_i32 s72, s70, 96
    s_add_u32 s77, s72, 64
    s_add_u32 s77, s77, s68
    s_lshl_b32 s77, s77, 10
    s_add_u32 s73, s72, 32
    s_add_u32 s74, s72, 64
    v_lshrrev_b32 v24, 2, v1
    s_movk_i32 s7, 2752
    v_mul_lo_u32 v24, v24, s7
    v_and_b32 v25, 1, v1
    v_lshl_add_u32 v24, v25, 4, v24
    v_lshrrev_b32 v25, 4, v1
    v_xor_b32 v25, v25, v1
    v_and_b32 v25, 2, v25
    v_cmp_eq_u32 vcc, 0, v25
    v_mov_b32 v26, s74
    v_mov_b32 v27, s73
    v_cndmask_b32 v26, v26, v27, vcc
    v_add_u32 v12, v24, v26
    buffer_load_dwordx4 v[132:135], v12, s[40:43], s75 offen
    s_and_b32 s78, s67, 511
    s_lshl_b32 s78, s78, 10
    s_add_u32 s78, s78, 0x180000
    s_lshl_b32 s75, s68, 14
    s_lshl_b32 s72, s71, 6
    s_add_u32 s75, s75, s72
    v_lshrrev_b32 v24, 2, v1
    s_movk_i32 s7, 1024
    v_mul_lo_u32 v24, v24, s7
    v_and_b32 v25, 1, v1
    v_lshl_add_u32 v24, v25, 4, v24
    v_lshrrev_b32 v25, 4, v1
    v_xor_b32 v25, v25, v1
    v_and_b32 v25, 2, v25
    v_cmp_eq_u32 vcc, 0, v25
    v_mov_b32 v26, 32
    v_mov_b32 v27, 0
    v_cndmask_b32 v26, v26, v27, vcc
    v_add_u32 v12, v24, v26
    buffer_load_dwordx4 v[136:139], v12, s[44:47], s75 offen
    s_and_b32 s68, s67, 63
    s_sub_u32 s72, s68, 44
    s_cmp_ge_u32 s68, 44
    s_cselect_b32 s68, s72, s68
    s_mul_i32 s79, s69, 44
    s_add_u32 s79, s79, s68
    s_lshl_b32 s79, s79, 10
    s_add_u32 s79, s79, 0x200000
    s_min_u32 s75, s68, 42
    s_lshl_b32 s75, s75, 14
    s_lshl_b32 s72, s69, 6
    s_add_u32 s75, s75, s72
    buffer_load_dwordx4 v[140:143], v12, s[48:51], s75 offen
    ds_read_b64_tr_b16 v[64:65], v16 offset:0
    ds_read_b64_tr_b16 v[66:67], v16 offset:256
    ds_read_b64_tr_b16 v[68:69], v17 offset:0
    ds_read_b64_tr_b16 v[70:71], v17 offset:256
    s_waitcnt lgkmcnt(0)
    ds_read_b64_tr_b16 v[72:73], v16 offset:2048
    ds_read_b64_tr_b16 v[74:75], v16 offset:2304
    v_mfma_f32_16x16x32_bf16 v[96:99], v[64:67], v[192:195], v[96:99]
    v_mfma_f32_16x16x32_bf16 v[100:103], v[64:67], v[196:199], v[100:103]
    v_mfma_f32_16x16x32_bf16 v[120:123], v[64:67], v[34:37], v[120:123]
    ds_read_b64_tr_b16 v[76:77], v17 offset:2048
    v_mfma_f32_16x16x32_bf16 v[104:107], v[68:71], v[192:195], v[104:107]
    v_mfma_f32_16x16x32_bf16 v[108:111], v[68:71], v[196:199], v[108:111]
    v_mfma_f32_16x16x32_bf16 v[124:127], v[68:71], v[34:37], v[124:127]
    ds_read_b64_tr_b16 v[78:79], v17 offset:2304
    s_waitcnt lgkmcnt(0)
    ds_read_b64_tr_b16 v[64:65], v16 offset:4096
    ds_read_b64_tr_b16 v[66:67], v16 offset:4352
    v_mfma_f32_16x16x32_bf16 v[96:99], v[72:75], v[200:203], v[96:99]
    v_mfma_f32_16x16x32_bf16 v[100:103], v[72:75], v[204:207], v[100:103]
    v_mfma_f32_16x16x32_bf16 v[120:123], v[72:75], v[34:37], v[120:123]
    ds_read_b64_tr_b16 v[68:69], v17 offset:4096
    v_mfma_f32_16x16x32_bf16 v[104:107], v[76:79], v[200:203], v[104:107]
    v_mfma_f32_16x16x32_bf16 v[108:111], v[76:79], v[204:207], v[108:111]
    v_mfma_f32_16x16x32_bf16 v[124:127], v[76:79], v[34:37], v[124:127]
    ds_read_b64_tr_b16 v[70:71], v17 offset:4352
    s_waitcnt lgkmcnt(0)
    ds_read_b64_tr_b16 v[72:73], v16 offset:6144
    ds_read_b64_tr_b16 v[74:75], v16 offset:6400
    v_mfma_f32_16x16x32_bf16 v[96:99], v[64:67], v[208:211], v[96:99]
    v_mfma_f32_16x16x32_bf16 v[100:103], v[64:67], v[212:215], v[100:103]
    v_mfma_f32_16x16x32_bf16 v[120:123], v[64:67], v[34:37], v[120:123]
    ds_read_b64_tr_b16 v[76:77], v17 offset:6144
    v_mfma_f32_16x16x32_bf16 v[104:107], v[68:71], v[208:211], v[104:107]
    v_mfma_f32_16x16x32_bf16 v[108:111], v[68:71], v[212:215], v[108:111]
    v_mfma_f32_16x16x32_bf16 v[124:127], v[68:71], v[34:37], v[124:127]
    ds_read_b64_tr_b16 v[78:79], v17 offset:6400
    s_waitcnt lgkmcnt(0)
    ds_read_b64_tr_b16 v[64:65], v16 offset:8192
    ds_read_b64_tr_b16 v[66:67], v16 offset:8448
    v_mfma_f32_16x16x32_bf16 v[96:99], v[72:75], v[216:219], v[96:99]
    v_mfma_f32_16x16x32_bf16 v[100:103], v[72:75], v[220:223], v[100:103]
    v_mfma_f32_16x16x32_bf16 v[120:123], v[72:75], v[34:37], v[120:123]
    ds_read_b64_tr_b16 v[68:69], v17 offset:8192
    v_mfma_f32_16x16x32_bf16 v[104:107], v[76:79], v[216:219], v[104:107]
    v_mfma_f32_16x16x32_bf16 v[108:111], v[76:79], v[220:223], v[108:111]
    v_mfma_f32_16x16x32_bf16 v[124:127], v[76:79], v[34:37], v[124:127]
    ds_read_b64_tr_b16 v[70:71], v17 offset:8448
    s_waitcnt lgkmcnt(0)
    ds_read_b64_tr_b16 v[72:73], v16 offset:10240
    ds_read_b64_tr_b16 v[74:75], v16 offset:10496
    v_mfma_f32_16x16x32_bf16 v[96:99], v[64:67], v[224:227], v[96:99]
    v_mfma_f32_16x16x32_bf16 v[100:103], v[64:67], v[228:231], v[100:103]
    v_mfma_f32_16x16x32_bf16 v[120:123], v[64:67], v[34:37], v[120:123]
    ds_read_b64_tr_b16 v[76:77], v17 offset:10240
    v_mfma_f32_16x16x32_bf16 v[104:107], v[68:71], v[224:227], v[104:107]
    v_mfma_f32_16x16x32_bf16 v[108:111], v[68:71], v[228:231], v[108:111]
    v_mfma_f32_16x16x32_bf16 v[124:127], v[68:71], v[34:37], v[124:127]
    ds_read_b64_tr_b16 v[78:79], v17 offset:10496
    s_waitcnt lgkmcnt(0)
    ds_read_b64_tr_b16 v[64:65], v16 offset:12288
    ds_read_b64_tr_b16 v[66:67], v16 offset:12544
    v_mfma_f32_16x16x32_bf16 v[96:99], v[72:75], v[232:235], v[96:99]
    v_mfma_f32_16x16x32_bf16 v[100:103], v[72:75], v[236:239], v[100:103]
    v_mfma_f32_16x16x32_bf16 v[120:123], v[72:75], v[34:37], v[120:123]
    ds_read_b64_tr_b16 v[68:69], v17 offset:12288
    v_mfma_f32_16x16x32_bf16 v[104:107], v[76:79], v[232:235], v[104:107]
    v_mfma_f32_16x16x32_bf16 v[108:111], v[76:79], v[236:239], v[108:111]
    v_mfma_f32_16x16x32_bf16 v[124:127], v[76:79], v[34:37], v[124:127]
    ds_read_b64_tr_b16 v[70:71], v17 offset:12544
    s_waitcnt lgkmcnt(0)
    ds_read_b64_tr_b16 v[72:73], v16 offset:14336
    ds_read_b64_tr_b16 v[74:75], v16 offset:14592
    v_mfma_f32_16x16x32_bf16 v[96:99], v[64:67], v[240:243], v[96:99]
    v_mfma_f32_16x16x32_bf16 v[100:103], v[64:67], v[244:247], v[100:103]
    v_mfma_f32_16x16x32_bf16 v[120:123], v[64:67], v[34:37], v[120:123]
    ds_read_b64_tr_b16 v[76:77], v17 offset:14336
    v_mfma_f32_16x16x32_bf16 v[104:107], v[68:71], v[240:243], v[104:107]
    v_mfma_f32_16x16x32_bf16 v[108:111], v[68:71], v[244:247], v[108:111]
    v_mfma_f32_16x16x32_bf16 v[124:127], v[68:71], v[34:37], v[124:127]
    ds_read_b64_tr_b16 v[78:79], v17 offset:14592
    s_waitcnt lgkmcnt(0)
    v_mfma_f32_16x16x32_bf16 v[96:99], v[72:75], v[248:251], v[96:99]
    v_mfma_f32_16x16x32_bf16 v[100:103], v[72:75], v[252:255], v[100:103]
    v_mfma_f32_16x16x32_bf16 v[120:123], v[72:75], v[34:37], v[120:123]
    v_mfma_f32_16x16x32_bf16 v[104:107], v[76:79], v[248:251], v[104:107]
    v_mfma_f32_16x16x32_bf16 v[108:111], v[76:79], v[252:255], v[108:111]
    v_mfma_f32_16x16x32_bf16 v[124:127], v[76:79], v[34:37], v[124:127]
    v_mul_f32 v96, v96, v20
    v_mul_f32 v97, v97, v20
    v_mul_f32 v98, v98, v20
    v_mul_f32 v99, v99, v20
    v_fmac_f32 v96, v120, v21
    v_fmac_f32 v97, v121, v21
    v_fmac_f32 v98, v122, v21
    v_fmac_f32 v99, v123, v21
    v_mul_f32 v100, v100, v22
    v_mul_f32 v101, v101, v22
    v_mul_f32 v102, v102, v22
    v_mul_f32 v103, v103, v22
    v_fmac_f32 v100, v120, v23
    v_fmac_f32 v101, v121, v23
    v_fmac_f32 v102, v122, v23
    v_fmac_f32 v103, v123, v23
    v_mul_f32 v104, v104, v20
    v_mul_f32 v105, v105, v20
    v_mul_f32 v106, v106, v20
    v_mul_f32 v107, v107, v20
    v_fmac_f32 v104, v124, v21
    v_fmac_f32 v105, v125, v21
    v_fmac_f32 v106, v126, v21
    v_fmac_f32 v107, v127, v21
    v_mul_f32 v108, v108, v22
    v_mul_f32 v109, v109, v22
    v_mul_f32 v110, v110, v22
    v_mul_f32 v111, v111, v22
    v_fmac_f32 v108, v124, v23
    v_fmac_f32 v109, v125, v23
    v_fmac_f32 v110, v126, v23
    v_fmac_f32 v111, v127, v23
    s_nop 7
    v_cvt_pk_bf16_f32 v64, v96, v97
    v_cvt_pk_bf16_f32 v72, v100, v101
    v_cvt_pk_bf16_f32 v80, v104, v105
    v_cvt_pk_bf16_f32 v88, v108, v109
    v_cvt_pk_bf16_f32 v65, v98, v99
    v_cvt_pk_bf16_f32 v73, v102, v103
    v_cvt_pk_bf16_f32 v81, v106, v107
    v_cvt_pk_bf16_f32 v89, v110, v111
    v_mfma_f32_16x16x16_bf16 v[96:99], v[28:29], v[64:65], 0
    v_mfma_f32_16x16x16_bf16 v[100:103], v[28:29], v[72:73], 0
    v_mfma_f32_16x16x16_bf16 v[104:107], v[30:31], v[80:81], 0
    v_mfma_f32_16x16x16_bf16 v[108:111], v[30:31], v[88:89], 0
    s_nop 7
    v_max3_f32 v64, v96, v97, v98
    v_max3_f32 v72, v100, v101, v102
    v_max3_f32 v80, v104, v105, v106
    v_max3_f32 v88, v108, v109, v110
    v_max3_f32 v65, -v96, -v97, -v98
    v_max3_f32 v73, -v100, -v101, -v102
    v_max3_f32 v81, -v104, -v105, -v106
    v_max3_f32 v89, -v108, -v109, -v110
    v_max_f32 v64, v64, v99
    v_max_f32 v72, v72, v103
    v_max_f32 v80, v80, v107
    v_max_f32 v88, v88, v111
    v_max_f32_e64 v65, v65, -v99
    v_max_f32_e64 v73, v73, -v103
    v_max_f32_e64 v81, v81, -v107
    v_max_f32_e64 v89, v89, -v111
    v_permlane32_swap_b32 v64, v65
    v_permlane32_swap_b32 v72, v73
    v_permlane32_swap_b32 v80, v81
    v_permlane32_swap_b32 v88, v89
    v_max_f32 v64, v64, v65
    v_max_f32 v72, v72, v73
    v_max_f32 v80, v80, v81
    v_max_f32 v88, v88, v89
    v_mov_b32 v66, v64
    v_mov_b32 v74, v72
    v_mov_b32 v82, v80
    v_mov_b32 v90, v88
    v_permlane16_swap_b32 v64, v66
    v_permlane16_swap_b32 v72, v74
    v_permlane16_swap_b32 v80, v82
    v_permlane16_swap_b32 v88, v90
    v_max_f32 v64, v64, v66
    v_max_f32 v72, v72, v74
    v_max_f32 v80, v80, v82
    v_max_f32 v88, v88, v90
    v_mov_b32 v65, v64
    v_mov_b32 v73, v72
    v_mov_b32 v81, v80
    v_mov_b32 v89, v88
    v_permlane32_swap_b32 v64, v65
    v_permlane32_swap_b32 v72, v73
    v_permlane32_swap_b32 v80, v81
    v_permlane32_swap_b32 v88, v89
    v_mul_f32 v64, s14, v64
    v_mul_f32 v72, s14, v72
    v_mul_f32 v80, s14, v80
    v_mul_f32 v88, s14, v88
    v_mul_f32 v65, s14, v65
    v_mul_f32 v73, s14, v73
    v_mul_f32 v81, s14, v81
    v_mul_f32 v89, s14, v89
    v_fma_f32 v68, -v96, s14, -v65
    v_fma_f32 v76, -v100, s14, -v73
    v_fma_f32 v84, -v104, s14, -v81
    v_fma_f32 v92, -v108, s14, -v89
    v_fma_f32 v96, v96, s14, -v64
    v_fma_f32 v100, v100, s14, -v72
    v_fma_f32 v104, v104, s14, -v80
    v_fma_f32 v108, v108, s14, -v88
    v_fma_f32 v69, -v97, s14, -v65
    v_fma_f32 v77, -v101, s14, -v73
    v_fma_f32 v85, -v105, s14, -v81
    v_fma_f32 v93, -v109, s14, -v89
    v_fma_f32 v97, v97, s14, -v64
    v_fma_f32 v101, v101, s14, -v72
    v_fma_f32 v105, v105, s14, -v80
    v_fma_f32 v109, v109, s14, -v88
    v_fma_f32 v70, -v98, s14, -v65
    v_fma_f32 v78, -v102, s14, -v73
    v_fma_f32 v86, -v106, s14, -v81
    v_fma_f32 v94, -v110, s14, -v89
    v_fma_f32 v98, v98, s14, -v64
    v_fma_f32 v102, v102, s14, -v72
    v_fma_f32 v106, v106, s14, -v80
    v_fma_f32 v110, v110, s14, -v88
    v_fma_f32 v71, -v99, s14, -v65
    v_fma_f32 v79, -v103, s14, -v73
    v_fma_f32 v87, -v107, s14, -v81
    v_fma_f32 v95, -v111, s14, -v89
    v_fma_f32 v99, v99, s14, -v64
    v_fma_f32 v103, v103, s14, -v72
    v_fma_f32 v107, v107, s14, -v80
    v_fma_f32 v111, v111, s14, -v88
    v_exp_f32 v68, v68
    v_exp_f32 v76, v76
    v_exp_f32 v84, v84
    v_exp_f32 v92, v92
    v_exp_f32 v96, v96
    v_exp_f32 v100, v100
    v_exp_f32 v104, v104
    v_exp_f32 v108, v108
    v_exp_f32 v69, v69
    v_exp_f32 v77, v77
    v_exp_f32 v85, v85
    v_exp_f32 v93, v93
    v_exp_f32 v97, v97
    v_exp_f32 v101, v101
    v_exp_f32 v105, v105
    v_exp_f32 v109, v109
    v_exp_f32 v70, v70
    v_exp_f32 v78, v78
    v_exp_f32 v86, v86
    v_exp_f32 v94, v94
    v_exp_f32 v98, v98
    v_exp_f32 v102, v102
    v_exp_f32 v106, v106
    v_exp_f32 v110, v110
    v_exp_f32 v71, v71
    v_exp_f32 v79, v79
    v_exp_f32 v87, v87
    v_exp_f32 v95, v95
    v_exp_f32 v99, v99
    v_exp_f32 v103, v103
    v_exp_f32 v107, v107
    v_exp_f32 v111, v111
    v_add_f32 v64, v96, v97
    v_add_f32 v72, v100, v101
    v_add_f32 v80, v104, v105
    v_add_f32 v88, v108, v109
    v_add_f32 v65, v68, v69
    v_add_f32 v73, v76, v77
    v_add_f32 v81, v84, v85
    v_add_f32 v89, v92, v93
    v_add_f32 v66, v98, v99
    v_add_f32 v74, v102, v103
    v_add_f32 v82, v106, v107
    v_add_f32 v90, v110, v111
    v_add_f32 v64, v64, v66
    v_add_f32 v72, v72, v74
    v_add_f32 v80, v80, v82
    v_add_f32 v88, v88, v90
    v_add_f32 v66, v70, v71
    v_add_f32 v74, v78, v79
    v_add_f32 v82, v86, v87
    v_add_f32 v90, v94, v95
    v_add_f32 v65, v65, v66
    v_add_f32 v73, v73, v74
    v_add_f32 v81, v81, v82
    v_add_f32 v89, v89, v90
    v_permlane32_swap_b32 v64, v65
    v_permlane32_swap_b32 v72, v73
    v_permlane32_swap_b32 v80, v81
    v_permlane32_swap_b32 v88, v89
    v_add_f32 v64, v64, v65
    v_add_f32 v72, v72, v73
    v_add_f32 v80, v80, v81
    v_add_f32 v88, v88, v89
    v_mov_b32 v66, v64
    v_mov_b32 v74, v72
    v_mov_b32 v82, v80
    v_mov_b32 v90, v88
    v_permlane16_swap_b32 v64, v66
    v_permlane16_swap_b32 v72, v74
    v_permlane16_swap_b32 v80, v82
    v_permlane16_swap_b32 v88, v90
    v_add_f32 v64, v64, v66
    v_add_f32 v72, v72, v74
    v_add_f32 v80, v80, v82
    v_add_f32 v88, v88, v90
    v_mov_b32 v65, v64
    v_mov_b32 v73, v72
    v_mov_b32 v81, v80
    v_mov_b32 v89, v88
    s_cmp_lg_u32 s3, 0
    s_cbranch_scc1 Lpd1970
    s_lshl_b32 s7, s5, 4
    v_mov_b32 v6, s7
    s_mov_b32 s12, 0x40000
Lp1970:
    buffer_load_dword v5, v6, s[60:63], 0 offen sc1
    s_waitcnt vmcnt(0)
    v_readfirstlane_b32 s7, v5
    s_cmp_ge_u32 s7, 16
    s_cbranch_scc1 Lpd1970
    s_sub_u32 s12, s12, 1
    s_cmp_eq_u32 s12, 0
    s_cbranch_scc1 Lpd1970
    s_sleep 1
    s_branch Lp1970
Lpd1970:
    s_barrier
    s_add_u32 s40, s38, 18874368
    s_addc_u32 s41, s39, 0
    s_mov_b32 s42, 3145728
    s_mov_b32 s43, 0x20000
    s_waitcnt vmcnt(0)
    buffer_store_dwordx4 v[128:131], v8, s[40:43], s76 offen
    buffer_store_dwordx4 v[132:135], v8, s[40:43], s77 offen
    buffer_store_dwordx4 v[136:139], v8, s[40:43], s78 offen
    buffer_store_dwordx4 v[140:143], v8, s[40:43], s79 offen
    s_add_u32 s65, s64, 0
    buffer_load_dwordx4 v[128:131], v8, s[52:55], s65 offen sc1
    buffer_load_dwordx4 v[132:135], v9, s[52:55], s65 offen offset:1024 sc1
    v_permlane32_swap_b32 v64, v65
    v_permlane32_swap_b32 v72, v73
    v_permlane32_swap_b32 v80, v81
    v_permlane32_swap_b32 v88, v89
    s_add_u32 s65, s64, 8192
    buffer_load_dwordx4 v[136:139], v8, s[52:55], s65 offen sc1
    buffer_load_dwordx4 v[140:143], v9, s[52:55], s65 offen offset:1024 sc1
    v_rcp_f32 v64, v64
    v_rcp_f32 v72, v72
    v_rcp_f32 v80, v80
    v_rcp_f32 v88, v88
    s_add_u32 s65, s64, 16384
    buffer_load_dwordx4 v[144:147], v8, s[52:55], s65 offen sc1
    buffer_load_dwordx4 v[148:151], v9, s[52:55], s65 offen offset:1024 sc1
    v_rcp_f32 v65, v65
    v_rcp_f32 v73, v73
    v_rcp_f32 v81, v81
    v_rcp_f32 v89, v89
    s_add_u32 s65, s64, 24576
    buffer_load_dwordx4 v[152:155], v8, s[52:55], s65 offen sc1
    buffer_load_dwordx4 v[156:159], v9, s[52:55], s65 offen offset:1024 sc1
    v_mul_f32 v96, v96, v64
    v_mul_f32 v100, v100, v72
    v_mul_f32 v104, v104, v80
    v_mul_f32 v108, v108, v88
    s_add_u32 s65, s64, 32768
    buffer_load_dwordx4 v[160:163], v8, s[52:55], s65 offen sc1
    buffer_load_dwordx4 v[164:167], v9, s[52:55], s65 offen offset:1024 sc1
    v_mul_f32 v68, v68, v65
    v_mul_f32 v76, v76, v73
    v_mul_f32 v84, v84, v81
    v_mul_f32 v92, v92, v89
    s_add_u32 s65, s64, 40960
    buffer_load_dwordx4 v[168:171], v8, s[52:55], s65 offen sc1
    buffer_load_dwordx4 v[172:175], v9, s[52:55], s65 offen offset:1024 sc1
    v_mul_f32 v97, v97, v64
    v_mul_f32 v101, v101, v72
    v_mul_f32 v105, v105, v80
    v_mul_f32 v109, v109, v88
    s_add_u32 s65, s64, 49152
    buffer_load_dwordx4 v[176:179], v8, s[52:55], s65 offen sc1
    buffer_load_dwordx4 v[180:183], v9, s[52:55], s65 offen offset:1024 sc1
    v_mul_f32 v69, v69, v65
    v_mul_f32 v77, v77, v73
    v_mul_f32 v85, v85, v81
    v_mul_f32 v93, v93, v89
    s_add_u32 s65, s64, 57344
    buffer_load_dwordx4 v[184:187], v8, s[52:55], s65 offen sc1
    buffer_load_dwordx4 v[188:191], v9, s[52:55], s65 offen offset:1024 sc1
    v_mul_f32 v98, v98, v64
    v_mul_f32 v102, v102, v72
    v_mul_f32 v106, v106, v80
    v_mul_f32 v110, v110, v88
    s_add_u32 s65, s64, 65536
    buffer_load_dwordx4 v[192:195], v8, s[52:55], s65 offen sc1
    buffer_load_dwordx4 v[196:199], v9, s[52:55], s65 offen offset:1024 sc1
    v_mul_f32 v70, v70, v65
    v_mul_f32 v78, v78, v73
    v_mul_f32 v86, v86, v81
    v_mul_f32 v94, v94, v89
    s_add_u32 s65, s64, 73728
    buffer_load_dwordx4 v[200:203], v8, s[52:55], s65 offen sc1
    buffer_load_dwordx4 v[204:207], v9, s[52:55], s65 offen offset:1024 sc1
    v_mul_f32 v99, v99, v64
    v_mul_f32 v103, v103, v72
    v_mul_f32 v107, v107, v80
    v_mul_f32 v111, v111, v88
    s_add_u32 s65, s64, 81920
    buffer_load_dwordx4 v[208:211], v8, s[52:55], s65 offen sc1
    buffer_load_dwordx4 v[212:215], v9, s[52:55], s65 offen offset:1024 sc1
    v_mul_f32 v71, v71, v65
    v_mul_f32 v79, v79, v73
    v_mul_f32 v87, v87, v81
    v_mul_f32 v95, v95, v89
    s_add_u32 s65, s64, 90112
    buffer_load_dwordx4 v[216:219], v8, s[52:55], s65 offen sc1
    buffer_load_dwordx4 v[220:223], v9, s[52:55], s65 offen offset:1024 sc1
    v_cvt_pk_bf16_f32 v40, v96, v97
    v_cvt_pk_bf16_f32 v44, v100, v101
    v_cvt_pk_bf16_f32 v48, v104, v105
    v_cvt_pk_bf16_f32 v52, v108, v109
    s_add_u32 s65, s64, 98304
    buffer_load_dwordx4 v[224:227], v8, s[52:55], s65 offen sc1
    buffer_load_dwordx4 v[228:231], v9, s[52:55], s65 offen offset:1024 sc1
    v_cvt_pk_bf16_f32 v41, v98, v99
    v_cvt_pk_bf16_f32 v45, v102, v103
    v_cvt_pk_bf16_f32 v49, v106, v107
    v_cvt_pk_bf16_f32 v53, v110, v111
    s_add_u32 s65, s64, 106496
    buffer_load_dwordx4 v[232:235], v8, s[52:55], s65 offen sc1
    buffer_load_dwordx4 v[236:239], v9, s[52:55], s65 offen offset:1024 sc1
    v_cvt_pk_bf16_f32 v42, v68, v69
    v_cvt_pk_bf16_f32 v46, v76, v77
    v_cvt_pk_bf16_f32 v50, v84, v85
    v_cvt_pk_bf16_f32 v54, v92, v93
    s_add_u32 s65, s64, 114688
    buffer_load_dwordx4 v[240:243], v8, s[52:55], s65 offen sc1
    buffer_load_dwordx4 v[244:247], v9, s[52:55], s65 offen offset:1024 sc1
    v_cvt_pk_bf16_f32 v43, v70, v71
    v_cvt_pk_bf16_f32 v47, v78, v79
    v_cvt_pk_bf16_f32 v51, v86, v87
    v_cvt_pk_bf16_f32 v55, v94, v95
    s_add_u32 s65, s64, 122880
    buffer_load_dwordx4 v[248:251], v8, s[52:55], s65 offen sc1
    buffer_load_dwordx4 v[252:255], v9, s[52:55], s65 offen offset:1024 sc1
    s_lshl_b32 s66, s5, 10
    s_lshr_b32 s7, s6, 4
    s_mul_i32 s7, s7, 16384
    s_add_u32 s7, s7, s66
    v_lshrrev_b32 v10, 1, v4
    v_lshlrev_b32 v10, 8, v10
    v_lshl_add_u32 v10, v3, 4, v10
    v_and_b32 v11, 1, v4
    v_lshl_add_u32 v10, v11, 3, v10
    v_add_u32 v10, s7, v10
    v_add_u32 v11, 16384, v10
    s_lshr_b32 s7, s3, 1
    s_lshl_b32 s7, s7, 11
    s_and_b32 s8, s3, 1
    s_lshl_b32 s8, s8, 3
    s_add_u32 s7, s7, s8
    v_add_u32 v5, s7, v8
    s_waitcnt vmcnt(24)
    v_pk_add_f32 v[128:129], v[128:129], v[136:137]
    v_pk_add_f32 v[130:131], v[130:131], v[138:139]
    v_pk_add_f32 v[132:133], v[132:133], v[140:141]
    v_pk_add_f32 v[134:135], v[134:135], v[142:143]
    v_pk_add_f32 v[144:145], v[144:145], v[152:153]
    v_pk_add_f32 v[146:147], v[146:147], v[154:155]
    v_pk_add_f32 v[148:149], v[148:149], v[156:157]
    v_pk_add_f32 v[150:151], v[150:151], v[158:159]
    v_pk_add_f32 v[128:129], v[128:129], v[144:145]
    v_pk_add_f32 v[130:131], v[130:131], v[146:147]
    v_pk_add_f32 v[132:133], v[132:133], v[148:149]
    v_pk_add_f32 v[134:135], v[134:135], v[150:151]
    s_waitcnt vmcnt(16)
    v_pk_add_f32 v[160:161], v[160:161], v[168:169]
    v_pk_add_f32 v[162:163], v[162:163], v[170:171]
    v_pk_add_f32 v[164:165], v[164:165], v[172:173]
    v_pk_add_f32 v[166:167], v[166:167], v[174:175]
    v_pk_add_f32 v[176:177], v[176:177], v[184:185]
    v_pk_add_f32 v[178:179], v[178:179], v[186:187]
    v_pk_add_f32 v[180:181], v[180:181], v[188:189]
    v_pk_add_f32 v[182:183], v[182:183], v[190:191]
    v_pk_add_f32 v[160:161], v[160:161], v[176:177]
    v_pk_add_f32 v[162:163], v[162:163], v[178:179]
    v_pk_add_f32 v[164:165], v[164:165], v[180:181]
    v_pk_add_f32 v[166:167], v[166:167], v[182:183]
    s_waitcnt vmcnt(8)
    v_pk_add_f32 v[192:193], v[192:193], v[200:201]
    v_pk_add_f32 v[194:195], v[194:195], v[202:203]
    v_pk_add_f32 v[196:197], v[196:197], v[204:205]
    v_pk_add_f32 v[198:199], v[198:199], v[206:207]
    v_pk_add_f32 v[208:209], v[208:209], v[216:217]
    v_pk_add_f32 v[210:211], v[210:211], v[218:219]
    v_pk_add_f32 v[212:213], v[212:213], v[220:221]
    v_pk_add_f32 v[214:215], v[214:215], v[222:223]
    v_pk_add_f32 v[192:193], v[192:193], v[208:209]
    v_pk_add_f32 v[194:195], v[194:195], v[210:211]
    v_pk_add_f32 v[196:197], v[196:197], v[212:213]
    v_pk_add_f32 v[198:199], v[198:199], v[214:215]
    s_waitcnt vmcnt(0)
    v_pk_add_f32 v[224:225], v[224:225], v[232:233]
    v_pk_add_f32 v[226:227], v[226:227], v[234:235]
    v_pk_add_f32 v[228:229], v[228:229], v[236:237]
    v_pk_add_f32 v[230:231], v[230:231], v[238:239]
    v_pk_add_f32 v[240:241], v[240:241], v[248:249]
    v_pk_add_f32 v[242:243], v[242:243], v[250:251]
    v_pk_add_f32 v[244:245], v[244:245], v[252:253]
    v_pk_add_f32 v[246:247], v[246:247], v[254:255]
    v_pk_add_f32 v[224:225], v[224:225], v[240:241]
    v_pk_add_f32 v[226:227], v[226:227], v[242:243]
    v_pk_add_f32 v[228:229], v[228:229], v[244:245]
    v_pk_add_f32 v[230:231], v[230:231], v[246:247]
    v_pk_add_f32 v[128:129], v[128:129], v[160:161]
    v_pk_add_f32 v[130:131], v[130:131], v[162:163]
    v_pk_add_f32 v[132:133], v[132:133], v[164:165]
    v_pk_add_f32 v[134:135], v[134:135], v[166:167]
    v_pk_add_f32 v[192:193], v[192:193], v[224:225]
    v_pk_add_f32 v[194:195], v[194:195], v[226:227]
    v_pk_add_f32 v[196:197], v[196:197], v[228:229]
    v_pk_add_f32 v[198:199], v[198:199], v[230:231]
    v_pk_add_f32 v[128:129], v[128:129], v[192:193]
    v_pk_add_f32 v[130:131], v[130:131], v[194:195]
    v_pk_add_f32 v[132:133], v[132:133], v[196:197]
    v_pk_add_f32 v[134:135], v[134:135], v[198:199]
    v_cvt_pk_bf16_f32 v64, v128, v129
    v_cvt_pk_bf16_f32 v65, v130, v131
    v_cvt_pk_bf16_f32 v66, v132, v133
    v_cvt_pk_bf16_f32 v67, v134, v135
    ds_write_b64 v5, v[64:65] offset:32768
    ds_write_b64 v5, v[66:67] offset:33792
    s_waitcnt lgkmcnt(0)
    s_barrier
    ds_read_b128 v[64:67], v8 offset:32768
    ds_read_b128 v[68:71], v8 offset:33792
    ds_read_b128 v[72:75], v8 offset:34816
    ds_read_b128 v[76:79], v8 offset:35840
    s_waitcnt lgkmcnt(0)
    v_mfma_f32_16x16x32_bf16 v[96:99], v[64:67], v[40:43], 0
    v_mfma_f32_16x16x32_bf16 v[144:147], v[68:71], v[40:43], 0
    v_mfma_f32_16x16x32_bf16 v[100:103], v[64:67], v[44:47], 0
    v_mfma_f32_16x16x32_bf16 v[148:151], v[68:71], v[44:47], 0
    v_mfma_f32_16x16x32_bf16 v[104:107], v[72:75], v[48:51], 0
    v_mfma_f32_16x16x32_bf16 v[152:155], v[76:79], v[48:51], 0
    v_mfma_f32_16x16x32_bf16 v[108:111], v[72:75], v[52:55], 0
    v_mfma_f32_16x16x32_bf16 v[156:159], v[76:79], v[52:55], 0
    s_nop 7
    v_add_f32 v144, 0x358637bd, v144
    v_add_f32 v148, 0x358637bd, v148
    v_add_f32 v152, 0x358637bd, v152
    v_add_f32 v156, 0x358637bd, v156
    v_rcp_f32 v144, v144
    v_rcp_f32 v148, v148
    v_rcp_f32 v152, v152
    v_rcp_f32 v156, v156
    v_mul_f32 v96, v96, v144
    v_mul_f32 v100, v100, v148
    v_mul_f32 v104, v104, v152
    v_mul_f32 v108, v108, v156
    v_mul_f32 v97, v97, v144
    v_mul_f32 v101, v101, v148
    v_mul_f32 v105, v105, v152
    v_mul_f32 v109, v109, v156
    v_mul_f32 v98, v98, v144
    v_mul_f32 v102, v102, v148
    v_mul_f32 v106, v106, v152
    v_mul_f32 v110, v110, v156
    v_mul_f32 v99, v99, v144
    v_mul_f32 v103, v103, v148
    v_mul_f32 v107, v107, v152
    v_mul_f32 v111, v111, v156
    v_cvt_pk_bf16_f32 v96, v96, v97
    v_cvt_pk_bf16_f32 v100, v100, v101
    v_cvt_pk_bf16_f32 v104, v104, v105
    v_cvt_pk_bf16_f32 v108, v108, v109
    v_cvt_pk_bf16_f32 v97, v98, v99
    v_cvt_pk_bf16_f32 v101, v102, v103
    v_cvt_pk_bf16_f32 v105, v106, v107
    v_cvt_pk_bf16_f32 v109, v110, v111
    buffer_store_dwordx2 v[96:97], v10, s[56:59], 0 offen offset:0
    buffer_store_dwordx2 v[100:101], v11, s[56:59], 0 offen offset:0
    buffer_store_dwordx2 v[104:105], v10, s[56:59], 0 offen offset:512
    buffer_store_dwordx2 v[108:109], v11, s[56:59], 0 offen offset:512
k1_kernel_fin:
k1_kernel_end:
    s_endpgm
.globl k2a_kernel
.p2align 8
.type k2a_kernel,@function
k2a_kernel:
    s_cmp_ge_u32 s2, 256
    s_cbranch_scc1 k2a_kernel_end
    s_load_dwordx16 s[16:31], s[0:1], 0
    s_load_dwordx8 s[32:39], s[0:1], 64
    v_and_b32 v1, 63, v0
    v_lshrrev_b32 v2, 6, v0
    v_and_b32 v3, 15, v0
    v_readfirstlane_b32 s3, v2
    v_lshrrev_b32 v4, 4, v1
    s_and_b32 s4, s2, 7
    s_lshl_b32 s4, s4, 1
    s_bfe_u32 s5, s2, 0x10003
    s_add_u32 s4, s4, s5
    s_lshr_b32 s5, s2, 4
    s_lshl_b32 s6, s4, 7
    s_lshl_b32 s7, s3, 5
    s_add_u32 s6, s6, s7
    s_waitcnt lgkmcnt(0)
    s_add_u32 s40, s38, 2097152
    s_addc_u32 s41, s39, 0
    s_mov_b32 s42, 2097152
    s_mov_b32 s43, 0x20000
    s_add_u32 s44, s38, 20447232
    s_addc_u32 s45, s39, 0
    s_mov_b32 s46, 524288
    s_mov_b32 s47, 0x20000
    s_mov_b32 s48, s16
    s_mov_b32 s49, s17
    s_mov_b32 s50, 2097152
    s_mov_b32 s51, 0x20000
    s_add_u32 s52, s38, 4194304
    s_addc_u32 s53, s39, 0
    s_mov_b32 s54, 2097152
    s_mov_b32 s55, 0x20000
    s_lshl_b32 s64, s5, 6
    s_lshl_b32 s9, s3, 10
    s_mul_i32 s10, s5, 32768
    s_add_u32 s10, s10, s9
    v_lshlrev_b32 v12, 4, v1
    s_lshr_b32 s7, s6, 4
    s_mul_i32 s7, s7, 16384
    v_lshlrev_b32 v10, 4, v1
    v_add_u32 v10, s7, v10
    s_add_u32 m0, s9, 0
    s_add_u32 s8, s10, 0
    buffer_load_dwordx4 v12, s[44:47], s8 offen lds
    s_add_u32 m0, s9, 4096
    s_add_u32 s8, s10, 4096
    buffer_load_dwordx4 v12, s[44:47], s8 offen lds
    s_add_u32 m0, s9, 8192
    s_add_u32 s8, s10, 8192
    buffer_load_dwordx4 v12, s[44:47], s8 offen lds
    s_add_u32 m0, s9, 12288
    s_add_u32 s8, s10, 12288
    buffer_load_dwordx4 v12, s[44:47], s8 offen lds
    s_add_u32 m0, s9, 16384
    s_add_u32 s8, s10, 16384
    buffer_load_dwordx4 v12, s[44:47], s8 offen lds
    s_add_u32 m0, s9, 20480
    s_add_u32 s8, s10, 20480
    buffer_load_dwordx4 v12, s[44:47], s8 offen lds
    s_add_u32 m0, s9, 24576
    s_add_u32 s8, s10, 24576
    buffer_load_dwordx4 v12, s[44:47], s8 offen lds
    s_add_u32 m0, s9, 28672
    s_add_u32 s8, s10, 28672
    buffer_load_dwordx4 v12, s[44:47], s8 offen lds
    s_mov_b32 s76, 0
    buffer_load_dwordx4 v[80:83], v10, s[40:43], s76 offen offset:0
    s_mov_b32 s77, 16384
    buffer_load_dwordx4 v[84:87], v10, s[40:43], s77 offen offset:0
    buffer_load_dwordx4 v[88:91], v10, s[40:43], s76 offen offset:1024
    buffer_load_dwordx4 v[92:95], v10, s[40:43], s77 offen offset:1024
    buffer_load_dwordx4 v[96:99], v10, s[40:43], s76 offen offset:2048
    buffer_load_dwordx4 v[100:103], v10, s[40:43], s77 offen offset:2048
    buffer_load_dwordx4 v[104:107], v10, s[40:43], s76 offen offset:3072
    buffer_load_dwordx4 v[108:111], v10, s[40:43], s77 offen offset:3072
    s_mov_b32 s76, 4096
    buffer_load_dwordx4 v[112:115], v10, s[40:43], s76 offen offset:0
    s_mov_b32 s77, 20480
    buffer_load_dwordx4 v[116:119], v10, s[40:43], s77 offen offset:0
    buffer_load_dwordx4 v[120:123], v10, s[40:43], s76 offen offset:1024
    buffer_load_dwordx4 v[124:127], v10, s[40:43], s77 offen offset:1024
    v_add_u32 v14, s6, v3
    s_movk_i32 s7, 1024
    v_mul_lo_u32 v14, v14, s7
    v_lshl_add_u32 v14, v4, 3, v14
    v_add_u32 v14, s64, v14
    v_add_u32 v15, 16384, v14
    s_lshl_b32 s66, s5, 10
    s_lshr_b32 s7, s6, 4
    s_mul_i32 s7, s7, 16384
    s_add_u32 s7, s7, s66
    v_lshrrev_b32 v18, 1, v4
    v_lshlrev_b32 v18, 8, v18
    v_lshl_add_u32 v18, v3, 4, v18
    v_and_b32 v19, 1, v4
    v_lshl_add_u32 v18, v19, 3, v18
    v_add_u32 v18, s7, v18
    v_add_u32 v19, 16384, v18
    v_bfe_u32 v6, v1, 2, 2
    v_lshl_add_u32 v6, v4, 3, v6
    v_lshlrev_b32 v6, 6, v6
    v_and_b32 v7, 3, v1
    v_lshl_add_u32 v6, v7, 3, v6
    v_and_b32 v7, 1, v4
    v_lshl_add_u32 v16, v7, 5, v6
    v_xor_b32 v17, 32, v16
    v_cmp_gt_u32 vcc, 2, v4
    s_waitcnt vmcnt(12)
    s_barrier
    ds_read_b64_tr_b16 v[48:49], v16 offset:0
    ds_read_b64_tr_b16 v[50:51], v16 offset:256
    ds_read_b64_tr_b16 v[52:53], v17 offset:0
    ds_read_b64_tr_b16 v[54:55], v17 offset:256
    s_waitcnt vmcnt(10)
    s_waitcnt lgkmcnt(0)
    ds_read_b64_tr_b16 v[56:57], v16 offset:2048
    ds_read_b64_tr_b16 v[58:59], v16 offset:2304
    v_mfma_f32_16x16x32_bf16 v[32:35], v[48:51], v[80:83], 0
    ds_read_b64_tr_b16 v[60:61], v17 offset:2048
    v_mfma_f32_16x16x32_bf16 v[36:39], v[48:51], v[84:87], 0
    ds_read_b64_tr_b16 v[62:63], v17 offset:2304
    v_mfma_f32_16x16x32_bf16 v[40:43], v[52:55], v[80:83], 0
    buffer_load_dwordx4 v[128:131], v10, s[40:43], s76 offen offset:2048
    v_mfma_f32_16x16x32_bf16 v[44:47], v[52:55], v[84:87], 0
    buffer_load_dwordx4 v[132:135], v10, s[40:43], s77 offen offset:2048
    s_waitcnt vmcnt(10)
    s_waitcnt lgkmcnt(0)
    ds_read_b64_tr_b16 v[48:49], v16 offset:4096
    ds_read_b64_tr_b16 v[50:51], v16 offset:4352
    v_mfma_f32_16x16x32_bf16 v[32:35], v[56:59], v[88:91], v[32:35]
    ds_read_b64_tr_b16 v[52:53], v17 offset:4096
    v_mfma_f32_16x16x32_bf16 v[36:39], v[56:59], v[92:95], v[36:39]
    ds_read_b64_tr_b16 v[54:55], v17 offset:4352
    v_mfma_f32_16x16x32_bf16 v[40:43], v[60:63], v[88:91], v[40:43]
    buffer_load_dwordx4 v[136:139], v10, s[40:43], s76 offen offset:3072
    v_mfma_f32_16x16x32_bf16 v[44:47], v[60:63], v[92:95], v[44:47]
    buffer_load_dwordx4 v[140:143], v10, s[40:43], s77 offen offset:3072
    s_waitcnt vmcnt(10)
    s_waitcnt lgkmcnt(0)
    ds_read_b64_tr_b16 v[56:57], v16 offset:6144
    ds_read_b64_tr_b16 v[58:59], v16 offset:6400
    v_mfma_f32_16x16x32_bf16 v[32:35], v[48:51], v[96:99], v[32:35]
    ds_read_b64_tr_b16 v[60:61], v17 offset:6144
    v_mfma_f32_16x16x32_bf16 v[36:39], v[48:51], v[100:103], v[36:39]
    ds_read_b64_tr_b16 v[62:63], v17 offset:6400
    s_mov_b32 s76, 8192
    v_mfma_f32_16x16x32_bf16 v[40:43], v[52:55], v[96:99], v[40:43]
    buffer_load_dwordx4 v[144:147], v10, s[40:43], s76 offen offset:0
    v_mfma_f32_16x16x32_bf16 v[44:47], v[52:55], v[100:103], v[44:47]
    s_mov_b32 s77, 24576
    buffer_load_dwordx4 v[148:151], v10, s[40:43], s77 offen offset:0
    s_waitcnt vmcnt(10)
    s_waitcnt lgkmcnt(0)
    ds_read_b64_tr_b16 v[48:49], v16 offset:8192
    ds_read_b64_tr_b16 v[50:51], v16 offset:8448
    v_mfma_f32_16x16x32_bf16 v[32:35], v[56:59], v[104:107], v[32:35]
    ds_read_b64_tr_b16 v[52:53], v17 offset:8192
    v_mfma_f32_16x16x32_bf16 v[36:39], v[56:59], v[108:111], v[36:39]
    ds_read_b64_tr_b16 v[54:55], v17 offset:8448
    v_mfma_f32_16x16x32_bf16 v[40:43], v[60:63], v[104:107], v[40:43]
    buffer_load_dwordx4 v[152:155], v10, s[40:43], s76 offen offset:1024
    v_mfma_f32_16x16x32_bf16 v[44:47], v[60:63], v[108:111], v[44:47]
    buffer_load_dwordx4 v[156:159], v10, s[40:43], s77 offen offset:1024
    s_waitcnt vmcnt(10)
    s_waitcnt lgkmcnt(0)
    ds_read_b64_tr_b16 v[56:57], v16 offset:10240
    ds_read_b64_tr_b16 v[58:59], v16 offset:10496
    v_mfma_f32_16x16x32_bf16 v[32:35], v[48:51], v[112:115], v[32:35]
    ds_read_b64_tr_b16 v[60:61], v17 offset:10240
    v_mfma_f32_16x16x32_bf16 v[36:39], v[48:51], v[116:119], v[36:39]
    ds_read_b64_tr_b16 v[62:63], v17 offset:10496
    v_mfma_f32_16x16x32_bf16 v[40:43], v[52:55], v[112:115], v[40:43]
    buffer_load_dwordx4 v[160:163], v10, s[40:43], s76 offen offset:2048
    v_mfma_f32_16x16x32_bf16 v[44:47], v[52:55], v[116:119], v[44:47]
    buffer_load_dwordx4 v[164:167], v10, s[40:43], s77 offen offset:2048
    s_waitcnt vmcnt(10)
    s_waitcnt lgkmcnt(0)
    ds_read_b64_tr_b16 v[48:49], v16 offset:12288
    ds_read_b64_tr_b16 v[50:51], v16 offset:12544
    v_mfma_f32_16x16x32_bf16 v[32:35], v[56:59], v[120:123], v[32:35]
    ds_read_b64_tr_b16 v[52:53], v17 offset:12288
    v_mfma_f32_16x16x32_bf16 v[36:39], v[56:59], v[124:127], v[36:39]
    ds_read_b64_tr_b16 v[54:55], v17 offset:12544
    v_mfma_f32_16x16x32_bf16 v[40:43], v[60:63], v[120:123], v[40:43]
    buffer_load_dwordx4 v[168:171], v10, s[40:43], s76 offen offset:3072
    v_mfma_f32_16x16x32_bf16 v[44:47], v[60:63], v[124:127], v[44:47]
    buffer_load_dwordx4 v[172:175], v10, s[40:43], s77 offen offset:3072
    s_waitcnt vmcnt(10)
    s_waitcnt lgkmcnt(0)
    ds_read_b64_tr_b16 v[56:57], v16 offset:14336
    ds_read_b64_tr_b16 v[58:59], v16 offset:14592
    v_mfma_f32_16x16x32_bf16 v[32:35], v[48:51], v[128:131], v[32:35]
    ds_read_b64_tr_b16 v[60:61], v17 offset:14336
    v_mfma_f32_16x16x32_bf16 v[36:39], v[48:51], v[132:135], v[36:39]
    ds_read_b64_tr_b16 v[62:63], v17 offset:14592
    s_mov_b32 s76, 12288
    v_mfma_f32_16x16x32_bf16 v[40:43], v[52:55], v[128:131], v[40:43]
    buffer_load_dwordx4 v[176:179], v10, s[40:43], s76 offen offset:0
    v_mfma_f32_16x16x32_bf16 v[44:47], v[52:55], v[132:135], v[44:47]
    s_mov_b32 s77, 28672
    buffer_load_dwordx4 v[180:183], v10, s[40:43], s77 offen offset:0
    s_waitcnt vmcnt(10)
    s_waitcnt lgkmcnt(0)
    ds_read_b64_tr_b16 v[48:49], v16 offset:16384
    ds_read_b64_tr_b16 v[50:51], v16 offset:16640
    v_mfma_f32_16x16x32_bf16 v[32:35], v[56:59], v[136:139], v[32:35]
    ds_read_b64_tr_b16 v[52:53], v17 offset:16384
    v_mfma_f32_16x16x32_bf16 v[36:39], v[56:59], v[140:143], v[36:39]
    ds_read_b64_tr_b16 v[54:55], v17 offset:16640
    v_mfma_f32_16x16x32_bf16 v[40:43], v[60:63], v[136:139], v[40:43]
    buffer_load_dwordx4 v[184:187], v10, s[40:43], s76 offen offset:1024
    v_mfma_f32_16x16x32_bf16 v[44:47], v[60:63], v[140:143], v[44:47]
    buffer_load_dwordx4 v[188:191], v10, s[40:43], s77 offen offset:1024
    s_waitcnt vmcnt(10)
    s_waitcnt lgkmcnt(0)
    ds_read_b64_tr_b16 v[56:57], v16 offset:18432
    ds_read_b64_tr_b16 v[58:59], v16 offset:18688
    v_mfma_f32_16x16x32_bf16 v[32:35], v[48:51], v[144:147], v[32:35]
    ds_read_b64_tr_b16 v[60:61], v17 offset:18432
    v_mfma_f32_16x16x32_bf16 v[36:39], v[48:51], v[148:151], v[36:39]
    ds_read_b64_tr_b16 v[62:63], v17 offset:18688
    v_mfma_f32_16x16x32_bf16 v[40:43], v[52:55], v[144:147], v[40:43]
    buffer_load_dwordx4 v[192:195], v10, s[40:43], s76 offen offset:2048
    v_mfma_f32_16x16x32_bf16 v[44:47], v[52:55], v[148:151], v[44:47]
    buffer_load_dwordx4 v[196:199], v10, s[40:43], s77 offen offset:2048
    s_waitcnt vmcnt(10)
    s_waitcnt lgkmcnt(0)
    ds_read_b64_tr_b16 v[48:49], v16 offset:20480
    ds_read_b64_tr_b16 v[50:51], v16 offset:20736
    v_mfma_f32_16x16x32_bf16 v[32:35], v[56:59], v[152:155], v[32:35]
    ds_read_b64_tr_b16 v[52:53], v17 offset:20480
    v_mfma_f32_16x16x32_bf16 v[36:39], v[56:59], v[156:159], v[36:39]
    ds_read_b64_tr_b16 v[54:55], v17 offset:20736
    v_mfma_f32_16x16x32_bf16 v[40:43], v[60:63], v[152:155], v[40:43]
    buffer_load_dwordx4 v[200:203], v10, s[40:43], s76 offen offset:3072
    v_mfma_f32_16x16x32_bf16 v[44:47], v[60:63], v[156:159], v[44:47]
    buffer_load_dwordx4 v[204:207], v10, s[40:43], s77 offen offset:3072
    s_waitcnt vmcnt(10)
    s_waitcnt lgkmcnt(0)
    ds_read_b64_tr_b16 v[56:57], v16 offset:22528
    ds_read_b64_tr_b16 v[58:59], v16 offset:22784
    v_mfma_f32_16x16x32_bf16 v[32:35], v[48:51], v[160:163], v[32:35]
    ds_read_b64_tr_b16 v[60:61], v17 offset:22528
    v_mfma_f32_16x16x32_bf16 v[36:39], v[48:51], v[164:167], v[36:39]
    ds_read_b64_tr_b16 v[62:63], v17 offset:22784
    buffer_load_dwordx2 v[20:21], v14, s[48:51], 0 offen offset:0
    v_mfma_f32_16x16x32_bf16 v[40:43], v[52:55], v[160:163], v[40:43]
    buffer_load_dwordx2 v[22:23], v15, s[48:51], 0 offen offset:0
    v_mfma_f32_16x16x32_bf16 v[44:47], v[52:55], v[164:167], v[44:47]
    buffer_load_dwordx2 v[24:25], v14, s[48:51], 0 offen offset:32
    buffer_load_dwordx2 v[26:27], v15, s[48:51], 0 offen offset:32
    s_waitcnt vmcnt(12)
    s_waitcnt lgkmcnt(0)
    ds_read_b64_tr_b16 v[48:49], v16 offset:24576
    ds_read_b64_tr_b16 v[50:51], v16 offset:24832
    v_mfma_f32_16x16x32_bf16 v[32:35], v[56:59], v[168:171], v[32:35]
    v_mfma_f32_16x16x32_bf16 v[36:39], v[56:59], v[172:175], v[36:39]
    ds_read_b64_tr_b16 v[52:53], v17 offset:24576
    v_mfma_f32_16x16x32_bf16 v[40:43], v[60:63], v[168:171], v[40:43]
    v_mfma_f32_16x16x32_bf16 v[44:47], v[60:63], v[172:175], v[44:47]
    ds_read_b64_tr_b16 v[54:55], v17 offset:24832
    s_waitcnt vmcnt(10)
    s_waitcnt lgkmcnt(0)
    ds_read_b64_tr_b16 v[56:57], v16 offset:26624
    ds_read_b64_tr_b16 v[58:59], v16 offset:26880
    v_mfma_f32_16x16x32_bf16 v[32:35], v[48:51], v[176:179], v[32:35]
    v_mfma_f32_16x16x32_bf16 v[36:39], v[48:51], v[180:183], v[36:39]
    ds_read_b64_tr_b16 v[60:61], v17 offset:26624
    v_mfma_f32_16x16x32_bf16 v[40:43], v[52:55], v[176:179], v[40:43]
    v_mfma_f32_16x16x32_bf16 v[44:47], v[52:55], v[180:183], v[44:47]
    ds_read_b64_tr_b16 v[62:63], v17 offset:26880
    s_waitcnt vmcnt(8)
    s_waitcnt lgkmcnt(0)
    ds_read_b64_tr_b16 v[48:49], v16 offset:28672
    ds_read_b64_tr_b16 v[50:51], v16 offset:28928
    v_mfma_f32_16x16x32_bf16 v[32:35], v[56:59], v[184:187], v[32:35]
    v_mfma_f32_16x16x32_bf16 v[36:39], v[56:59], v[188:191], v[36:39]
    ds_read_b64_tr_b16 v[52:53], v17 offset:28672
    v_mfma_f32_16x16x32_bf16 v[40:43], v[60:63], v[184:187], v[40:43]
    v_mfma_f32_16x16x32_bf16 v[44:47], v[60:63], v[188:191], v[44:47]
    ds_read_b64_tr_b16 v[54:55], v17 offset:28928
    s_waitcnt vmcnt(6)
    s_waitcnt lgkmcnt(0)
    ds_read_b64_tr_b16 v[56:57], v16 offset:30720
    ds_read_b64_tr_b16 v[58:59], v16 offset:30976
    v_mfma_f32_16x16x32_bf16 v[32:35], v[48:51], v[192:195], v[32:35]
    v_mfma_f32_16x16x32_bf16 v[36:39], v[48:51], v[196:199], v[36:39]
    ds_read_b64_tr_b16 v[60:61], v17 offset:30720
    v_mfma_f32_16x16x32_bf16 v[40:43], v[52:55], v[192:195], v[40:43]
    v_mfma_f32_16x16x32_bf16 v[44:47], v[52:55], v[196:199], v[44:47]
    ds_read_b64_tr_b16 v[62:63], v17 offset:30976
    s_waitcnt vmcnt(4)
    s_waitcnt lgkmcnt(0)
    v_mfma_f32_16x16x32_bf16 v[32:35], v[56:59], v[200:203], v[32:35]
    v_mfma_f32_16x16x32_bf16 v[36:39], v[56:59], v[204:207], v[36:39]
    v_mfma_f32_16x16x32_bf16 v[40:43], v[60:63], v[200:203], v[40:43]
    v_mfma_f32_16x16x32_bf16 v[44:47], v[60:63], v[204:207], v[44:47]
    s_waitcnt vmcnt(0)
    s_nop 7
    v_lshlrev_b32 v64, 16, v20
    v_lshlrev_b32 v68, 16, v22
    v_lshlrev_b32 v72, 16, v24
    v_lshlrev_b32 v76, 16, v26
    v_and_b32 v65, 0xffff0000, v20
    v_and_b32 v69, 0xffff0000, v22
    v_and_b32 v73, 0xffff0000, v24
    v_and_b32 v77, 0xffff0000, v26
    v_lshlrev_b32 v66, 16, v21
    v_lshlrev_b32 v70, 16, v23
    v_lshlrev_b32 v74, 16, v25
    v_lshlrev_b32 v78, 16, v27
    v_and_b32 v67, 0xffff0000, v21
    v_and_b32 v71, 0xffff0000, v23
    v_and_b32 v75, 0xffff0000, v25
    v_and_b32 v79, 0xffff0000, v27
    v_add_f32 v32, v32, v64
    v_add_f32 v36, v36, v68
    v_add_f32 v40, v40, v72
    v_add_f32 v44, v44, v76
    v_add_f32 v33, v33, v65
    v_add_f32 v37, v37, v69
    v_add_f32 v41, v41, v73
    v_add_f32 v45, v45, v77
    v_add_f32 v34, v34, v66
    v_add_f32 v38, v38, v70
    v_add_f32 v42, v42, v74
    v_add_f32 v46, v46, v78
    v_add_f32 v35, v35, v67
    v_add_f32 v39, v39, v71
    v_add_f32 v43, v43, v75
    v_add_f32 v47, v47, v79
    v_cvt_pk_bf16_f32 v32, v32, v33
    v_cvt_pk_bf16_f32 v36, v36, v37
    v_cvt_pk_bf16_f32 v40, v40, v41
    v_cvt_pk_bf16_f32 v44, v44, v45
    v_cvt_pk_bf16_f32 v33, v34, v35
    v_cvt_pk_bf16_f32 v37, v38, v39
    v_cvt_pk_bf16_f32 v41, v42, v43
    v_cvt_pk_bf16_f32 v45, v46, v47
    buffer_store_dwordx2 v[32:33], v18, s[52:55], 0 offen offset:0
    buffer_store_dwordx2 v[36:37], v19, s[52:55], 0 offen offset:0
    buffer_store_dwordx2 v[40:41], v18, s[52:55], 0 offen offset:512
    buffer_store_dwordx2 v[44:45], v19, s[52:55], 0 offen offset:512
k2a_kernel_fin:
k2a_kernel_end:
    s_endpgm
.globl k2b_kernel
.p2align 8
.type k2b_kernel,@function
k2b_kernel:
    s_cmp_ge_u32 s2, 256
    s_cbranch_scc1 k2b_kernel_end
    s_load_dwordx16 s[16:31], s[0:1], 0
    s_load_dwordx8 s[32:39], s[0:1], 64
    v_and_b32 v1, 63, v0
    v_lshrrev_b32 v2, 6, v0
    v_and_b32 v3, 15, v0
    v_readfirstlane_b32 s3, v2
    v_lshrrev_b32 v4, 4, v1
    s_and_b32 s4, s2, 7
    s_lshl_b32 s4, s4, 1
    s_bfe_u32 s5, s2, 0x10003
    s_add_u32 s4, s4, s5
    s_lshr_b32 s5, s2, 4
    s_lshl_b32 s6, s4, 7
    s_lshl_b32 s7, s3, 5
    s_add_u32 s6, s6, s7
    s_waitcnt lgkmcnt(0)
    s_cmp_lt_u32 s2, 240
    s_cbranch_scc1 k2b_main
    s_mov_b32 s40, s28
    s_mov_b32 s41, s29
    s_mov_b32 s42, 8388608
    s_mov_b32 s43, 0x20000
    s_and_b32 s7, s2, 7
    s_lshl_b32 s7, s7, 20
    s_bfe_u32 s8, s2, 0x10003
    s_mul_i32 s8, s8, 229376
    s_add_u32 s7, s7, s8
    s_lshl_b32 s8, s3, 12
    s_add_u32 s7, s7, s8
    s_add_u32 s7, s7, 589824
    v_lshlrev_b32 v12, 4, v1
    s_mov_b32 s8, 14
k2b_pf:
    buffer_load_dwordx4 v[128:131], v12, s[40:43], s7 offen offset:0
    buffer_load_dwordx4 v[132:135], v12, s[40:43], s7 offen offset:1024
    buffer_load_dwordx4 v[136:139], v12, s[40:43], s7 offen offset:2048
    buffer_load_dwordx4 v[140:143], v12, s[40:43], s7 offen offset:3072
    s_add_u32 s7, s7, 0x4000
    s_sub_u32 s8, s8, 1
    s_waitcnt vmcnt(56)
    s_cmp_lg_u32 s8, 0
    s_cbranch_scc1 k2b_pf
    s_waitcnt vmcnt(0)
    s_endpgm
k2b_main:
    s_add_u32 s40, s38, 4194304
    s_addc_u32 s41, s39, 0
    s_mov_b32 s42, 2097152
    s_mov_b32 s43, 0x20000
    s_add_u32 s44, s38, 18874368
    s_addc_u32 s45, s39, 0
    s_mov_b32 s46, 1572864
    s_mov_b32 s47, 0x20000
    s_add_u32 s48, s38, 6291456
    s_addc_u32 s49, s39, 0
    s_mov_b32 s50, 2883584
    s_mov_b32 s51, 0x20000
    s_add_u32 s52, s38, 9437184
    s_addc_u32 s53, s39, 0
    s_mov_b32 s54, 2883584
    s_mov_b32 s55, 0x20000
    s_add_u32 s56, s38, 15728640
    s_addc_u32 s57, s39, 0
    s_mov_b32 s58, 262144
    s_mov_b32 s59, 0x20000
    s_mov_b32 s60, s36
    s_mov_b32 s61, s37
    s_mov_b32 s62, 256
    s_mov_b32 s63, 0x20000
    s_lshr_b32 s7, s6, 4
    s_mul_i32 s7, s7, 16384
    v_lshlrev_b32 v10, 4, v1
    v_add_u32 v10, s7, v10
    s_lshl_b32 s9, s3, 10
    s_mul_i32 s10, s5, 98304
    s_add_u32 s10, s10, s9
    v_lshlrev_b32 v12, 4, v1
    s_mov_b32 s76, 0
    buffer_load_dwordx4 v[128:131], v10, s[40:43], s76 offen offset:0
    buffer_load_dwordx4 v[136:139], v10, s[40:43], s76 offen offset:1024
    buffer_load_dwordx4 v[144:147], v10, s[40:43], s76 offen offset:2048
    buffer_load_dwordx4 v[152:155], v10, s[40:43], s76 offen offset:3072
    s_add_u32 m0, s9, 0
    s_add_u32 s8, s10, 0
    buffer_load_dwordx4 v12, s[44:47], s8 offen lds
    s_add_u32 m0, s9, 32768
    s_add_u32 s8, s10, 32768
    buffer_load_dwordx4 v12, s[44:47], s8 offen lds
    s_mov_b32 s77, 16384
    buffer_load_dwordx4 v[132:135], v10, s[40:43], s77 offen offset:0
    buffer_load_dwordx4 v[140:143], v10, s[40:43], s77 offen offset:1024
    buffer_load_dwordx4 v[148:151], v10, s[40:43], s77 offen offset:2048
    buffer_load_dwordx4 v[156:159], v10, s[40:43], s77 offen offset:3072
    s_add_u32 m0, s9, 4096
    s_add_u32 s8, s10, 4096
    buffer_load_dwordx4 v12, s[44:47], s8 offen lds
    s_add_u32 m0, s9, 36864
    s_add_u32 s8, s10, 36864
    buffer_load_dwordx4 v12, s[44:47], s8 offen lds
    s_mov_b32 s76, 4096
    buffer_load_dwordx4 v[160:163], v10, s[40:43], s76 offen offset:0
    buffer_load_dwordx4 v[168:171], v10, s[40:43], s76 offen offset:1024
    buffer_load_dwordx4 v[176:179], v10, s[40:43], s76 offen offset:2048
    buffer_load_dwordx4 v[184:187], v10, s[40:43], s76 offen offset:3072
    s_add_u32 m0, s9, 8192
    s_add_u32 s8, s10, 8192
    buffer_load_dwordx4 v12, s[44:47], s8 offen lds
    s_add_u32 m0, s9, 40960
    s_add_u32 s8, s10, 40960
    buffer_load_dwordx4 v12, s[44:47], s8 offen lds
    s_mov_b32 s77, 20480
    buffer_load_dwordx4 v[164:167], v10, s[40:43], s77 offen offset:0
    buffer_load_dwordx4 v[172:175], v10, s[40:43], s77 offen offset:1024
    buffer_load_dwordx4 v[180:183], v10, s[40:43], s77 offen offset:2048
    buffer_load_dwordx4 v[188:191], v10, s[40:43], s77 offen offset:3072
    s_add_u32 m0, s9, 12288
    s_add_u32 s8, s10, 12288
    buffer_load_dwordx4 v12, s[44:47], s8 offen lds
    s_add_u32 m0, s9, 45056
    s_add_u32 s8, s10, 45056
    buffer_load_dwordx4 v12, s[44:47], s8 offen lds
    v_bfe_u32 v5, v1, 2, 2
    v_lshl_add_u32 v5, v4, 3, v5
    v_lshlrev_b32 v5, 6, v5
    v_and_b32 v6, 3, v1
    v_lshl_add_u32 v5, v6, 3, v5
    v_and_b32 v6, 1, v4
    v_lshl_add_u32 v16, v6, 5, v5
    v_xor_b32 v17, 32, v16
    v_add_u32 v18, 0x10000, v16
    v_add_u32 v19, 0x10000, v17
    s_mov_b32 s11, 0x3f803f80
    v_mov_b32 v56, s11
    v_mov_b32 v57, s11
    v_mov_b32 v58, s11
    v_mov_b32 v59, s11
    s_waitcnt vmcnt(20)
    s_waitcnt vmcnt(14)
    s_waitcnt vmcnt(12)
    s_barrier
    ds_read_b64_tr_b16 v[64:65], v16 offset:0
    ds_read_b64_tr_b16 v[66:67], v16 offset:256
    ds_read_b64_tr_b16 v[68:69], v17 offset:0
    ds_read_b64_tr_b16 v[70:71], v17 offset:256
    ds_read_b64_tr_b16 v[72:73], v16 offset:32768
    ds_read_b64_tr_b16 v[74:75], v16 offset:33024
    ds_read_b64_tr_b16 v[76:77], v17 offset:32768
    ds_read_b64_tr_b16 v[78:79], v17 offset:33024
    v_mfma_f32_16x16x32_bf16 v[20:23], v[56:59], v[128:131], 0
    v_mfma_f32_16x16x32_bf16 v[28:31], v[128:131], v[128:131], 0
    v_mfma_f32_16x16x32_bf16 v[24:27], v[56:59], v[132:135], 0
    v_mfma_f32_16x16x32_bf16 v[6:9], v[132:135], v[132:135], 0
    s_waitcnt lgkmcnt(0)
    v_mfma_f32_16x16x32_bf16 v[96:99], v[64:67], v[128:131], 0
    ds_read_b64_tr_b16 v[80:81], v16 offset:2048
    v_mfma_f32_16x16x32_bf16 v[100:103], v[64:67], v[132:135], 0
    ds_read_b64_tr_b16 v[82:83], v16 offset:2304
    v_mfma_f32_16x16x32_bf16 v[40:43], v[64:67], v[56:59], 0
    ds_read_b64_tr_b16 v[84:85], v17 offset:2048
    v_mfma_f32_16x16x32_bf16 v[104:107], v[68:71], v[128:131], 0
    ds_read_b64_tr_b16 v[86:87], v17 offset:2304
    ds_read_b64_tr_b16 v[88:89], v16 offset:34816
    v_mfma_f32_16x16x32_bf16 v[108:111], v[68:71], v[132:135], 0
    ds_read_b64_tr_b16 v[90:91], v16 offset:35072
    v_mfma_f32_16x16x32_bf16 v[44:47], v[68:71], v[56:59], 0
    ds_read_b64_tr_b16 v[92:93], v17 offset:34816
    v_mfma_f32_16x16x32_bf16 v[112:115], v[72:75], v[128:131], 0
    ds_read_b64_tr_b16 v[94:95], v17 offset:35072
    v_mfma_f32_16x16x32_bf16 v[116:119], v[72:75], v[132:135], 0
    s_mov_b32 s76, 8192
    buffer_load_dwordx4 v[192:195], v10, s[40:43], s76 offen offset:0
    v_mfma_f32_16x16x32_bf16 v[48:51], v[72:75], v[56:59], 0
    buffer_load_dwordx4 v[200:203], v10, s[40:43], s76 offen offset:1024
    v_mfma_f32_16x16x32_bf16 v[120:123], v[76:79], v[128:131], 0
    buffer_load_dwordx4 v[208:211], v10, s[40:43], s76 offen offset:2048
    v_mfma_f32_16x16x32_bf16 v[124:127], v[76:79], v[132:135], 0
    buffer_load_dwordx4 v[216:219], v10, s[40:43], s76 offen offset:3072
    v_mfma_f32_16x16x32_bf16 v[52:55], v[76:79], v[56:59], 0
    s_add_u32 m0, s9, 16384
    s_add_u32 s8, s10, 16384
    buffer_load_dwordx4 v12, s[44:47], s8 offen lds
    s_add_u32 m0, s9, 49152
    s_add_u32 s8, s10, 49152
    buffer_load_dwordx4 v12, s[44:47], s8 offen lds
    s_nop 1
    v_mfma_f32_16x16x32_bf16 v[20:23], v[56:59], v[136:139], v[20:23]
    v_mfma_f32_16x16x32_bf16 v[28:31], v[136:139], v[136:139], v[28:31]
    v_mfma_f32_16x16x32_bf16 v[24:27], v[56:59], v[140:143], v[24:27]
    v_mfma_f32_16x16x32_bf16 v[6:9], v[140:143], v[140:143], v[6:9]
    s_waitcnt lgkmcnt(0)
    v_mfma_f32_16x16x32_bf16 v[96:99], v[80:83], v[136:139], v[96:99]
    ds_read_b64_tr_b16 v[64:65], v16 offset:4096
    v_mfma_f32_16x16x32_bf16 v[100:103], v[80:83], v[140:143], v[100:103]
    ds_read_b64_tr_b16 v[66:67], v16 offset:4352
    v_mfma_f32_16x16x32_bf16 v[40:43], v[80:83], v[56:59], v[40:43]
    ds_read_b64_tr_b16 v[68:69], v17 offset:4096
    v_mfma_f32_16x16x32_bf16 v[104:107], v[84:87], v[136:139], v[104:107]
    ds_read_b64_tr_b16 v[70:71], v17 offset:4352
    ds_read_b64_tr_b16 v[72:73], v16 offset:36864
    v_mfma_f32_16x16x32_bf16 v[108:111], v[84:87], v[140:143], v[108:111]
    ds_read_b64_tr_b16 v[74:75], v16 offset:37120
    v_mfma_f32_16x16x32_bf16 v[44:47], v[84:87], v[56:59], v[44:47]
    ds_read_b64_tr_b16 v[76:77], v17 offset:36864
    v_mfma_f32_16x16x32_bf16 v[112:115], v[88:91], v[136:139], v[112:115]
    ds_read_b64_tr_b16 v[78:79], v17 offset:37120
    v_mfma_f32_16x16x32_bf16 v[116:119], v[88:91], v[140:143], v[116:119]
    s_mov_b32 s77, 24576
    buffer_load_dwordx4 v[196:199], v10, s[40:43], s77 offen offset:0
    v_mfma_f32_16x16x32_bf16 v[48:51], v[88:91], v[56:59], v[48:51]
    buffer_load_dwordx4 v[204:207], v10, s[40:43], s77 offen offset:1024
    v_mfma_f32_16x16x32_bf16 v[120:123], v[92:95], v[136:139], v[120:123]
    buffer_load_dwordx4 v[212:215], v10, s[40:43], s77 offen offset:2048
    v_mfma_f32_16x16x32_bf16 v[124:127], v[92:95], v[140:143], v[124:127]
    buffer_load_dwordx4 v[220:223], v10, s[40:43], s77 offen offset:3072
    v_mfma_f32_16x16x32_bf16 v[52:55], v[92:95], v[56:59], v[52:55]
    s_add_u32 m0, s9, 20480
    s_add_u32 s8, s10, 20480
    buffer_load_dwordx4 v12, s[44:47], s8 offen lds
    s_add_u32 m0, s9, 53248
    s_add_u32 s8, s10, 53248
    buffer_load_dwordx4 v12, s[44:47], s8 offen lds
    s_nop 1
    v_mfma_f32_16x16x32_bf16 v[20:23], v[56:59], v[144:147], v[20:23]
    v_mfma_f32_16x16x32_bf16 v[28:31], v[144:147], v[144:147], v[28:31]
    v_mfma_f32_16x16x32_bf16 v[24:27], v[56:59], v[148:151], v[24:27]
    v_mfma_f32_16x16x32_bf16 v[6:9], v[148:151], v[148:151], v[6:9]
    s_waitcnt lgkmcnt(0)
    v_mfma_f32_16x16x32_bf16 v[96:99], v[64:67], v[144:147], v[96:99]
    v_mfma_f32_16x16x32_bf16 v[100:103], v[64:67], v[148:151], v[100:103]
    ds_read_b64_tr_b16 v[80:81], v16 offset:6144
    v_mfma_f32_16x16x32_bf16 v[40:43], v[64:67], v[56:59], v[40:43]
    ds_read_b64_tr_b16 v[82:83], v16 offset:6400
    v_mfma_f32_16x16x32_bf16 v[104:107], v[68:71], v[144:147], v[104:107]
    ds_read_b64_tr_b16 v[84:85], v17 offset:6144
    v_mfma_f32_16x16x32_bf16 v[108:111], v[68:71], v[148:151], v[108:111]
    v_mfma_f32_16x16x32_bf16 v[44:47], v[68:71], v[56:59], v[44:47]
    ds_read_b64_tr_b16 v[86:87], v17 offset:6400
    v_mfma_f32_16x16x32_bf16 v[112:115], v[72:75], v[144:147], v[112:115]
    ds_read_b64_tr_b16 v[88:89], v16 offset:38912
    v_mfma_f32_16x16x32_bf16 v[116:119], v[72:75], v[148:151], v[116:119]
    ds_read_b64_tr_b16 v[90:91], v16 offset:39168
    v_mfma_f32_16x16x32_bf16 v[48:51], v[72:75], v[56:59], v[48:51]
    v_mfma_f32_16x16x32_bf16 v[120:123], v[76:79], v[144:147], v[120:123]
    ds_read_b64_tr_b16 v[92:93], v17 offset:38912
    v_mfma_f32_16x16x32_bf16 v[124:127], v[76:79], v[148:151], v[124:127]
    ds_read_b64_tr_b16 v[94:95], v17 offset:39168
    v_mfma_f32_16x16x32_bf16 v[52:55], v[76:79], v[56:59], v[52:55]
    s_waitcnt vmcnt(20)
    s_nop 1
    v_mfma_f32_16x16x32_bf16 v[20:23], v[56:59], v[152:155], v[20:23]
    v_mfma_f32_16x16x32_bf16 v[28:31], v[152:155], v[152:155], v[28:31]
    v_mfma_f32_16x16x32_bf16 v[24:27], v[56:59], v[156:159], v[24:27]
    v_mfma_f32_16x16x32_bf16 v[6:9], v[156:159], v[156:159], v[6:9]
    s_waitcnt lgkmcnt(0)
    v_mfma_f32_16x16x32_bf16 v[96:99], v[80:83], v[152:155], v[96:99]
    v_mfma_f32_16x16x32_bf16 v[100:103], v[80:83], v[156:159], v[100:103]
    s_waitcnt vmcnt(14)
    v_mfma_f32_16x16x32_bf16 v[40:43], v[80:83], v[56:59], v[40:43]
    s_waitcnt vmcnt(12)
    v_mfma_f32_16x16x32_bf16 v[104:107], v[84:87], v[152:155], v[104:107]
    s_barrier
    v_mfma_f32_16x16x32_bf16 v[108:111], v[84:87], v[156:159], v[108:111]
    ds_read_b64_tr_b16 v[64:65], v16 offset:8192
    v_mfma_f32_16x16x32_bf16 v[44:47], v[84:87], v[56:59], v[44:47]
    ds_read_b64_tr_b16 v[66:67], v16 offset:8448
    v_mfma_f32_16x16x32_bf16 v[112:115], v[88:91], v[152:155], v[112:115]
    ds_read_b64_tr_b16 v[68:69], v17 offset:8192
    v_mfma_f32_16x16x32_bf16 v[116:119], v[88:91], v[156:159], v[116:119]
    ds_read_b64_tr_b16 v[70:71], v17 offset:8448
    v_mfma_f32_16x16x32_bf16 v[48:51], v[88:91], v[56:59], v[48:51]
    ds_read_b64_tr_b16 v[72:73], v16 offset:40960
    v_mfma_f32_16x16x32_bf16 v[120:123], v[92:95], v[152:155], v[120:123]
    ds_read_b64_tr_b16 v[74:75], v16 offset:41216
    v_mfma_f32_16x16x32_bf16 v[124:127], v[92:95], v[156:159], v[124:127]
    ds_read_b64_tr_b16 v[76:77], v17 offset:40960
    v_mfma_f32_16x16x32_bf16 v[52:55], v[92:95], v[56:59], v[52:55]
    ds_read_b64_tr_b16 v[78:79], v17 offset:41216
    s_nop 1
    v_mfma_f32_16x16x32_bf16 v[20:23], v[56:59], v[160:163], v[20:23]
    v_mfma_f32_16x16x32_bf16 v[28:31], v[160:163], v[160:163], v[28:31]
    v_mfma_f32_16x16x32_bf16 v[24:27], v[56:59], v[164:167], v[24:27]
    v_mfma_f32_16x16x32_bf16 v[6:9], v[164:167], v[164:167], v[6:9]
    s_waitcnt lgkmcnt(0)
    v_mfma_f32_16x16x32_bf16 v[96:99], v[64:67], v[160:163], v[96:99]
    ds_read_b64_tr_b16 v[80:81], v16 offset:10240
    v_mfma_f32_16x16x32_bf16 v[100:103], v[64:67], v[164:167], v[100:103]
    ds_read_b64_tr_b16 v[82:83], v16 offset:10496
    v_mfma_f32_16x16x32_bf16 v[40:43], v[64:67], v[56:59], v[40:43]
    ds_read_b64_tr_b16 v[84:85], v17 offset:10240
    v_mfma_f32_16x16x32_bf16 v[104:107], v[68:71], v[160:163], v[104:107]
    ds_read_b64_tr_b16 v[86:87], v17 offset:10496
    ds_read_b64_tr_b16 v[88:89], v16 offset:43008
    v_mfma_f32_16x16x32_bf16 v[108:111], v[68:71], v[164:167], v[108:111]
    ds_read_b64_tr_b16 v[90:91], v16 offset:43264
    v_mfma_f32_16x16x32_bf16 v[44:47], v[68:71], v[56:59], v[44:47]
    ds_read_b64_tr_b16 v[92:93], v17 offset:43008
    v_mfma_f32_16x16x32_bf16 v[112:115], v[72:75], v[160:163], v[112:115]
    ds_read_b64_tr_b16 v[94:95], v17 offset:43264
    v_mfma_f32_16x16x32_bf16 v[116:119], v[72:75], v[164:167], v[116:119]
    s_mov_b32 s76, 12288
    buffer_load_dwordx4 v[224:227], v10, s[40:43], s76 offen offset:0
    v_mfma_f32_16x16x32_bf16 v[48:51], v[72:75], v[56:59], v[48:51]
    buffer_load_dwordx4 v[232:235], v10, s[40:43], s76 offen offset:1024
    v_mfma_f32_16x16x32_bf16 v[120:123], v[76:79], v[160:163], v[120:123]
    buffer_load_dwordx4 v[240:243], v10, s[40:43], s76 offen offset:2048
    v_mfma_f32_16x16x32_bf16 v[124:127], v[76:79], v[164:167], v[124:127]
    buffer_load_dwordx4 v[248:251], v10, s[40:43], s76 offen offset:3072
    v_mfma_f32_16x16x32_bf16 v[52:55], v[76:79], v[56:59], v[52:55]
    s_add_u32 m0, s9, 24576
    s_add_u32 s8, s10, 24576
    buffer_load_dwordx4 v12, s[44:47], s8 offen lds
    s_add_u32 m0, s9, 57344
    s_add_u32 s8, s10, 57344
    buffer_load_dwordx4 v12, s[44:47], s8 offen lds
    s_nop 1
    v_mfma_f32_16x16x32_bf16 v[20:23], v[56:59], v[168:171], v[20:23]
    v_mfma_f32_16x16x32_bf16 v[28:31], v[168:171], v[168:171], v[28:31]
    v_mfma_f32_16x16x32_bf16 v[24:27], v[56:59], v[172:175], v[24:27]
    v_mfma_f32_16x16x32_bf16 v[6:9], v[172:175], v[172:175], v[6:9]
    s_waitcnt lgkmcnt(0)
    v_mfma_f32_16x16x32_bf16 v[96:99], v[80:83], v[168:171], v[96:99]
    ds_read_b64_tr_b16 v[64:65], v16 offset:12288
    v_mfma_f32_16x16x32_bf16 v[100:103], v[80:83], v[172:175], v[100:103]
    ds_read_b64_tr_b16 v[66:67], v16 offset:12544
    v_mfma_f32_16x16x32_bf16 v[40:43], v[80:83], v[56:59], v[40:43]
    ds_read_b64_tr_b16 v[68:69], v17 offset:12288
    v_mfma_f32_16x16x32_bf16 v[104:107], v[84:87], v[168:171], v[104:107]
    ds_read_b64_tr_b16 v[70:71], v17 offset:12544
    ds_read_b64_tr_b16 v[72:73], v16 offset:45056
    v_mfma_f32_16x16x32_bf16 v[108:111], v[84:87], v[172:175], v[108:111]
    ds_read_b64_tr_b16 v[74:75], v16 offset:45312
    v_mfma_f32_16x16x32_bf16 v[44:47], v[84:87], v[56:59], v[44:47]
    ds_read_b64_tr_b16 v[76:77], v17 offset:45056
    v_mfma_f32_16x16x32_bf16 v[112:115], v[88:91], v[168:171], v[112:115]
    ds_read_b64_tr_b16 v[78:79], v17 offset:45312
    v_mfma_f32_16x16x32_bf16 v[116:119], v[88:91], v[172:175], v[116:119]
    s_mov_b32 s77, 28672
    buffer_load_dwordx4 v[228:231], v10, s[40:43], s77 offen offset:0
    v_mfma_f32_16x16x32_bf16 v[48:51], v[88:91], v[56:59], v[48:51]
    buffer_load_dwordx4 v[236:239], v10, s[40:43], s77 offen offset:1024
    v_mfma_f32_16x16x32_bf16 v[120:123], v[92:95], v[168:171], v[120:123]
    buffer_load_dwordx4 v[244:247], v10, s[40:43], s77 offen offset:2048
    v_mfma_f32_16x16x32_bf16 v[124:127], v[92:95], v[172:175], v[124:127]
    buffer_load_dwordx4 v[252:255], v10, s[40:43], s77 offen offset:3072
    v_mfma_f32_16x16x32_bf16 v[52:55], v[92:95], v[56:59], v[52:55]
    s_add_u32 m0, s9, 28672
    s_add_u32 s8, s10, 28672
    buffer_load_dwordx4 v12, s[44:47], s8 offen lds
    s_add_u32 m0, s9, 61440
    s_add_u32 s8, s10, 61440
    buffer_load_dwordx4 v12, s[44:47], s8 offen lds
    s_nop 1
    v_mfma_f32_16x16x32_bf16 v[20:23], v[56:59], v[176:179], v[20:23]
    v_mfma_f32_16x16x32_bf16 v[28:31], v[176:179], v[176:179], v[28:31]
    v_mfma_f32_16x16x32_bf16 v[24:27], v[56:59], v[180:183], v[24:27]
    v_mfma_f32_16x16x32_bf16 v[6:9], v[180:183], v[180:183], v[6:9]
    s_waitcnt lgkmcnt(0)
    v_mfma_f32_16x16x32_bf16 v[96:99], v[64:67], v[176:179], v[96:99]
    v_mfma_f32_16x16x32_bf16 v[100:103], v[64:67], v[180:183], v[100:103]
    ds_read_b64_tr_b16 v[80:81], v16 offset:14336
    v_mfma_f32_16x16x32_bf16 v[40:43], v[64:67], v[56:59], v[40:43]
    ds_read_b64_tr_b16 v[82:83], v16 offset:14592
    v_mfma_f32_16x16x32_bf16 v[104:107], v[68:71], v[176:179], v[104:107]
    ds_read_b64_tr_b16 v[84:85], v17 offset:14336
    v_mfma_f32_16x16x32_bf16 v[108:111], v[68:71], v[180:183], v[108:111]
    v_mfma_f32_16x16x32_bf16 v[44:47], v[68:71], v[56:59], v[44:47]
    ds_read_b64_tr_b16 v[86:87], v17 offset:14592
    v_mfma_f32_16x16x32_bf16 v[112:115], v[72:75], v[176:179], v[112:115]
    ds_read_b64_tr_b16 v[88:89], v16 offset:47104
    v_mfma_f32_16x16x32_bf16 v[116:119], v[72:75], v[180:183], v[116:119]
    ds_read_b64_tr_b16 v[90:91], v16 offset:47360
    v_mfma_f32_16x16x32_bf16 v[48:51], v[72:75], v[56:59], v[48:51]
    v_mfma_f32_16x16x32_bf16 v[120:123], v[76:79], v[176:179], v[120:123]
    ds_read_b64_tr_b16 v[92:93], v17 offset:47104
    v_mfma_f32_16x16x32_bf16 v[124:127], v[76:79], v[180:183], v[124:127]
    ds_read_b64_tr_b16 v[94:95], v17 offset:47360
    v_mfma_f32_16x16x32_bf16 v[52:55], v[76:79], v[56:59], v[52:55]
    s_waitcnt vmcnt(20)
    s_nop 1
    v_mfma_f32_16x16x32_bf16 v[20:23], v[56:59], v[184:187], v[20:23]
    v_mfma_f32_16x16x32_bf16 v[28:31], v[184:187], v[184:187], v[28:31]
    v_mfma_f32_16x16x32_bf16 v[24:27], v[56:59], v[188:191], v[24:27]
    v_mfma_f32_16x16x32_bf16 v[6:9], v[188:191], v[188:191], v[6:9]
    s_waitcnt lgkmcnt(0)
    v_mfma_f32_16x16x32_bf16 v[96:99], v[80:83], v[184:187], v[96:99]
    v_mfma_f32_16x16x32_bf16 v[100:103], v[80:83], v[188:191], v[100:103]
    s_waitcnt vmcnt(14)
    v_mfma_f32_16x16x32_bf16 v[40:43], v[80:83], v[56:59], v[40:43]
    s_waitcnt vmcnt(12)
    v_mfma_f32_16x16x32_bf16 v[104:107], v[84:87], v[184:187], v[104:107]
    s_barrier
    v_mfma_f32_16x16x32_bf16 v[108:111], v[84:87], v[188:191], v[108:111]
    ds_read_b64_tr_b16 v[64:65], v16 offset:16384
    v_mfma_f32_16x16x32_bf16 v[44:47], v[84:87], v[56:59], v[44:47]
    ds_read_b64_tr_b16 v[66:67], v16 offset:16640
    v_mfma_f32_16x16x32_bf16 v[112:115], v[88:91], v[184:187], v[112:115]
    ds_read_b64_tr_b16 v[68:69], v17 offset:16384
    v_mfma_f32_16x16x32_bf16 v[116:119], v[88:91], v[188:191], v[116:119]
    ds_read_b64_tr_b16 v[70:71], v17 offset:16640
    v_mfma_f32_16x16x32_bf16 v[48:51], v[88:91], v[56:59], v[48:51]
    ds_read_b64_tr_b16 v[72:73], v16 offset:49152
    v_mfma_f32_16x16x32_bf16 v[120:123], v[92:95], v[184:187], v[120:123]
    ds_read_b64_tr_b16 v[74:75], v16 offset:49408
    v_mfma_f32_16x16x32_bf16 v[124:127], v[92:95], v[188:191], v[124:127]
    ds_read_b64_tr_b16 v[76:77], v17 offset:49152
    v_mfma_f32_16x16x32_bf16 v[52:55], v[92:95], v[56:59], v[52:55]
    ds_read_b64_tr_b16 v[78:79], v17 offset:49408
    s_nop 1
    v_mfma_f32_16x16x32_bf16 v[20:23], v[56:59], v[192:195], v[20:23]
    v_mfma_f32_16x16x32_bf16 v[28:31], v[192:195], v[192:195], v[28:31]
    v_mfma_f32_16x16x32_bf16 v[24:27], v[56:59], v[196:199], v[24:27]
    v_mfma_f32_16x16x32_bf16 v[6:9], v[196:199], v[196:199], v[6:9]
    s_waitcnt lgkmcnt(0)
    v_mfma_f32_16x16x32_bf16 v[96:99], v[64:67], v[192:195], v[96:99]
    v_mfma_f32_16x16x32_bf16 v[100:103], v[64:67], v[196:199], v[100:103]
    ds_read_b64_tr_b16 v[80:81], v16 offset:18432
    v_mfma_f32_16x16x32_bf16 v[40:43], v[64:67], v[56:59], v[40:43]
    ds_read_b64_tr_b16 v[82:83], v16 offset:18688
    v_mfma_f32_16x16x32_bf16 v[104:107], v[68:71], v[192:195], v[104:107]
    ds_read_b64_tr_b16 v[84:85], v17 offset:18432
    v_mfma_f32_16x16x32_bf16 v[108:111], v[68:71], v[196:199], v[108:111]
    ds_read_b64_tr_b16 v[86:87], v17 offset:18688
    v_mfma_f32_16x16x32_bf16 v[44:47], v[68:71], v[56:59], v[44:47]
    ds_read_b64_tr_b16 v[88:89], v16 offset:51200
    v_mfma_f32_16x16x32_bf16 v[112:115], v[72:75], v[192:195], v[112:115]
    v_mfma_f32_16x16x32_bf16 v[116:119], v[72:75], v[196:199], v[116:119]
    ds_read_b64_tr_b16 v[90:91], v16 offset:51456
    v_mfma_f32_16x16x32_bf16 v[48:51], v[72:75], v[56:59], v[48:51]
    ds_read_b64_tr_b16 v[92:93], v17 offset:51200
    v_mfma_f32_16x16x32_bf16 v[120:123], v[76:79], v[192:195], v[120:123]
    ds_read_b64_tr_b16 v[94:95], v17 offset:51456
    v_mfma_f32_16x16x32_bf16 v[124:127], v[76:79], v[196:199], v[124:127]
    s_add_u32 m0, s9, 65536
    s_add_u32 s8, s10, 65536
    buffer_load_dwordx4 v12, s[44:47], s8 offen lds
    v_mfma_f32_16x16x32_bf16 v[52:55], v[76:79], v[56:59], v[52:55]
    s_add_u32 m0, s9, 69632
    s_add_u32 s8, s10, 69632
    buffer_load_dwordx4 v12, s[44:47], s8 offen lds
    s_nop 1
    v_mfma_f32_16x16x32_bf16 v[20:23], v[56:59], v[200:203], v[20:23]
    v_mfma_f32_16x16x32_bf16 v[28:31], v[200:203], v[200:203], v[28:31]
    v_mfma_f32_16x16x32_bf16 v[24:27], v[56:59], v[204:207], v[24:27]
    v_mfma_f32_16x16x32_bf16 v[6:9], v[204:207], v[204:207], v[6:9]
    s_waitcnt lgkmcnt(0)
    v_mfma_f32_16x16x32_bf16 v[96:99], v[80:83], v[200:203], v[96:99]
    v_mfma_f32_16x16x32_bf16 v[100:103], v[80:83], v[204:207], v[100:103]
    ds_read_b64_tr_b16 v[64:65], v16 offset:20480
    v_mfma_f32_16x16x32_bf16 v[40:43], v[80:83], v[56:59], v[40:43]
    ds_read_b64_tr_b16 v[66:67], v16 offset:20736
    v_mfma_f32_16x16x32_bf16 v[104:107], v[84:87], v[200:203], v[104:107]
    ds_read_b64_tr_b16 v[68:69], v17 offset:20480
    v_mfma_f32_16x16x32_bf16 v[108:111], v[84:87], v[204:207], v[108:111]
    ds_read_b64_tr_b16 v[70:71], v17 offset:20736
    v_mfma_f32_16x16x32_bf16 v[44:47], v[84:87], v[56:59], v[44:47]
    ds_read_b64_tr_b16 v[72:73], v16 offset:53248
    v_mfma_f32_16x16x32_bf16 v[112:115], v[88:91], v[200:203], v[112:115]
    v_mfma_f32_16x16x32_bf16 v[116:119], v[88:91], v[204:207], v[116:119]
    ds_read_b64_tr_b16 v[74:75], v16 offset:53504
    v_mfma_f32_16x16x32_bf16 v[48:51], v[88:91], v[56:59], v[48:51]
    ds_read_b64_tr_b16 v[76:77], v17 offset:53248
    v_mfma_f32_16x16x32_bf16 v[120:123], v[92:95], v[200:203], v[120:123]
    ds_read_b64_tr_b16 v[78:79], v17 offset:53504
    v_mfma_f32_16x16x32_bf16 v[124:127], v[92:95], v[204:207], v[124:127]
    s_add_u32 m0, s9, 73728
    s_add_u32 s8, s10, 73728
    buffer_load_dwordx4 v12, s[44:47], s8 offen lds
    v_mfma_f32_16x16x32_bf16 v[52:55], v[92:95], v[56:59], v[52:55]
    s_add_u32 m0, s9, 77824
    s_add_u32 s8, s10, 77824
    buffer_load_dwordx4 v12, s[44:47], s8 offen lds
    s_nop 1
    v_mfma_f32_16x16x32_bf16 v[20:23], v[56:59], v[208:211], v[20:23]
    v_mfma_f32_16x16x32_bf16 v[28:31], v[208:211], v[208:211], v[28:31]
    v_mfma_f32_16x16x32_bf16 v[24:27], v[56:59], v[212:215], v[24:27]
    v_mfma_f32_16x16x32_bf16 v[6:9], v[212:215], v[212:215], v[6:9]
    s_waitcnt lgkmcnt(0)
    v_mfma_f32_16x16x32_bf16 v[96:99], v[64:67], v[208:211], v[96:99]
    v_mfma_f32_16x16x32_bf16 v[100:103], v[64:67], v[212:215], v[100:103]
    ds_read_b64_tr_b16 v[80:81], v16 offset:22528
    v_mfma_f32_16x16x32_bf16 v[40:43], v[64:67], v[56:59], v[40:43]
    ds_read_b64_tr_b16 v[82:83], v16 offset:22784
    v_mfma_f32_16x16x32_bf16 v[104:107], v[68:71], v[208:211], v[104:107]
    ds_read_b64_tr_b16 v[84:85], v17 offset:22528
    v_mfma_f32_16x16x32_bf16 v[108:111], v[68:71], v[212:215], v[108:111]
    v_mfma_f32_16x16x32_bf16 v[44:47], v[68:71], v[56:59], v[44:47]
    ds_read_b64_tr_b16 v[86:87], v17 offset:22784
    v_mfma_f32_16x16x32_bf16 v[112:115], v[72:75], v[208:211], v[112:115]
    ds_read_b64_tr_b16 v[88:89], v16 offset:55296
    v_mfma_f32_16x16x32_bf16 v[116:119], v[72:75], v[212:215], v[116:119]
    ds_read_b64_tr_b16 v[90:91], v16 offset:55552
    v_mfma_f32_16x16x32_bf16 v[48:51], v[72:75], v[56:59], v[48:51]
    v_mfma_f32_16x16x32_bf16 v[120:123], v[76:79], v[208:211], v[120:123]
    ds_read_b64_tr_b16 v[92:93], v17 offset:55296
    v_mfma_f32_16x16x32_bf16 v[124:127], v[76:79], v[212:215], v[124:127]
    ds_read_b64_tr_b16 v[94:95], v17 offset:55552
    v_mfma_f32_16x16x32_bf16 v[52:55], v[76:79], v[56:59], v[52:55]
    s_waitcnt vmcnt(12)
    s_nop 1
    v_mfma_f32_16x16x32_bf16 v[20:23], v[56:59], v[216:219], v[20:23]
    v_mfma_f32_16x16x32_bf16 v[28:31], v[216:219], v[216:219], v[28:31]
    v_mfma_f32_16x16x32_bf16 v[24:27], v[56:59], v[220:223], v[24:27]
    v_mfma_f32_16x16x32_bf16 v[6:9], v[220:223], v[220:223], v[6:9]
    s_waitcnt lgkmcnt(0)
    v_mfma_f32_16x16x32_bf16 v[96:99], v[80:83], v[216:219], v[96:99]
    v_mfma_f32_16x16x32_bf16 v[100:103], v[80:83], v[220:223], v[100:103]
    s_waitcnt vmcnt(6)
    v_mfma_f32_16x16x32_bf16 v[40:43], v[80:83], v[56:59], v[40:43]
    s_waitcnt vmcnt(4)
    v_mfma_f32_16x16x32_bf16 v[104:107], v[84:87], v[216:219], v[104:107]
    s_barrier
    v_mfma_f32_16x16x32_bf16 v[108:111], v[84:87], v[220:223], v[108:111]
    ds_read_b64_tr_b16 v[64:65], v16 offset:24576
    v_mfma_f32_16x16x32_bf16 v[44:47], v[84:87], v[56:59], v[44:47]
    ds_read_b64_tr_b16 v[66:67], v16 offset:24832
    v_mfma_f32_16x16x32_bf16 v[112:115], v[88:91], v[216:219], v[112:115]
    ds_read_b64_tr_b16 v[68:69], v17 offset:24576
    v_mfma_f32_16x16x32_bf16 v[116:119], v[88:91], v[220:223], v[116:119]
    ds_read_b64_tr_b16 v[70:71], v17 offset:24832
    v_mfma_f32_16x16x32_bf16 v[48:51], v[88:91], v[56:59], v[48:51]
    ds_read_b64_tr_b16 v[72:73], v16 offset:57344
    v_mfma_f32_16x16x32_bf16 v[120:123], v[92:95], v[216:219], v[120:123]
    ds_read_b64_tr_b16 v[74:75], v16 offset:57600
    v_mfma_f32_16x16x32_bf16 v[124:127], v[92:95], v[220:223], v[124:127]
    ds_read_b64_tr_b16 v[76:77], v17 offset:57344
    v_mfma_f32_16x16x32_bf16 v[52:55], v[92:95], v[56:59], v[52:55]
    ds_read_b64_tr_b16 v[78:79], v17 offset:57600
    s_nop 1
    v_mfma_f32_16x16x32_bf16 v[20:23], v[56:59], v[224:227], v[20:23]
    v_mfma_f32_16x16x32_bf16 v[28:31], v[224:227], v[224:227], v[28:31]
    v_mfma_f32_16x16x32_bf16 v[24:27], v[56:59], v[228:231], v[24:27]
    v_mfma_f32_16x16x32_bf16 v[6:9], v[228:231], v[228:231], v[6:9]
    s_waitcnt lgkmcnt(0)
    v_mfma_f32_16x16x32_bf16 v[96:99], v[64:67], v[224:227], v[96:99]
    v_mfma_f32_16x16x32_bf16 v[100:103], v[64:67], v[228:231], v[100:103]
    ds_read_b64_tr_b16 v[80:81], v16 offset:26624
    v_mfma_f32_16x16x32_bf16 v[40:43], v[64:67], v[56:59], v[40:43]
    ds_read_b64_tr_b16 v[82:83], v16 offset:26880
    v_mfma_f32_16x16x32_bf16 v[104:107], v[68:71], v[224:227], v[104:107]
    v_mfma_f32_16x16x32_bf16 v[108:111], v[68:71], v[228:231], v[108:111]
    ds_read_b64_tr_b16 v[84:85], v17 offset:26624
    v_mfma_f32_16x16x32_bf16 v[44:47], v[68:71], v[56:59], v[44:47]
    ds_read_b64_tr_b16 v[86:87], v17 offset:26880
    v_mfma_f32_16x16x32_bf16 v[112:115], v[72:75], v[224:227], v[112:115]
    v_mfma_f32_16x16x32_bf16 v[116:119], v[72:75], v[228:231], v[116:119]
    ds_read_b64_tr_b16 v[88:89], v16 offset:59392
    v_mfma_f32_16x16x32_bf16 v[48:51], v[72:75], v[56:59], v[48:51]
    ds_read_b64_tr_b16 v[90:91], v16 offset:59648
    v_mfma_f32_16x16x32_bf16 v[120:123], v[76:79], v[224:227], v[120:123]
    v_mfma_f32_16x16x32_bf16 v[124:127], v[76:79], v[228:231], v[124:127]
    ds_read_b64_tr_b16 v[92:93], v17 offset:59392
    v_mfma_f32_16x16x32_bf16 v[52:55], v[76:79], v[56:59], v[52:55]
    ds_read_b64_tr_b16 v[94:95], v17 offset:59648
    s_nop 1
    v_mfma_f32_16x16x32_bf16 v[20:23], v[56:59], v[232:235], v[20:23]
    v_mfma_f32_16x16x32_bf16 v[28:31], v[232:235], v[232:235], v[28:31]
    v_mfma_f32_16x16x32_bf16 v[24:27], v[56:59], v[236:239], v[24:27]
    v_mfma_f32_16x16x32_bf16 v[6:9], v[236:239], v[236:239], v[6:9]
    s_waitcnt lgkmcnt(0)
    v_mfma_f32_16x16x32_bf16 v[96:99], v[80:83], v[232:235], v[96:99]
    v_mfma_f32_16x16x32_bf16 v[100:103], v[80:83], v[236:239], v[100:103]
    ds_read_b64_tr_b16 v[64:65], v16 offset:28672
    v_mfma_f32_16x16x32_bf16 v[40:43], v[80:83], v[56:59], v[40:43]
    ds_read_b64_tr_b16 v[66:67], v16 offset:28928
    v_mfma_f32_16x16x32_bf16 v[104:107], v[84:87], v[232:235], v[104:107]
    v_mfma_f32_16x16x32_bf16 v[108:111], v[84:87], v[236:239], v[108:111]
    ds_read_b64_tr_b16 v[68:69], v17 offset:28672
    v_mfma_f32_16x16x32_bf16 v[44:47], v[84:87], v[56:59], v[44:47]
    ds_read_b64_tr_b16 v[70:71], v17 offset:28928
    v_mfma_f32_16x16x32_bf16 v[112:115], v[88:91], v[232:235], v[112:115]
    v_mfma_f32_16x16x32_bf16 v[116:119], v[88:91], v[236:239], v[116:119]
    ds_read_b64_tr_b16 v[72:73], v16 offset:61440
    v_mfma_f32_16x16x32_bf16 v[48:51], v[88:91], v[56:59], v[48:51]
    ds_read_b64_tr_b16 v[74:75], v16 offset:61696
    v_mfma_f32_16x16x32_bf16 v[120:123], v[92:95], v[232:235], v[120:123]
    v_mfma_f32_16x16x32_bf16 v[124:127], v[92:95], v[236:239], v[124:127]
    ds_read_b64_tr_b16 v[76:77], v17 offset:61440
    v_mfma_f32_16x16x32_bf16 v[52:55], v[92:95], v[56:59], v[52:55]
    ds_read_b64_tr_b16 v[78:79], v17 offset:61696
    s_nop 1
    v_mfma_f32_16x16x32_bf16 v[20:23], v[56:59], v[240:243], v[20:23]
    v_mfma_f32_16x16x32_bf16 v[28:31], v[240:243], v[240:243], v[28:31]
    v_mfma_f32_16x16x32_bf16 v[24:27], v[56:59], v[244:247], v[24:27]
    v_mfma_f32_16x16x32_bf16 v[6:9], v[244:247], v[244:247], v[6:9]
    s_waitcnt lgkmcnt(0)
    v_mfma_f32_16x16x32_bf16 v[96:99], v[64:67], v[240:243], v[96:99]
    v_mfma_f32_16x16x32_bf16 v[100:103], v[64:67], v[244:247], v[100:103]
    ds_read_b64_tr_b16 v[80:81], v16 offset:30720
    v_mfma_f32_16x16x32_bf16 v[40:43], v[64:67], v[56:59], v[40:43]
    ds_read_b64_tr_b16 v[82:83], v16 offset:30976
    v_mfma_f32_16x16x32_bf16 v[104:107], v[68:71], v[240:243], v[104:107]
    v_mfma_f32_16x16x32_bf16 v[108:111], v[68:71], v[244:247], v[108:111]
    ds_read_b64_tr_b16 v[84:85], v17 offset:30720
    v_mfma_f32_16x16x32_bf16 v[44:47], v[68:71], v[56:59], v[44:47]
    ds_read_b64_tr_b16 v[86:87], v17 offset:30976
    v_mfma_f32_16x16x32_bf16 v[112:115], v[72:75], v[240:243], v[112:115]
    v_mfma_f32_16x16x32_bf16 v[116:119], v[72:75], v[244:247], v[116:119]
    ds_read_b64_tr_b16 v[88:89], v16 offset:63488
    v_mfma_f32_16x16x32_bf16 v[48:51], v[72:75], v[56:59], v[48:51]
    ds_read_b64_tr_b16 v[90:91], v16 offset:63744
    v_mfma_f32_16x16x32_bf16 v[120:123], v[76:79], v[240:243], v[120:123]
    v_mfma_f32_16x16x32_bf16 v[124:127], v[76:79], v[244:247], v[124:127]
    ds_read_b64_tr_b16 v[92:93], v17 offset:63488
    v_mfma_f32_16x16x32_bf16 v[52:55], v[76:79], v[56:59], v[52:55]
    ds_read_b64_tr_b16 v[94:95], v17 offset:63744
    s_nop 1
    v_mfma_f32_16x16x32_bf16 v[20:23], v[56:59], v[248:251], v[20:23]
    v_mfma_f32_16x16x32_bf16 v[28:31], v[248:251], v[248:251], v[28:31]
    v_mfma_f32_16x16x32_bf16 v[24:27], v[56:59], v[252:255], v[24:27]
    v_mfma_f32_16x16x32_bf16 v[6:9], v[252:255], v[252:255], v[6:9]
    s_waitcnt lgkmcnt(0)
    v_mfma_f32_16x16x32_bf16 v[96:99], v[80:83], v[248:251], v[96:99]
    v_mfma_f32_16x16x32_bf16 v[100:103], v[80:83], v[252:255], v[100:103]
    v_mfma_f32_16x16x32_bf16 v[40:43], v[80:83], v[56:59], v[40:43]
    v_mfma_f32_16x16x32_bf16 v[104:107], v[84:87], v[248:251], v[104:107]
    v_mfma_f32_16x16x32_bf16 v[108:111], v[84:87], v[252:255], v[108:111]
    v_mfma_f32_16x16x32_bf16 v[44:47], v[84:87], v[56:59], v[44:47]
    v_mfma_f32_16x16x32_bf16 v[112:115], v[88:91], v[248:251], v[112:115]
    v_mfma_f32_16x16x32_bf16 v[116:119], v[88:91], v[252:255], v[116:119]
    v_mfma_f32_16x16x32_bf16 v[48:51], v[88:91], v[56:59], v[48:51]
    v_mfma_f32_16x16x32_bf16 v[120:123], v[92:95], v[248:251], v[120:123]
    v_mfma_f32_16x16x32_bf16 v[124:127], v[92:95], v[252:255], v[124:127]
    v_mfma_f32_16x16x32_bf16 v[52:55], v[92:95], v[56:59], v[52:55]
    s_nop 1
    s_waitcnt vmcnt(0)
    s_barrier
    s_add_u32 m0, s9, 0
    s_add_u32 s8, s10, 81920
    buffer_load_dwordx4 v12, s[44:47], s8 offen lds
    s_add_u32 m0, s9, 4096
    s_add_u32 s8, s10, 86016
    buffer_load_dwordx4 v12, s[44:47], s8 offen lds
    s_add_u32 m0, s9, 8192
    s_add_u32 s8, s10, 90112
    buffer_load_dwordx4 v12, s[44:47], s8 offen lds
    s_add_u32 m0, s9, 12288
    s_add_u32 s8, s10, 94208
    buffer_load_dwordx4 v12, s[44:47], s8 offen lds
    v_lshlrev_b32 v5, 2, v4
    v_sub_u32 v5, v3, v5
    v_mov_b32 v21, 0
    v_mov_b32 v23, 0
    v_mul_f32 v26, 0x3b000000, v20
    v_mul_f32 v27, 0x3b000000, v24
    v_cmp_eq_u32 s[68:69], 0, v5
    v_cmp_eq_u32 s[70:71], 1, v5
    v_cmp_eq_u32 s[72:73], 2, v5
    v_cmp_eq_u32 s[74:75], 3, v5
    s_nop 0
    v_cndmask_b32 v21, v21, v28, s[68:69]
    v_cndmask_b32 v23, v23, v6, s[68:69]
    v_cndmask_b32 v21, v21, v29, s[70:71]
    v_cndmask_b32 v23, v23, v7, s[70:71]
    v_cndmask_b32 v21, v21, v30, s[72:73]
    v_cndmask_b32 v23, v23, v8, s[72:73]
    v_cndmask_b32 v21, v21, v31, s[74:75]
    v_cndmask_b32 v23, v23, v9, s[74:75]
    s_nop 1
    v_permlane32_swap_b32 v21, v23
    v_add_f32 v21, v21, v23
    v_mov_b32 v25, v21
    s_nop 1
    v_permlane16_swap_b32 v21, v25
    v_add_f32 v21, v21, v25
    v_mov_b32 v23, v21
    s_nop 1
    v_permlane32_swap_b32 v21, v23
    v_mul_f32 v21, 0x3b000000, v21
    v_mul_f32 v23, 0x3b000000, v23
    v_fma_f32 v21, -v26, v26, v21
    v_fma_f32 v23, -v27, v27, v23
    v_max_f32 v21, 0, v21
    v_max_f32 v23, 0, v23
    v_add_f32 v21, 0x3727c5ac, v21
    v_add_f32 v23, 0x3727c5ac, v23
    v_rsq_f32 v20, v21
    v_rsq_f32 v22, v23
    v_mul_f32_e64 v21, -v26, v20
    v_mul_f32_e64 v23, -v27, v22
    v_mul_f32 v96, v96, v20
    v_mul_f32 v97, v97, v20
    v_mul_f32 v98, v98, v20
    v_mul_f32 v99, v99, v20
    v_fmac_f32 v96, v40, v21
    v_fmac_f32 v97, v41, v21
    v_fmac_f32 v98, v42, v21
    v_fmac_f32 v99, v43, v21
    v_mul_f32 v100, v100, v22
    v_mul_f32 v101, v101, v22
    v_mul_f32 v102, v102, v22
    v_mul_f32 v103, v103, v22
    v_fmac_f32 v100, v40, v23
    v_fmac_f32 v101, v41, v23
    v_fmac_f32 v102, v42, v23
    v_fmac_f32 v103, v43, v23
    v_mul_f32 v104, v104, v20
    v_mul_f32 v105, v105, v20
    v_mul_f32 v106, v106, v20
    v_mul_f32 v107, v107, v20
    v_fmac_f32 v104, v44, v21
    v_fmac_f32 v105, v45, v21
    v_fmac_f32 v106, v46, v21
    v_fmac_f32 v107, v47, v21
    v_mul_f32 v108, v108, v22
    v_mul_f32 v109, v109, v22
    v_mul_f32 v110, v110, v22
    v_mul_f32 v111, v111, v22
    v_fmac_f32 v108, v44, v23
    v_fmac_f32 v109, v45, v23
    v_fmac_f32 v110, v46, v23
    v_fmac_f32 v111, v47, v23
    v_mul_f32 v112, v112, v20
    v_mul_f32 v113, v113, v20
    v_mul_f32 v114, v114, v20
    v_mul_f32 v115, v115, v20
    v_fmac_f32 v112, v48, v21
    v_fmac_f32 v113, v49, v21
    v_fmac_f32 v114, v50, v21
    v_fmac_f32 v115, v51, v21
    v_mul_f32 v116, v116, v22
    v_mul_f32 v117, v117, v22
    v_mul_f32 v118, v118, v22
    v_mul_f32 v119, v119, v22
    v_fmac_f32 v116, v48, v23
    v_fmac_f32 v117, v49, v23
    v_fmac_f32 v118, v50, v23
    v_fmac_f32 v119, v51, v23
    v_mul_f32 v120, v120, v20
    v_mul_f32 v121, v121, v20
    v_mul_f32 v122, v122, v20
    v_mul_f32 v123, v123, v20
    v_fmac_f32 v120, v52, v21
    v_fmac_f32 v121, v53, v21
    v_fmac_f32 v122, v54, v21
    v_fmac_f32 v123, v55, v21
    v_mul_f32 v124, v124, v22
    v_mul_f32 v125, v125, v22
    v_mul_f32 v126, v126, v22
    v_mul_f32 v127, v127, v22
    v_fmac_f32 v124, v52, v23
    v_fmac_f32 v125, v53, v23
    v_fmac_f32 v126, v54, v23
    v_fmac_f32 v127, v55, v23
    s_mov_b32 s14, 0xbdd2d3e8
    v_mov_b32 v15, 0xc0135761
    s_cmp_eq_u32 s5, 14
    s_cselect_b32 s15, 0, 1.0
    s_nop 4
    v_mul_f32 v64, v96, v96
    v_mul_f32 v65, v97, v97
    v_mul_f32 v66, v98, v98
    v_mul_f32 v67, v99, v99
    v_mul_f32 v68, v100, v100
    v_mul_f32 v69, v101, v101
    v_mul_f32 v70, v102, v102
    v_mul_f32 v71, v103, v103
    v_fma_f32 v64, v64, s14, v15
    v_fma_f32 v65, v65, s14, v15
    v_fma_f32 v66, v66, s14, v15
    v_fma_f32 v67, v67, s14, v15
    v_fma_f32 v68, v68, s14, v15
    v_fma_f32 v69, v69, s14, v15
    v_fma_f32 v70, v70, s14, v15
    v_fma_f32 v71, v71, s14, v15
    v_mul_f32 v64, v64, v96
    v_mul_f32 v65, v65, v97
    v_mul_f32 v66, v66, v98
    v_mul_f32 v67, v67, v99
    v_mul_f32 v68, v68, v100
    v_mul_f32 v69, v69, v101
    v_mul_f32 v70, v70, v102
    v_mul_f32 v71, v71, v103
    v_exp_f32 v64, v64
    v_exp_f32 v65, v65
    v_exp_f32 v66, v66
    v_exp_f32 v67, v67
    v_exp_f32 v68, v68
    v_exp_f32 v69, v69
    v_exp_f32 v70, v70
    v_exp_f32 v71, v71
    v_add_f32 v64, 1.0, v64
    v_add_f32 v65, 1.0, v65
    v_add_f32 v66, 1.0, v66
    v_add_f32 v67, 1.0, v67
    v_add_f32 v68, 1.0, v68
    v_add_f32 v69, 1.0, v69
    v_add_f32 v70, 1.0, v70
    v_add_f32 v71, 1.0, v71
    v_rcp_f32 v64, v64
    v_rcp_f32 v65, v65
    v_rcp_f32 v66, v66
    v_rcp_f32 v67, v67
    v_rcp_f32 v68, v68
    v_rcp_f32 v69, v69
    v_rcp_f32 v70, v70
    v_rcp_f32 v71, v71
    v_mul_f32 v96, v96, v64
    v_mul_f32 v97, v97, v65
    v_mul_f32 v98, v98, v66
    v_mul_f32 v99, v99, v67
    v_mul_f32 v100, v100, v68
    v_mul_f32 v101, v101, v69
    v_mul_f32 v102, v102, v70
    v_mul_f32 v103, v103, v71
    v_mul_f32 v64, v104, v104
    v_mul_f32 v65, v105, v105
    v_mul_f32 v66, v106, v106
    v_mul_f32 v67, v107, v107
    v_mul_f32 v68, v108, v108
    v_mul_f32 v69, v109, v109
    v_mul_f32 v70, v110, v110
    v_mul_f32 v71, v111, v111
    v_fma_f32 v64, v64, s14, v15
    v_fma_f32 v65, v65, s14, v15
    v_fma_f32 v66, v66, s14, v15
    v_fma_f32 v67, v67, s14, v15
    v_fma_f32 v68, v68, s14, v15
    v_fma_f32 v69, v69, s14, v15
    v_fma_f32 v70, v70, s14, v15
    v_fma_f32 v71, v71, s14, v15
    v_mul_f32 v64, v64, v104
    v_mul_f32 v65, v65, v105
    v_mul_f32 v66, v66, v106
    v_mul_f32 v67, v67, v107
    v_mul_f32 v68, v68, v108
    v_mul_f32 v69, v69, v109
    v_mul_f32 v70, v70, v110
    v_mul_f32 v71, v71, v111
    v_exp_f32 v64, v64
    v_exp_f32 v65, v65
    v_exp_f32 v66, v66
    v_exp_f32 v67, v67
    v_exp_f32 v68, v68
    v_exp_f32 v69, v69
    v_exp_f32 v70, v70
    v_exp_f32 v71, v71
    v_add_f32 v64, 1.0, v64
    v_add_f32 v65, 1.0, v65
    v_add_f32 v66, 1.0, v66
    v_add_f32 v67, 1.0, v67
    v_add_f32 v68, 1.0, v68
    v_add_f32 v69, 1.0, v69
    v_add_f32 v70, 1.0, v70
    v_add_f32 v71, 1.0, v71
    v_rcp_f32 v64, v64
    v_rcp_f32 v65, v65
    v_rcp_f32 v66, v66
    v_rcp_f32 v67, v67
    v_rcp_f32 v68, v68
    v_rcp_f32 v69, v69
    v_rcp_f32 v70, v70
    v_rcp_f32 v71, v71
    v_mul_f32 v104, v104, v64
    v_mul_f32 v105, v105, v65
    v_mul_f32 v106, v106, v66
    v_mul_f32 v107, v107, v67
    v_mul_f32 v108, v108, v68
    v_mul_f32 v109, v109, v69
    v_mul_f32 v110, v110, v70
    v_mul_f32 v111, v111, v71
    v_mul_f32 v64, v112, v112
    v_mul_f32 v65, v113, v113
    v_mul_f32 v66, v114, v114
    v_mul_f32 v67, v115, v115
    v_mul_f32 v68, v116, v116
    v_mul_f32 v69, v117, v117
    v_mul_f32 v70, v118, v118
    v_mul_f32 v71, v119, v119
    v_fma_f32 v64, v64, s14, v15
    v_fma_f32 v65, v65, s14, v15
    v_fma_f32 v66, v66, s14, v15
    v_fma_f32 v67, v67, s14, v15
    v_fma_f32 v68, v68, s14, v15
    v_fma_f32 v69, v69, s14, v15
    v_fma_f32 v70, v70, s14, v15
    v_fma_f32 v71, v71, s14, v15
    v_mul_f32 v64, v64, v112
    v_mul_f32 v65, v65, v113
    v_mul_f32 v66, v66, v114
    v_mul_f32 v67, v67, v115
    v_mul_f32 v68, v68, v116
    v_mul_f32 v69, v69, v117
    v_mul_f32 v70, v70, v118
    v_mul_f32 v71, v71, v119
    v_exp_f32 v64, v64
    v_exp_f32 v65, v65
    v_exp_f32 v66, v66
    v_exp_f32 v67, v67
    v_exp_f32 v68, v68
    v_exp_f32 v69, v69
    v_exp_f32 v70, v70
    v_exp_f32 v71, v71
    v_add_f32 v64, 1.0, v64
    v_add_f32 v65, 1.0, v65
    v_add_f32 v66, 1.0, v66
    v_add_f32 v67, 1.0, v67
    v_add_f32 v68, 1.0, v68
    v_add_f32 v69, 1.0, v69
    v_add_f32 v70, 1.0, v70
    v_add_f32 v71, 1.0, v71
    v_rcp_f32 v64, v64
    v_rcp_f32 v65, v65
    v_rcp_f32 v66, v66
    v_rcp_f32 v67, v67
    v_rcp_f32 v68, v68
    v_rcp_f32 v69, v69
    v_rcp_f32 v70, v70
    v_rcp_f32 v71, v71
    v_mul_f32 v112, v112, v64
    v_mul_f32 v113, v113, v65
    v_mul_f32 v114, v114, v66
    v_mul_f32 v115, v115, v67
    v_mul_f32 v116, v116, v68
    v_mul_f32 v117, v117, v69
    v_mul_f32 v118, v118, v70
    v_mul_f32 v119, v119, v71
    v_add_f32 v28, v96, v97
    v_add_f32 v30, v100, v101
    v_mul_f32 v29, v96, v96
    v_mul_f32 v31, v100, v100
    v_add_f32 v64, v104, v105
    v_add_f32 v68, v108, v109
    v_mul_f32 v65, v104, v104
    v_mul_f32 v69, v108, v108
    v_add_f32 v28, v28, v98
    v_add_f32 v30, v30, v102
    v_add_f32 v28, v28, v99
    v_add_f32 v30, v30, v103
    v_fmac_f32 v29, v97, v97
    v_fmac_f32 v31, v101, v101
    v_fmac_f32 v29, v98, v98
    v_fmac_f32 v31, v102, v102
    v_fmac_f32 v29, v99, v99
    v_fmac_f32 v31, v103, v103
    v_add_f32 v64, v64, v106
    v_add_f32 v68, v68, v110
    v_add_f32 v64, v64, v107
    v_add_f32 v68, v68, v111
    v_add_f32 v64, v64, v112
    v_add_f32 v68, v68, v116
    v_add_f32 v64, v64, v113
    v_add_f32 v68, v68, v117
    v_add_f32 v64, v64, v114
    v_add_f32 v68, v68, v118
    v_add_f32 v64, v64, v115
    v_add_f32 v68, v68, v119
    v_fmac_f32 v65, v105, v105
    v_fmac_f32 v69, v109, v109
    v_fmac_f32 v65, v106, v106
    v_fmac_f32 v69, v110, v110
    v_fmac_f32 v65, v107, v107
    v_fmac_f32 v69, v111, v111
    v_fmac_f32 v65, v112, v112
    v_fmac_f32 v69, v116, v116
    v_fmac_f32 v65, v113, v113
    v_fmac_f32 v69, v117, v117
    v_fmac_f32 v65, v114, v114
    v_fmac_f32 v69, v118, v118
    v_fmac_f32 v65, v115, v115
    v_fmac_f32 v69, v119, v119
    v_fmac_f32 v28, s15, v64
    v_fmac_f32 v30, s15, v68
    v_fmac_f32 v29, s15, v65
    v_fmac_f32 v31, s15, v69
    s_nop 0
    s_nop 0
    v_permlane32_swap_b32 v28, v29
    v_permlane32_swap_b32 v30, v31
    v_add_f32 v28, v28, v29
    v_add_f32 v30, v30, v31
    v_mov_b32 v64, v28
    v_mov_b32 v68, v30
    s_nop 0
    s_nop 0
    v_permlane16_swap_b32 v28, v64
    v_permlane16_swap_b32 v30, v68
    v_add_f32 v28, v28, v64
    v_add_f32 v30, v30, v68
    v_mov_b32 v29, v28
    v_mov_b32 v31, v30
    s_nop 0
    s_nop 0
    v_permlane32_swap_b32 v28, v29
    v_permlane32_swap_b32 v30, v31
    s_lshl_b32 s65, s4, 14
    s_lshl_b32 s66, s5, 10
    s_add_u32 s66, s66, s65
    s_lshl_b32 s7, s3, 8
    v_lshlrev_b32 v8, 3, v3
    v_add_u32 v8, s7, v8
    buffer_store_dwordx2 v[28:29], v8, s[56:59], s66 offen sc1
    buffer_store_dwordx2 v[30:31], v8, s[56:59], s66 offen offset:128 sc1
    ds_read_b64_tr_b16 v[64:65], v18 offset:0
    ds_read_b64_tr_b16 v[66:67], v18 offset:256
    ds_read_b64_tr_b16 v[68:69], v19 offset:0
    ds_read_b64_tr_b16 v[70:71], v19 offset:256
    s_waitcnt lgkmcnt(0)
    ds_read_b64_tr_b16 v[72:73], v18 offset:2048
    ds_read_b64_tr_b16 v[74:75], v18 offset:2304
    v_mfma_f32_16x16x32_bf16 v[32:35], v[64:67], v[128:131], 0
    v_mfma_f32_16x16x32_bf16 v[36:39], v[64:67], v[132:135], 0
    v_mfma_f32_16x16x32_bf16 v[48:51], v[64:67], v[56:59], 0
    ds_read_b64_tr_b16 v[76:77], v19 offset:2048
    v_mfma_f32_16x16x32_bf16 v[40:43], v[68:71], v[128:131], 0
    v_mfma_f32_16x16x32_bf16 v[44:47], v[68:71], v[132:135], 0
    v_mfma_f32_16x16x32_bf16 v[52:55], v[68:71], v[56:59], 0
    ds_read_b64_tr_b16 v[78:79], v19 offset:2304
    s_waitcnt lgkmcnt(0)
    ds_read_b64_tr_b16 v[64:65], v18 offset:4096
    ds_read_b64_tr_b16 v[66:67], v18 offset:4352
    v_mfma_f32_16x16x32_bf16 v[32:35], v[72:75], v[136:139], v[32:35]
    v_mfma_f32_16x16x32_bf16 v[36:39], v[72:75], v[140:143], v[36:39]
    v_mfma_f32_16x16x32_bf16 v[48:51], v[72:75], v[56:59], v[48:51]
    ds_read_b64_tr_b16 v[68:69], v19 offset:4096
    v_mfma_f32_16x16x32_bf16 v[40:43], v[76:79], v[136:139], v[40:43]
    v_mfma_f32_16x16x32_bf16 v[44:47], v[76:79], v[140:143], v[44:47]
    v_mfma_f32_16x16x32_bf16 v[52:55], v[76:79], v[56:59], v[52:55]
    ds_read_b64_tr_b16 v[70:71], v19 offset:4352
    s_waitcnt lgkmcnt(0)
    ds_read_b64_tr_b16 v[72:73], v18 offset:6144
    ds_read_b64_tr_b16 v[74:75], v18 offset:6400
    v_mfma_f32_16x16x32_bf16 v[32:35], v[64:67], v[144:147], v[32:35]
    v_mfma_f32_16x16x32_bf16 v[36:39], v[64:67], v[148:151], v[36:39]
    v_mfma_f32_16x16x32_bf16 v[48:51], v[64:67], v[56:59], v[48:51]
    ds_read_b64_tr_b16 v[76:77], v19 offset:6144
    v_mfma_f32_16x16x32_bf16 v[40:43], v[68:71], v[144:147], v[40:43]
    v_mfma_f32_16x16x32_bf16 v[44:47], v[68:71], v[148:151], v[44:47]
    v_mfma_f32_16x16x32_bf16 v[52:55], v[68:71], v[56:59], v[52:55]
    ds_read_b64_tr_b16 v[78:79], v19 offset:6400
    s_waitcnt lgkmcnt(0)
    ds_read_b64_tr_b16 v[64:65], v18 offset:8192
    ds_read_b64_tr_b16 v[66:67], v18 offset:8448
    v_mfma_f32_16x16x32_bf16 v[32:35], v[72:75], v[152:155], v[32:35]
    v_mfma_f32_16x16x32_bf16 v[36:39], v[72:75], v[156:159], v[36:39]
    v_mfma_f32_16x16x32_bf16 v[48:51], v[72:75], v[56:59], v[48:51]
    ds_read_b64_tr_b16 v[68:69], v19 offset:8192
    v_mfma_f32_16x16x32_bf16 v[40:43], v[76:79], v[152:155], v[40:43]
    v_mfma_f32_16x16x32_bf16 v[44:47], v[76:79], v[156:159], v[44:47]
    v_mfma_f32_16x16x32_bf16 v[52:55], v[76:79], v[56:59], v[52:55]
    ds_read_b64_tr_b16 v[70:71], v19 offset:8448
    s_waitcnt lgkmcnt(0)
    ds_read_b64_tr_b16 v[72:73], v18 offset:10240
    ds_read_b64_tr_b16 v[74:75], v18 offset:10496
    v_mfma_f32_16x16x32_bf16 v[32:35], v[64:67], v[160:163], v[32:35]
    v_mfma_f32_16x16x32_bf16 v[36:39], v[64:67], v[164:167], v[36:39]
    v_mfma_f32_16x16x32_bf16 v[48:51], v[64:67], v[56:59], v[48:51]
    ds_read_b64_tr_b16 v[76:77], v19 offset:10240
    v_mfma_f32_16x16x32_bf16 v[40:43], v[68:71], v[160:163], v[40:43]
    v_mfma_f32_16x16x32_bf16 v[44:47], v[68:71], v[164:167], v[44:47]
    v_mfma_f32_16x16x32_bf16 v[52:55], v[68:71], v[56:59], v[52:55]
    ds_read_b64_tr_b16 v[78:79], v19 offset:10496
    s_waitcnt lgkmcnt(0)
    ds_read_b64_tr_b16 v[64:65], v18 offset:12288
    ds_read_b64_tr_b16 v[66:67], v18 offset:12544
    v_mfma_f32_16x16x32_bf16 v[32:35], v[72:75], v[168:171], v[32:35]
    v_mfma_f32_16x16x32_bf16 v[36:39], v[72:75], v[172:175], v[36:39]
    v_mfma_f32_16x16x32_bf16 v[48:51], v[72:75], v[56:59], v[48:51]
    ds_read_b64_tr_b16 v[68:69], v19 offset:12288
    v_mfma_f32_16x16x32_bf16 v[40:43], v[76:79], v[168:171], v[40:43]
    v_mfma_f32_16x16x32_bf16 v[44:47], v[76:79], v[172:175], v[44:47]
    v_mfma_f32_16x16x32_bf16 v[52:55], v[76:79], v[56:59], v[52:55]
    ds_read_b64_tr_b16 v[70:71], v19 offset:12544
    s_waitcnt lgkmcnt(0)
    ds_read_b64_tr_b16 v[72:73], v18 offset:14336
    ds_read_b64_tr_b16 v[74:75], v18 offset:14592
    v_mfma_f32_16x16x32_bf16 v[32:35], v[64:67], v[176:179], v[32:35]
    v_mfma_f32_16x16x32_bf16 v[36:39], v[64:67], v[180:183], v[36:39]
    v_mfma_f32_16x16x32_bf16 v[48:51], v[64:67], v[56:59], v[48:51]
    ds_read_b64_tr_b16 v[76:77], v19 offset:14336
    v_mfma_f32_16x16x32_bf16 v[40:43], v[68:71], v[176:179], v[40:43]
    v_mfma_f32_16x16x32_bf16 v[44:47], v[68:71], v[180:183], v[44:47]
    v_mfma_f32_16x16x32_bf16 v[52:55], v[68:71], v[56:59], v[52:55]
    ds_read_b64_tr_b16 v[78:79], v19 offset:14592
    s_waitcnt lgkmcnt(0)
    v_mfma_f32_16x16x32_bf16 v[32:35], v[72:75], v[184:187], v[32:35]
    v_mfma_f32_16x16x32_bf16 v[36:39], v[72:75], v[188:191], v[36:39]
    v_mfma_f32_16x16x32_bf16 v[48:51], v[72:75], v[56:59], v[48:51]
    v_mfma_f32_16x16x32_bf16 v[40:43], v[76:79], v[184:187], v[40:43]
    v_mfma_f32_16x16x32_bf16 v[44:47], v[76:79], v[188:191], v[44:47]
    v_mfma_f32_16x16x32_bf16 v[52:55], v[76:79], v[56:59], v[52:55]
    s_waitcnt vmcnt(0)
    s_barrier
    s_cmp_lg_u32 s3, 0
    s_cbranch_scc1 Lsig3681
    v_mov_b32 v5, 1
    s_lshl_b32 s7, s4, 4
    v_mov_b32 v6, s7
    s_mov_b64 s[12:13], exec
    s_mov_b64 exec, 1
    buffer_atomic_add v5, v6, s[60:63], 0 offen sc1
    s_mov_b64 exec, s[12:13]
Lsig3681:
    s_mov_b32 s40, s28
    s_mov_b32 s41, s29
    s_mov_b32 s42, 8388608
    s_mov_b32 s43, 0x20000
    s_and_b32 s7, s2, 7
    s_lshl_b32 s7, s7, 20
    s_lshr_b32 s8, s2, 3
    s_lshl_b32 s8, s8, 2
    s_add_u32 s8, s8, s3
    s_mul_i32 s8, s8, 5120
    s_add_u32 s7, s7, s8
    v_add_u32 v12, s7, v12
    v_add_u32 v13, 0x1000, v12
    buffer_load_dwordx4 v[128:131], v12, s[40:43], 0 offen offset:0
    buffer_load_dwordx4 v[132:135], v12, s[40:43], 0 offen offset:1024
    buffer_load_dwordx4 v[136:139], v12, s[40:43], 0 offen offset:2048
    buffer_load_dwordx4 v[140:143], v12, s[40:43], 0 offen offset:3072
    buffer_load_dwordx4 v[144:147], v13, s[40:43], 0 offen offset:0
    ds_read_b64_tr_b16 v[64:65], v16 offset:0
    ds_read_b64_tr_b16 v[66:67], v16 offset:256
    ds_read_b64_tr_b16 v[68:69], v17 offset:0
    ds_read_b64_tr_b16 v[70:71], v17 offset:256
    s_waitcnt lgkmcnt(0)
    ds_read_b64_tr_b16 v[72:73], v16 offset:2048
    ds_read_b64_tr_b16 v[74:75], v16 offset:2304
    v_mfma_f32_16x16x32_bf16 v[32:35], v[64:67], v[192:195], v[32:35]
    v_mfma_f32_16x16x32_bf16 v[36:39], v[64:67], v[196:199], v[36:39]
    v_mfma_f32_16x16x32_bf16 v[48:51], v[64:67], v[56:59], v[48:51]
    ds_read_b64_tr_b16 v[76:77], v17 offset:2048
    v_mfma_f32_16x16x32_bf16 v[40:43], v[68:71], v[192:195], v[40:43]
    v_mfma_f32_16x16x32_bf16 v[44:47], v[68:71], v[196:199], v[44:47]
    v_mfma_f32_16x16x32_bf16 v[52:55], v[68:71], v[56:59], v[52:55]
    ds_read_b64_tr_b16 v[78:79], v17 offset:2304
    s_waitcnt lgkmcnt(0)
    ds_read_b64_tr_b16 v[64:65], v16 offset:4096
    ds_read_b64_tr_b16 v[66:67], v16 offset:4352
    v_mfma_f32_16x16x32_bf16 v[32:35], v[72:75], v[200:203], v[32:35]
    v_mfma_f32_16x16x32_bf16 v[36:39], v[72:75], v[204:207], v[36:39]
    v_mfma_f32_16x16x32_bf16 v[48:51], v[72:75], v[56:59], v[48:51]
    ds_read_b64_tr_b16 v[68:69], v17 offset:4096
    v_mfma_f32_16x16x32_bf16 v[40:43], v[76:79], v[200:203], v[40:43]
    v_mfma_f32_16x16x32_bf16 v[44:47], v[76:79], v[204:207], v[44:47]
    v_mfma_f32_16x16x32_bf16 v[52:55], v[76:79], v[56:59], v[52:55]
    ds_read_b64_tr_b16 v[70:71], v17 offset:4352
    s_waitcnt lgkmcnt(0)
    ds_read_b64_tr_b16 v[72:73], v16 offset:6144
    ds_read_b64_tr_b16 v[74:75], v16 offset:6400
    v_mfma_f32_16x16x32_bf16 v[32:35], v[64:67], v[208:211], v[32:35]
    v_mfma_f32_16x16x32_bf16 v[36:39], v[64:67], v[212:215], v[36:39]
    v_mfma_f32_16x16x32_bf16 v[48:51], v[64:67], v[56:59], v[48:51]
    ds_read_b64_tr_b16 v[76:77], v17 offset:6144
    v_mfma_f32_16x16x32_bf16 v[40:43], v[68:71], v[208:211], v[40:43]
    v_mfma_f32_16x16x32_bf16 v[44:47], v[68:71], v[212:215], v[44:47]
    v_mfma_f32_16x16x32_bf16 v[52:55], v[68:71], v[56:59], v[52:55]
    ds_read_b64_tr_b16 v[78:79], v17 offset:6400
    s_waitcnt lgkmcnt(0)
    ds_read_b64_tr_b16 v[64:65], v16 offset:8192
    ds_read_b64_tr_b16 v[66:67], v16 offset:8448
    v_mfma_f32_16x16x32_bf16 v[32:35], v[72:75], v[216:219], v[32:35]
    v_mfma_f32_16x16x32_bf16 v[36:39], v[72:75], v[220:223], v[36:39]
    v_mfma_f32_16x16x32_bf16 v[48:51], v[72:75], v[56:59], v[48:51]
    ds_read_b64_tr_b16 v[68:69], v17 offset:8192
    v_mfma_f32_16x16x32_bf16 v[40:43], v[76:79], v[216:219], v[40:43]
    v_mfma_f32_16x16x32_bf16 v[44:47], v[76:79], v[220:223], v[44:47]
    v_mfma_f32_16x16x32_bf16 v[52:55], v[76:79], v[56:59], v[52:55]
    ds_read_b64_tr_b16 v[70:71], v17 offset:8448
    s_waitcnt lgkmcnt(0)
    ds_read_b64_tr_b16 v[72:73], v16 offset:10240
    ds_read_b64_tr_b16 v[74:75], v16 offset:10496
    v_mfma_f32_16x16x32_bf16 v[32:35], v[64:67], v[224:227], v[32:35]
    v_mfma_f32_16x16x32_bf16 v[36:39], v[64:67], v[228:231], v[36:39]
    v_mfma_f32_16x16x32_bf16 v[48:51], v[64:67], v[56:59], v[48:51]
    ds_read_b64_tr_b16 v[76:77], v17 offset:10240
    v_mfma_f32_16x16x32_bf16 v[40:43], v[68:71], v[224:227], v[40:43]
    v_mfma_f32_16x16x32_bf16 v[44:47], v[68:71], v[228:231], v[44:47]
    v_mfma_f32_16x16x32_bf16 v[52:55], v[68:71], v[56:59], v[52:55]
    ds_read_b64_tr_b16 v[78:79], v17 offset:10496
    s_waitcnt lgkmcnt(0)
    ds_read_b64_tr_b16 v[64:65], v16 offset:12288
    ds_read_b64_tr_b16 v[66:67], v16 offset:12544
    v_mfma_f32_16x16x32_bf16 v[32:35], v[72:75], v[232:235], v[32:35]
    v_mfma_f32_16x16x32_bf16 v[36:39], v[72:75], v[236:239], v[36:39]
    v_mfma_f32_16x16x32_bf16 v[48:51], v[72:75], v[56:59], v[48:51]
    ds_read_b64_tr_b16 v[68:69], v17 offset:12288
    v_mfma_f32_16x16x32_bf16 v[40:43], v[76:79], v[232:235], v[40:43]
    v_mfma_f32_16x16x32_bf16 v[44:47], v[76:79], v[236:239], v[44:47]
    v_mfma_f32_16x16x32_bf16 v[52:55], v[76:79], v[56:59], v[52:55]
    ds_read_b64_tr_b16 v[70:71], v17 offset:12544
    s_waitcnt lgkmcnt(0)
    ds_read_b64_tr_b16 v[72:73], v16 offset:14336
    ds_read_b64_tr_b16 v[74:75], v16 offset:14592
    v_mfma_f32_16x16x32_bf16 v[32:35], v[64:67], v[240:243], v[32:35]
    v_mfma_f32_16x16x32_bf16 v[36:39], v[64:67], v[244:247], v[36:39]
    v_mfma_f32_16x16x32_bf16 v[48:51], v[64:67], v[56:59], v[48:51]
    ds_read_b64_tr_b16 v[76:77], v17 offset:14336
    v_mfma_f32_16x16x32_bf16 v[40:43], v[68:71], v[240:243], v[40:43]
    v_mfma_f32_16x16x32_bf16 v[44:47], v[68:71], v[244:247], v[44:47]
    v_mfma_f32_16x16x32_bf16 v[52:55], v[68:71], v[56:59], v[52:55]
    ds_read_b64_tr_b16 v[78:79], v17 offset:14592
    s_waitcnt lgkmcnt(0)
    v_mfma_f32_16x16x32_bf16 v[32:35], v[72:75], v[248:251], v[32:35]
    v_mfma_f32_16x16x32_bf16 v[36:39], v[72:75], v[252:255], v[36:39]
    v_mfma_f32_16x16x32_bf16 v[48:51], v[72:75], v[56:59], v[48:51]
    v_mfma_f32_16x16x32_bf16 v[40:43], v[76:79], v[248:251], v[40:43]
    v_mfma_f32_16x16x32_bf16 v[44:47], v[76:79], v[252:255], v[44:47]
    v_mfma_f32_16x16x32_bf16 v[52:55], v[76:79], v[56:59], v[52:55]
    s_mul_i32 s64, s5, 1536
    s_lshr_b32 s7, s6, 4
    s_mul_i32 s7, s7, 22528
    s_add_u32 s7, s7, s64
    v_lshrrev_b32 v10, 1, v4
    v_lshlrev_b32 v10, 8, v10
    v_lshl_add_u32 v10, v3, 4, v10
    v_and_b32 v11, 1, v4
    v_lshl_add_u32 v10, v11, 3, v10
    v_add_u32 v10, s7, v10
    v_add_u32 v11, 22528, v10
    v_mul_f32 v80, v120, v120
    v_mul_f32 v81, v121, v121
    v_mul_f32 v82, v122, v122
    v_mul_f32 v83, v123, v123
    v_mul_f32 v84, v124, v124
    v_mul_f32 v85, v125, v125
    v_mul_f32 v86, v126, v126
    v_mul_f32 v87, v127, v127
    v_fma_f32 v80, v80, s14, v15
    v_fma_f32 v81, v81, s14, v15
    v_fma_f32 v82, v82, s14, v15
    v_fma_f32 v83, v83, s14, v15
    v_fma_f32 v84, v84, s14, v15
    v_fma_f32 v85, v85, s14, v15
    v_fma_f32 v86, v86, s14, v15
    v_fma_f32 v87, v87, s14, v15
    v_mul_f32 v80, v80, v120
    v_mul_f32 v81, v81, v121
    v_mul_f32 v82, v82, v122
    v_mul_f32 v83, v83, v123
    v_mul_f32 v84, v84, v124
    v_mul_f32 v85, v85, v125
    v_mul_f32 v86, v86, v126
    v_mul_f32 v87, v87, v127
    v_exp_f32 v80, v80
    v_exp_f32 v81, v81
    v_exp_f32 v82, v82
    v_exp_f32 v83, v83
    v_exp_f32 v84, v84
    v_exp_f32 v85, v85
    v_exp_f32 v86, v86
    v_exp_f32 v87, v87
    v_add_f32 v80, 1.0, v80
    v_add_f32 v81, 1.0, v81
    v_add_f32 v82, 1.0, v82
    v_add_f32 v83, 1.0, v83
    v_add_f32 v84, 1.0, v84
    v_add_f32 v85, 1.0, v85
    v_add_f32 v86, 1.0, v86
    v_add_f32 v87, 1.0, v87
    v_rcp_f32 v80, v80
    v_rcp_f32 v81, v81
    v_rcp_f32 v82, v82
    v_rcp_f32 v83, v83
    v_rcp_f32 v84, v84
    v_rcp_f32 v85, v85
    v_rcp_f32 v86, v86
    v_rcp_f32 v87, v87
    v_mul_f32 v120, v120, v80
    v_mul_f32 v121, v121, v81
    v_mul_f32 v122, v122, v82
    v_mul_f32 v123, v123, v83
    v_mul_f32 v124, v124, v84
    v_mul_f32 v125, v125, v85
    v_mul_f32 v126, v126, v86
    v_mul_f32 v127, v127, v87
    v_cvt_pk_bf16_f32 v120, v120, v121
    v_cvt_pk_bf16_f32 v121, v122, v123
    v_cvt_pk_bf16_f32 v124, v124, v125
    v_cvt_pk_bf16_f32 v125, v126, v127
    buffer_store_dwordx2 v[120:121], v10, s[48:51], 0 offen offset:0
    buffer_store_dwordx2 v[124:125], v11, s[48:51], 0 offen offset:0
    s_cmp_eq_u32 s5, 14
    s_cbranch_scc1 k2b_s1
    v_mul_f32 v32, v32, v20
    v_mul_f32 v33, v33, v20
    v_mul_f32 v34, v34, v20
    v_mul_f32 v35, v35, v20
    v_fmac_f32 v32, v48, v21
    v_fmac_f32 v33, v49, v21
    v_fmac_f32 v34, v50, v21
    v_fmac_f32 v35, v51, v21
    v_mul_f32 v36, v36, v22
    v_mul_f32 v37, v37, v22
    v_mul_f32 v38, v38, v22
    v_mul_f32 v39, v39, v22
    v_fmac_f32 v36, v48, v23
    v_fmac_f32 v37, v49, v23
    v_fmac_f32 v38, v50, v23
    v_fmac_f32 v39, v51, v23
    v_mul_f32 v40, v40, v20
    v_mul_f32 v41, v41, v20
    v_mul_f32 v42, v42, v20
    v_mul_f32 v43, v43, v20
    v_fmac_f32 v40, v52, v21
    v_fmac_f32 v41, v53, v21
    v_fmac_f32 v42, v54, v21
    v_fmac_f32 v43, v55, v21
    v_mul_f32 v44, v44, v22
    v_mul_f32 v45, v45, v22
    v_mul_f32 v46, v46, v22
    v_mul_f32 v47, v47, v22
    v_fmac_f32 v44, v52, v23
    v_fmac_f32 v45, v53, v23
    v_fmac_f32 v46, v54, v23
    v_fmac_f32 v47, v55, v23
    v_mul_f32 v80, v32, v32
    v_mul_f32 v81, v33, v33
    v_mul_f32 v82, v34, v34
    v_mul_f32 v83, v35, v35
    v_mul_f32 v84, v36, v36
    v_mul_f32 v85, v37, v37
    v_mul_f32 v86, v38, v38
    v_mul_f32 v87, v39, v39
    v_fma_f32 v80, v80, s14, v15
    v_fma_f32 v81, v81, s14, v15
    v_fma_f32 v82, v82, s14, v15
    v_fma_f32 v83, v83, s14, v15
    v_fma_f32 v84, v84, s14, v15
    v_fma_f32 v85, v85, s14, v15
    v_fma_f32 v86, v86, s14, v15
    v_fma_f32 v87, v87, s14, v15
    v_mul_f32 v80, v80, v32
    v_mul_f32 v81, v81, v33
    v_mul_f32 v82, v82, v34
    v_mul_f32 v83, v83, v35
    v_mul_f32 v84, v84, v36
    v_mul_f32 v85, v85, v37
    v_mul_f32 v86, v86, v38
    v_mul_f32 v87, v87, v39
    v_exp_f32 v80, v80
    v_exp_f32 v81, v81
    v_exp_f32 v82, v82
    v_exp_f32 v83, v83
    v_exp_f32 v84, v84
    v_exp_f32 v85, v85
    v_exp_f32 v86, v86
    v_exp_f32 v87, v87
    v_add_f32 v80, 1.0, v80
    v_add_f32 v81, 1.0, v81
    v_add_f32 v82, 1.0, v82
    v_add_f32 v83, 1.0, v83
    v_add_f32 v84, 1.0, v84
    v_add_f32 v85, 1.0, v85
    v_add_f32 v86, 1.0, v86
    v_add_f32 v87, 1.0, v87
    v_rcp_f32 v80, v80
    v_rcp_f32 v81, v81
    v_rcp_f32 v82, v82
    v_rcp_f32 v83, v83
    v_rcp_f32 v84, v84
    v_rcp_f32 v85, v85
    v_rcp_f32 v86, v86
    v_rcp_f32 v87, v87
    v_mul_f32 v32, v32, v80
    v_mul_f32 v33, v33, v81
    v_mul_f32 v34, v34, v82
    v_mul_f32 v35, v35, v83
    v_mul_f32 v36, v36, v84
    v_mul_f32 v37, v37, v85
    v_mul_f32 v38, v38, v86
    v_mul_f32 v39, v39, v87
    v_mul_f32 v80, v40, v40
    v_mul_f32 v81, v41, v41
    v_mul_f32 v82, v42, v42
    v_mul_f32 v83, v43, v43
    v_mul_f32 v84, v44, v44
    v_mul_f32 v85, v45, v45
    v_mul_f32 v86, v46, v46
    v_mul_f32 v87, v47, v47
    v_fma_f32 v80, v80, s14, v15
    v_fma_f32 v81, v81, s14, v15
    v_fma_f32 v82, v82, s14, v15
    v_fma_f32 v83, v83, s14, v15
    v_fma_f32 v84, v84, s14, v15
    v_fma_f32 v85, v85, s14, v15
    v_fma_f32 v86, v86, s14, v15
    v_fma_f32 v87, v87, s14, v15
    v_mul_f32 v80, v80, v40
    v_mul_f32 v81, v81, v41
    v_mul_f32 v82, v82, v42
    v_mul_f32 v83, v83, v43
    v_mul_f32 v84, v84, v44
    v_mul_f32 v85, v85, v45
    v_mul_f32 v86, v86, v46
    v_mul_f32 v87, v87, v47
    v_exp_f32 v80, v80
    v_exp_f32 v81, v81
    v_exp_f32 v82, v82
    v_exp_f32 v83, v83
    v_exp_f32 v84, v84
    v_exp_f32 v85, v85
    v_exp_f32 v86, v86
    v_exp_f32 v87, v87
    v_add_f32 v80, 1.0, v80
    v_add_f32 v81, 1.0, v81
    v_add_f32 v82, 1.0, v82
    v_add_f32 v83, 1.0, v83
    v_add_f32 v84, 1.0, v84
    v_add_f32 v85, 1.0, v85
    v_add_f32 v86, 1.0, v86
    v_add_f32 v87, 1.0, v87
    v_rcp_f32 v80, v80
    v_rcp_f32 v81, v81
    v_rcp_f32 v82, v82
    v_rcp_f32 v83, v83
    v_rcp_f32 v84, v84
    v_rcp_f32 v85, v85
    v_rcp_f32 v86, v86
    v_rcp_f32 v87, v87
    v_mul_f32 v40, v40, v80
    v_mul_f32 v41, v41, v81
    v_mul_f32 v42, v42, v82
    v_mul_f32 v43, v43, v83
    v_mul_f32 v44, v44, v84
    v_mul_f32 v45, v45, v85
    v_mul_f32 v46, v46, v86
    v_mul_f32 v47, v47, v87
    v_cvt_pk_bf16_f32 v32, v32, v33
    v_cvt_pk_bf16_f32 v33, v34, v35
    v_cvt_pk_bf16_f32 v36, v36, v37
    v_cvt_pk_bf16_f32 v37, v38, v39
    buffer_store_dwordx2 v[32:33], v10, s[48:51], 0 offen offset:512
    buffer_store_dwordx2 v[36:37], v11, s[48:51], 0 offen offset:512
    v_cvt_pk_bf16_f32 v40, v40, v41
    v_cvt_pk_bf16_f32 v41, v42, v43
    v_cvt_pk_bf16_f32 v44, v44, v45
    v_cvt_pk_bf16_f32 v45, v46, v47
    buffer_store_dwordx2 v[40:41], v10, s[48:51], 0 offen offset:1024
    buffer_store_dwordx2 v[44:45], v11, s[48:51], 0 offen offset:1024
k2b_s1:
    v_lshl_add_u32 v8, v4, 10, v8
    v_mov_b32 v9, 0x7fff0000
    v_cmp_eq_u32 vcc, 3, v4
    s_nop 1
    v_cndmask_b32 v9, v8, v9, vcc
    v_lshrrev_b32 v10, 3, v3
    v_lshlrev_b32 v10, 11, v10
    v_and_b32 v11, 7, v3
    v_lshl_add_u32 v10, v11, 6, v10
    v_lshl_add_u32 v10, v4, 3, v10
    s_lshl_b32 s7, s4, 13
    s_lshl_b32 s8, s3, 9
    s_add_u32 s7, s7, s8
    v_add_u32 v10, s7, v10
    v_add_u32 v11, 0x1000, v10
    s_mul_i32 s64, s5, 3
    s_add_u32 s7, s64, 0
    s_lshr_b32 s8, s7, 1
    s_lshl_b32 s8, s8, 17
    s_xor_b32 s7, s7, s3
    s_and_b32 s7, s7, 1
    s_lshl_b32 s7, s7, 5
    s_add_u32 s76, s7, s8
    s_add_u32 s7, s64, 1
    s_lshr_b32 s8, s7, 1
    s_lshl_b32 s8, s8, 17
    s_xor_b32 s7, s7, s3
    s_and_b32 s7, s7, 1
    s_lshl_b32 s7, s7, 5
    s_add_u32 s77, s7, s8
    s_add_u32 s7, s64, 2
    s_lshr_b32 s8, s7, 1
    s_lshl_b32 s8, s8, 17
    s_xor_b32 s7, s7, s3
    s_and_b32 s7, s7, 1
    s_lshl_b32 s7, s7, 5
    s_add_u32 s78, s7, s8
    s_cmp_lg_u32 s3, 0
    s_cbranch_scc1 Lpd4066
    s_lshl_b32 s7, s4, 4
    v_mov_b32 v6, s7
    s_mov_b32 s12, 0x40000
Lp4066:
    buffer_load_dword v5, v6, s[60:63], 0 offen sc1
    s_waitcnt vmcnt(0)
    v_readfirstlane_b32 s7, v5
    s_cmp_ge_u32 s7, 15
    s_cbranch_scc1 Lpd4066
    s_sub_u32 s12, s12, 1
    s_cmp_eq_u32 s12, 0
    s_cbranch_scc1 Lpd4066
    s_sleep 1
    s_branch Lp4066
Lpd4066:
    s_barrier
    s_add_u32 s66, s65, 0
    buffer_load_dwordx2 v[64:65], v8, s[56:59], s66 offen offset:0 sc1
    buffer_load_dwordx2 v[72:73], v8, s[56:59], s66 offen offset:128 sc1
    s_add_u32 s66, s65, 4096
    buffer_load_dwordx2 v[66:67], v8, s[56:59], s66 offen offset:0 sc1
    buffer_load_dwordx2 v[74:75], v8, s[56:59], s66 offen offset:128 sc1
    s_add_u32 s66, s65, 8192
    buffer_load_dwordx2 v[68:69], v8, s[56:59], s66 offen offset:0 sc1
    buffer_load_dwordx2 v[76:77], v8, s[56:59], s66 offen offset:128 sc1
    s_add_u32 s66, s65, 12288
    buffer_load_dwordx2 v[70:71], v9, s[56:59], s66 offen offset:0 sc1
    buffer_load_dwordx2 v[78:79], v9, s[56:59], s66 offen offset:128 sc1
    s_waitcnt vmcnt(0)
    v_pk_add_f32 v[64:65], v[64:65], v[66:67]
    v_pk_add_f32 v[68:69], v[68:69], v[70:71]
    v_pk_add_f32 v[64:65], v[64:65], v[68:69]
    v_pk_add_f32 v[72:73], v[72:73], v[74:75]
    v_pk_add_f32 v[76:77], v[76:77], v[78:79]
    v_pk_add_f32 v[72:73], v[72:73], v[76:77]
    s_nop 1
    v_permlane32_swap_b32 v64, v65
    v_permlane32_swap_b32 v72, v73
    v_add_f32 v64, v64, v65
    v_add_f32 v72, v72, v73
    v_mov_b32 v66, v64
    v_mov_b32 v74, v72
    s_nop 0
    s_nop 0
    v_permlane16_swap_b32 v64, v66
    v_permlane16_swap_b32 v72, v74
    v_add_f32 v64, v64, v66
    v_add_f32 v72, v72, v74
    v_mov_b32 v65, v64
    v_mov_b32 v73, v72
    s_nop 0
    s_nop 0
    v_permlane32_swap_b32 v64, v65
    v_permlane32_swap_b32 v72, v73
    v_mul_f32 v64, 0x3abe82fa, v64
    v_mul_f32 v72, 0x3abe82fa, v72
    v_mul_f32 v65, 0x3abe82fa, v65
    v_mul_f32 v73, 0x3abe82fa, v73
    v_fma_f32 v65, -v64, v64, v65
    v_fma_f32 v73, -v72, v72, v73
    v_max_f32 v65, 0, v65
    v_max_f32 v73, 0, v73
    v_add_f32 v65, 0x3727c5ac, v65
    v_add_f32 v73, 0x3727c5ac, v73
    v_rsq_f32 v66, v65
    v_rsq_f32 v74, v73
    v_mul_f32 v65, v64, v66
    v_mul_f32 v73, v72, v74
    v_sub_f32 v65, 0, v65
    v_sub_f32 v73, 0, v73
    v_fma_f32 v96, v96, v66, v65
    v_fma_f32 v97, v97, v66, v65
    v_fma_f32 v98, v98, v66, v65
    v_fma_f32 v99, v99, v66, v65
    v_fma_f32 v100, v100, v74, v73
    v_fma_f32 v101, v101, v74, v73
    v_fma_f32 v102, v102, v74, v73
    v_fma_f32 v103, v103, v74, v73
    v_cvt_pk_bf16_f32 v96, v96, v97
    v_cvt_pk_bf16_f32 v97, v98, v99
    v_cvt_pk_bf16_f32 v100, v100, v101
    v_cvt_pk_bf16_f32 v101, v102, v103
    buffer_store_dwordx2 v[96:97], v10, s[52:55], s76 offen offset:0
    buffer_store_dwordx2 v[100:101], v11, s[52:55], s76 offen offset:0
    s_cmp_eq_u32 s5, 14
    s_cbranch_scc1 k2b_kernel_fin
    v_fma_f32 v104, v104, v66, v65
    v_fma_f32 v105, v105, v66, v65
    v_fma_f32 v106, v106, v66, v65
    v_fma_f32 v107, v107, v66, v65
    v_fma_f32 v108, v108, v74, v73
    v_fma_f32 v109, v109, v74, v73
    v_fma_f32 v110, v110, v74, v73
    v_fma_f32 v111, v111, v74, v73
    v_cvt_pk_bf16_f32 v104, v104, v105
    v_cvt_pk_bf16_f32 v105, v106, v107
    v_cvt_pk_bf16_f32 v108, v108, v109
    v_cvt_pk_bf16_f32 v109, v110, v111
    buffer_store_dwordx2 v[104:105], v10, s[52:55], s77 offen offset:0
    buffer_store_dwordx2 v[108:109], v11, s[52:55], s77 offen offset:0
    v_fma_f32 v112, v112, v66, v65
    v_fma_f32 v113, v113, v66, v65
    v_fma_f32 v114, v114, v66, v65
    v_fma_f32 v115, v115, v66, v65
    v_fma_f32 v116, v116, v74, v73
    v_fma_f32 v117, v117, v74, v73
    v_fma_f32 v118, v118, v74, v73
    v_fma_f32 v119, v119, v74, v73
    v_cvt_pk_bf16_f32 v112, v112, v113
    v_cvt_pk_bf16_f32 v113, v114, v115
    v_cvt_pk_bf16_f32 v116, v116, v117
    v_cvt_pk_bf16_f32 v117, v118, v119
    buffer_store_dwordx2 v[112:113], v10, s[52:55], s78 offen offset:0
    buffer_store_dwordx2 v[116:117], v11, s[52:55], s78 offen offset:0
k2b_kernel_fin:
k2b_kernel_end:
    s_endpgm
.globl k3_kernel
.p2align 8
.type k3_kernel,@function
k3_kernel:
    s_cmp_ge_u32 s2, 256
    s_cbranch_scc1 k3_kernel_end
    s_load_dwordx16 s[16:31], s[0:1], 0
    s_load_dwordx8 s[32:39], s[0:1], 64
    v_and_b32 v1, 63, v0
    v_lshrrev_b32 v2, 6, v0
    v_and_b32 v3, 15, v0
    v_readfirstlane_b32 s3, v2
    v_lshrrev_b32 v4, 4, v1
    s_and_b32 s4, s2, 7
    s_lshl_b32 s4, s4, 2
    s_bfe_u32 s5, s2, 0x20003
    s_add_u32 s4, s4, s5
    s_lshr_b32 s5, s2, 5
    s_lshl_b32 s6, s4, 6
    s_waitcnt lgkmcnt(0)
    s_mov_b32 s40, s28
    s_mov_b32 s41, s29
    s_mov_b32 s42, 8388608
    s_mov_b32 s43, 0x20000
    s_add_u32 s44, s38, 9437184
    s_addc_u32 s45, s39, 0
    s_mov_b32 s46, 2883584
    s_mov_b32 s47, 0x20000
    s_add_u32 s48, s38, 6291456
    s_addc_u32 s49, s39, 0
    s_mov_b32 s50, 2883584
    s_mov_b32 s51, 0x20000
    s_add_u32 s52, s38, 12582912
    s_addc_u32 s53, s39, 0
    s_mov_b32 s54, 2883584
    s_mov_b32 s55, 0x20000
    s_mov_b32 s56, s30
    s_mov_b32 s57, s31
    s_mov_b32 s58, 4096
    s_mov_b32 s59, 0x20000
    v_and_b32 v10, 12, v1
    v_add_u32 v10, s6, v10
    s_movk_i32 s7, 4096
    v_mul_lo_u32 v10, v10, s7
    v_lshl_add_u32 v10, v4, 6, v10
    v_and_b32 v11, 3, v1
    v_lshl_add_u32 v10, v11, 4, v10
    v_add_u32 v11, 65536, v10
    s_lshl_b32 s7, s3, 10
    v_add_u32 v10, s7, v10
    v_add_u32 v11, s7, v11
    v_add_u32 v12, 0x20000, v10
    v_add_u32 v13, 0x20000, v11
    v_lshlrev_b32 v14, 4, v1
    s_mul_i32 s9, s3, 30720
    s_lshl_b32 s10, s3, 15
    s_mul_i32 s64, s5, 3
    s_mov_b32 s80, 0
    s_mov_b32 s81, 0x1000
    s_mov_b32 s82, 0x2000
    s_mov_b32 s83, 0x3000
    s_add_u32 s7, s64, 0
    s_min_u32 s7, s7, 21
    s_lshl_b32 s7, s7, 17
    s_add_u32 s76, s7, s10
    s_add_u32 s7, s64, 1
    s_min_u32 s7, s7, 21
    s_lshl_b32 s7, s7, 17
    s_add_u32 s77, s7, s10
    s_add_u32 s7, s64, 2
    s_min_u32 s7, s7, 21
    s_lshl_b32 s7, s7, 17
    s_add_u32 s78, s7, s10
    buffer_load_dwordx4 v[64:67], v10, s[40:43], s80 offen offset:0
    buffer_load_dwordx4 v[68:71], v10, s[40:43], s81 offen offset:0
    buffer_load_dwordx4 v[72:75], v10, s[40:43], s82 offen offset:0
    buffer_load_dwordx4 v[76:79], v10, s[40:43], s83 offen offset:0
    buffer_load_dwordx4 v[80:83], v11, s[40:43], s80 offen offset:0
    buffer_load_dwordx4 v[84:87], v11, s[40:43], s81 offen offset:0
    buffer_load_dwordx4 v[88:91], v11, s[40:43], s82 offen offset:0
    buffer_load_dwordx4 v[92:95], v11, s[40:43], s83 offen offset:0
    buffer_load_dwordx4 v[96:99], v12, s[40:43], s80 offen offset:0
    buffer_load_dwordx4 v[100:103], v12, s[40:43], s81 offen offset:0
    buffer_load_dwordx4 v[104:107], v12, s[40:43], s82 offen offset:0
    buffer_load_dwordx4 v[108:111], v12, s[40:43], s83 offen offset:0
    buffer_load_dwordx4 v[112:115], v13, s[40:43], s80 offen offset:0
    buffer_load_dwordx4 v[116:119], v13, s[40:43], s81 offen offset:0
    buffer_load_dwordx4 v[120:123], v13, s[40:43], s82 offen offset:0
    buffer_load_dwordx4 v[124:127], v13, s[40:43], s83 offen offset:0
    s_add_u32 m0, s9, 0
    s_add_u32 s8, s76, 0
    buffer_load_dwordx4 v14, s[44:47], s8 offen lds
    buffer_load_dwordx4 v14, s[44:47], s8 offen offset:1024 lds
    s_add_u32 m0, s9, 2048
    s_add_u32 s8, s77, 0
    buffer_load_dwordx4 v14, s[44:47], s8 offen lds
    buffer_load_dwordx4 v14, s[44:47], s8 offen offset:1024 lds
    s_add_u32 m0, s9, 4096
    s_add_u32 s8, s78, 0
    buffer_load_dwordx4 v14, s[44:47], s8 offen lds
    buffer_load_dwordx4 v14, s[44:47], s8 offen offset:1024 lds
    s_add_u32 m0, s9, 6144
    s_add_u32 s8, s76, 2048
    buffer_load_dwordx4 v14, s[44:47], s8 offen lds
    buffer_load_dwordx4 v14, s[44:47], s8 offen offset:1024 lds
    s_add_u32 m0, s9, 8192
    s_add_u32 s8, s77, 2048
    buffer_load_dwordx4 v14, s[44:47], s8 offen lds
    buffer_load_dwordx4 v14, s[44:47], s8 offen offset:1024 lds
    s_add_u32 m0, s9, 10240
    s_add_u32 s8, s78, 2048
    buffer_load_dwordx4 v14, s[44:47], s8 offen lds
    buffer_load_dwordx4 v14, s[44:47], s8 offen offset:1024 lds
    buffer_load_dwordx4 v[128:131], v10, s[40:43], s80 offen offset:256
    buffer_load_dwordx4 v[132:135], v10, s[40:43], s81 offen offset:256
    buffer_load_dwordx4 v[136:139], v10, s[40:43], s82 offen offset:256
    buffer_load_dwordx4 v[140:143], v10, s[40:43], s83 offen offset:256
    s_mov_b32 s68, 0x55555555
    s_mov_b32 s69, 0x55555555
    s_mov_b32 s70, 0xaaaaaaaa
    s_mov_b32 s71, 0xaaaaaaaa
    s_mov_b32 s72, 0x33333333
    s_mov_b32 s73, 0x33333333
    s_mov_b32 s74, 0xcccccccc
    s_mov_b32 s75, 0xcccccccc
    v_bfe_u32 v6, v1, 2, 2
    v_lshl_add_u32 v6, v4, 3, v6
    v_lshlrev_b32 v6, 6, v6
    v_and_b32 v7, 3, v1
    v_lshl_add_u32 v6, v7, 3, v6
    v_and_b32 v7, 1, v4
    v_lshl_add_u32 v16, v7, 5, v6
    v_xor_b32 v17, 32, v16
    v_add_u32 v16, s9, v16
    v_add_u32 v17, s9, v17
    s_lshl_b32 s7, s3, 4
    s_add_u32 s6, s6, s7
    s_mul_i32 s64, s5, 3072
    s_lshr_b32 s7, s6, 4
    s_mul_i32 s7, s7, 22528
    s_add_u32 s7, s7, s64
    v_lshrrev_b32 v18, 1, v4
    v_lshlrev_b32 v18, 8, v18
    v_lshl_add_u32 v18, v3, 4, v18
    v_and_b32 v19, 1, v4
    v_lshl_add_u32 v18, v19, 3, v18
    v_add_u32 v18, s7, v18
    v_add_u32 v19, 22528, v18
    v_add_u32 v15, s6, v3
    v_lshlrev_b32 v15, 1, v15
    s_waitcnt vmcnt(28)
    s_mov_b64 vcc, s[68:69]
    v_cndmask_b32_dpp v32, v68, v64, vcc quad_perm:[1,0,3,2] row_mask:0xf bank_mask:0xf
    v_cndmask_b32_dpp v33, v69, v65, vcc quad_perm:[1,0,3,2] row_mask:0xf bank_mask:0xf
    v_cndmask_b32_dpp v34, v70, v66, vcc quad_perm:[1,0,3,2] row_mask:0xf bank_mask:0xf
    v_cndmask_b32_dpp v35, v71, v67, vcc quad_perm:[1,0,3,2] row_mask:0xf bank_mask:0xf
    v_cndmask_b32_dpp v40, v76, v72, vcc quad_perm:[1,0,3,2] row_mask:0xf bank_mask:0xf
    v_cndmask_b32_dpp v41, v77, v73, vcc quad_perm:[1,0,3,2] row_mask:0xf bank_mask:0xf
    v_cndmask_b32_dpp v42, v78, v74, vcc quad_perm:[1,0,3,2] row_mask:0xf bank_mask:0xf
    v_cndmask_b32_dpp v43, v79, v75, vcc quad_perm:[1,0,3,2] row_mask:0xf bank_mask:0xf
    s_mov_b64 vcc, s[70:71]
    v_cndmask_b32_dpp v36, v64, v68, vcc quad_perm:[1,0,3,2] row_mask:0xf bank_mask:0xf
    v_cndmask_b32_dpp v37, v65, v69, vcc quad_perm:[1,0,3,2] row_mask:0xf bank_mask:0xf
    v_cndmask_b32_dpp v38, v66, v70, vcc quad_perm:[1,0,3,2] row_mask:0xf bank_mask:0xf
    v_cndmask_b32_dpp v39, v67, v71, vcc quad_perm:[1,0,3,2] row_mask:0xf bank_mask:0xf
    v_cndmask_b32_dpp v44, v72, v76, vcc quad_perm:[1,0,3,2] row_mask:0xf bank_mask:0xf
    v_cndmask_b32_dpp v45, v73, v77, vcc quad_perm:[1,0,3,2] row_mask:0xf bank_mask:0xf
    v_cndmask_b32_dpp v46, v74, v78, vcc quad_perm:[1,0,3,2] row_mask:0xf bank_mask:0xf
    v_cndmask_b32_dpp v47, v75, v79, vcc quad_perm:[1,0,3,2] row_mask:0xf bank_mask:0xf
    s_mov_b64 vcc, s[72:73]
    v_cndmask_b32_dpp v64, v40, v32, vcc quad_perm:[2,3,0,1] row_mask:0xf bank_mask:0xf
    v_cndmask_b32_dpp v65, v41, v33, vcc quad_perm:[2,3,0,1] row_mask:0xf bank_mask:0xf
    v_cndmask_b32_dpp v66, v42, v34, vcc quad_perm:[2,3,0,1] row_mask:0xf bank_mask:0xf
    v_cndmask_b32_dpp v67, v43, v35, vcc quad_perm:[2,3,0,1] row_mask:0xf bank_mask:0xf
    v_cndmask_b32_dpp v68, v44, v36, vcc quad_perm:[2,3,0,1] row_mask:0xf bank_mask:0xf
    v_cndmask_b32_dpp v69, v45, v37, vcc quad_perm:[2,3,0,1] row_mask:0xf bank_mask:0xf
    v_cndmask_b32_dpp v70, v46, v38, vcc quad_perm:[2,3,0,1] row_mask:0xf bank_mask:0xf
    v_cndmask_b32_dpp v71, v47, v39, vcc quad_perm:[2,3,0,1] row_mask:0xf bank_mask:0xf
    s_mov_b64 vcc, s[74:75]
    v_cndmask_b32_dpp v72, v32, v40, vcc quad_perm:[2,3,0,1] row_mask:0xf bank_mask:0xf
    v_cndmask_b32_dpp v73, v33, v41, vcc quad_perm:[2,3,0,1] row_mask:0xf bank_mask:0xf
    v_cndmask_b32_dpp v74, v34, v42, vcc quad_perm:[2,3,0,1] row_mask:0xf bank_mask:0xf
    v_cndmask_b32_dpp v75, v35, v43, vcc quad_perm:[2,3,0,1] row_mask:0xf bank_mask:0xf
    v_cndmask_b32_dpp v76, v36, v44, vcc quad_perm:[2,3,0,1] row_mask:0xf bank_mask:0xf
    v_cndmask_b32_dpp v77, v37, v45, vcc quad_perm:[2,3,0,1] row_mask:0xf bank_mask:0xf
    v_cndmask_b32_dpp v78, v38, v46, vcc quad_perm:[2,3,0,1] row_mask:0xf bank_mask:0xf
    v_cndmask_b32_dpp v79, v39, v47, vcc quad_perm:[2,3,0,1] row_mask:0xf bank_mask:0xf
    s_add_u32 m0, s9, 12288
    s_add_u32 s8, s76, 4096
    buffer_load_dwordx4 v14, s[44:47], s8 offen lds
    buffer_load_dwordx4 v14, s[44:47], s8 offen offset:1024 lds
    s_add_u32 m0, s9, 14336
    s_add_u32 s8, s77, 4096
    buffer_load_dwordx4 v14, s[44:47], s8 offen lds
    buffer_load_dwordx4 v14, s[44:47], s8 offen offset:1024 lds
    s_add_u32 m0, s9, 16384
    s_add_u32 s8, s78, 4096
    buffer_load_dwordx4 v14, s[44:47], s8 offen lds
    buffer_load_dwordx4 v14, s[44:47], s8 offen offset:1024 lds
    s_waitcnt vmcnt(30)
    s_mov_b64 vcc, s[68:69]
    v_cndmask_b32_dpp v48, v84, v80, vcc quad_perm:[1,0,3,2] row_mask:0xf bank_mask:0xf
    v_cndmask_b32_dpp v49, v85, v81, vcc quad_perm:[1,0,3,2] row_mask:0xf bank_mask:0xf
    v_cndmask_b32_dpp v50, v86, v82, vcc quad_perm:[1,0,3,2] row_mask:0xf bank_mask:0xf
    v_cndmask_b32_dpp v51, v87, v83, vcc quad_perm:[1,0,3,2] row_mask:0xf bank_mask:0xf
    v_cndmask_b32_dpp v56, v92, v88, vcc quad_perm:[1,0,3,2] row_mask:0xf bank_mask:0xf
    v_cndmask_b32_dpp v57, v93, v89, vcc quad_perm:[1,0,3,2] row_mask:0xf bank_mask:0xf
    v_cndmask_b32_dpp v58, v94, v90, vcc quad_perm:[1,0,3,2] row_mask:0xf bank_mask:0xf
    v_cndmask_b32_dpp v59, v95, v91, vcc quad_perm:[1,0,3,2] row_mask:0xf bank_mask:0xf
    s_mov_b64 vcc, s[70:71]
    v_cndmask_b32_dpp v52, v80, v84, vcc quad_perm:[1,0,3,2] row_mask:0xf bank_mask:0xf
    v_cndmask_b32_dpp v53, v81, v85, vcc quad_perm:[1,0,3,2] row_mask:0xf bank_mask:0xf
    v_cndmask_b32_dpp v54, v82, v86, vcc quad_perm:[1,0,3,2] row_mask:0xf bank_mask:0xf
    v_cndmask_b32_dpp v55, v83, v87, vcc quad_perm:[1,0,3,2] row_mask:0xf bank_mask:0xf
    v_cndmask_b32_dpp v60, v88, v92, vcc quad_perm:[1,0,3,2] row_mask:0xf bank_mask:0xf
    v_cndmask_b32_dpp v61, v89, v93, vcc quad_perm:[1,0,3,2] row_mask:0xf bank_mask:0xf
    v_cndmask_b32_dpp v62, v90, v94, vcc quad_perm:[1,0,3,2] row_mask:0xf bank_mask:0xf
    v_cndmask_b32_dpp v63, v91, v95, vcc quad_perm:[1,0,3,2] row_mask:0xf bank_mask:0xf
    s_mov_b64 vcc, s[72:73]
    v_cndmask_b32_dpp v80, v56, v48, vcc quad_perm:[2,3,0,1] row_mask:0xf bank_mask:0xf
    v_cndmask_b32_dpp v81, v57, v49, vcc quad_perm:[2,3,0,1] row_mask:0xf bank_mask:0xf
    v_cndmask_b32_dpp v82, v58, v50, vcc quad_perm:[2,3,0,1] row_mask:0xf bank_mask:0xf
    v_cndmask_b32_dpp v83, v59, v51, vcc quad_perm:[2,3,0,1] row_mask:0xf bank_mask:0xf
    v_cndmask_b32_dpp v84, v60, v52, vcc quad_perm:[2,3,0,1] row_mask:0xf bank_mask:0xf
    v_cndmask_b32_dpp v85, v61, v53, vcc quad_perm:[2,3,0,1] row_mask:0xf bank_mask:0xf
    v_cndmask_b32_dpp v86, v62, v54, vcc quad_perm:[2,3,0,1] row_mask:0xf bank_mask:0xf
    v_cndmask_b32_dpp v87, v63, v55, vcc quad_perm:[2,3,0,1] row_mask:0xf bank_mask:0xf
    s_mov_b64 vcc, s[74:75]
    v_cndmask_b32_dpp v88, v48, v56, vcc quad_perm:[2,3,0,1] row_mask:0xf bank_mask:0xf
    v_cndmask_b32_dpp v89, v49, v57, vcc quad_perm:[2,3,0,1] row_mask:0xf bank_mask:0xf
    v_cndmask_b32_dpp v90, v50, v58, vcc quad_perm:[2,3,0,1] row_mask:0xf bank_mask:0xf
    v_cndmask_b32_dpp v91, v51, v59, vcc quad_perm:[2,3,0,1] row_mask:0xf bank_mask:0xf
    v_cndmask_b32_dpp v92, v52, v60, vcc quad_perm:[2,3,0,1] row_mask:0xf bank_mask:0xf
    v_cndmask_b32_dpp v93, v53, v61, vcc quad_perm:[2,3,0,1] row_mask:0xf bank_mask:0xf
    v_cndmask_b32_dpp v94, v54, v62, vcc quad_perm:[2,3,0,1] row_mask:0xf bank_mask:0xf
    v_cndmask_b32_dpp v95, v55, v63, vcc quad_perm:[2,3,0,1] row_mask:0xf bank_mask:0xf
    buffer_load_dwordx4 v[144:147], v11, s[40:43], s80 offen offset:256
    buffer_load_dwordx4 v[148:151], v11, s[40:43], s81 offen offset:256
    buffer_load_dwordx4 v[152:155], v11, s[40:43], s82 offen offset:256
    buffer_load_dwordx4 v[156:159], v11, s[40:43], s83 offen offset:256
    s_waitcnt vmcnt(30)
    s_mov_b64 vcc, s[68:69]
    v_cndmask_b32_dpp v32, v100, v96, vcc quad_perm:[1,0,3,2] row_mask:0xf bank_mask:0xf
    v_cndmask_b32_dpp v33, v101, v97, vcc quad_perm:[1,0,3,2] row_mask:0xf bank_mask:0xf
    v_cndmask_b32_dpp v34, v102, v98, vcc quad_perm:[1,0,3,2] row_mask:0xf bank_mask:0xf
    v_cndmask_b32_dpp v35, v103, v99, vcc quad_perm:[1,0,3,2] row_mask:0xf bank_mask:0xf
    v_cndmask_b32_dpp v40, v108, v104, vcc quad_perm:[1,0,3,2] row_mask:0xf bank_mask:0xf
    v_cndmask_b32_dpp v41, v109, v105, vcc quad_perm:[1,0,3,2] row_mask:0xf bank_mask:0xf
    v_cndmask_b32_dpp v42, v110, v106, vcc quad_perm:[1,0,3,2] row_mask:0xf bank_mask:0xf
    v_cndmask_b32_dpp v43, v111, v107, vcc quad_perm:[1,0,3,2] row_mask:0xf bank_mask:0xf
    s_mov_b64 vcc, s[70:71]
    v_cndmask_b32_dpp v36, v96, v100, vcc quad_perm:[1,0,3,2] row_mask:0xf bank_mask:0xf
    v_cndmask_b32_dpp v37, v97, v101, vcc quad_perm:[1,0,3,2] row_mask:0xf bank_mask:0xf
    v_cndmask_b32_dpp v38, v98, v102, vcc quad_perm:[1,0,3,2] row_mask:0xf bank_mask:0xf
    v_cndmask_b32_dpp v39, v99, v103, vcc quad_perm:[1,0,3,2] row_mask:0xf bank_mask:0xf
    v_cndmask_b32_dpp v44, v104, v108, vcc quad_perm:[1,0,3,2] row_mask:0xf bank_mask:0xf
    v_cndmask_b32_dpp v45, v105, v109, vcc quad_perm:[1,0,3,2] row_mask:0xf bank_mask:0xf
    v_cndmask_b32_dpp v46, v106, v110, vcc quad_perm:[1,0,3,2] row_mask:0xf bank_mask:0xf
    v_cndmask_b32_dpp v47, v107, v111, vcc quad_perm:[1,0,3,2] row_mask:0xf bank_mask:0xf
    s_mov_b64 vcc, s[72:73]
    v_cndmask_b32_dpp v96, v40, v32, vcc quad_perm:[2,3,0,1] row_mask:0xf bank_mask:0xf
    v_cndmask_b32_dpp v97, v41, v33, vcc quad_perm:[2,3,0,1] row_mask:0xf bank_mask:0xf
    v_cndmask_b32_dpp v98, v42, v34, vcc quad_perm:[2,3,0,1] row_mask:0xf bank_mask:0xf
    v_cndmask_b32_dpp v99, v43, v35, vcc quad_perm:[2,3,0,1] row_mask:0xf bank_mask:0xf
    v_cndmask_b32_dpp v100, v44, v36, vcc quad_perm:[2,3,0,1] row_mask:0xf bank_mask:0xf
    v_cndmask_b32_dpp v101, v45, v37, vcc quad_perm:[2,3,0,1] row_mask:0xf bank_mask:0xf
    v_cndmask_b32_dpp v102, v46, v38, vcc quad_perm:[2,3,0,1] row_mask:0xf bank_mask:0xf
    v_cndmask_b32_dpp v103, v47, v39, vcc quad_perm:[2,3,0,1] row_mask:0xf bank_mask:0xf
    s_mov_b64 vcc, s[74:75]
    v_cndmask_b32_dpp v104, v32, v40, vcc quad_perm:[2,3,0,1] row_mask:0xf bank_mask:0xf
    v_cndmask_b32_dpp v105, v33, v41, vcc quad_perm:[2,3,0,1] row_mask:0xf bank_mask:0xf
    v_cndmask_b32_dpp v106, v34, v42, vcc quad_perm:[2,3,0,1] row_mask:0xf bank_mask:0xf
    v_cndmask_b32_dpp v107, v35, v43, vcc quad_perm:[2,3,0,1] row_mask:0xf bank_mask:0xf
    v_cndmask_b32_dpp v108, v36, v44, vcc quad_perm:[2,3,0,1] row_mask:0xf bank_mask:0xf
    v_cndmask_b32_dpp v109, v37, v45, vcc quad_perm:[2,3,0,1] row_mask:0xf bank_mask:0xf
    v_cndmask_b32_dpp v110, v38, v46, vcc quad_perm:[2,3,0,1] row_mask:0xf bank_mask:0xf
    v_cndmask_b32_dpp v111, v39, v47, vcc quad_perm:[2,3,0,1] row_mask:0xf bank_mask:0xf
    s_add_u32 m0, s9, 18432
    s_add_u32 s8, s76, 6144
    buffer_load_dwordx4 v14, s[44:47], s8 offen lds
    buffer_load_dwordx4 v14, s[44:47], s8 offen offset:1024 lds
    s_add_u32 m0, s9, 20480
    s_add_u32 s8, s77, 6144
    buffer_load_dwordx4 v14, s[44:47], s8 offen lds
    buffer_load_dwordx4 v14, s[44:47], s8 offen offset:1024 lds
    s_add_u32 m0, s9, 22528
    s_add_u32 s8, s78, 6144
    buffer_load_dwordx4 v14, s[44:47], s8 offen lds
    buffer_load_dwordx4 v14, s[44:47], s8 offen offset:1024 lds
    s_waitcnt vmcnt(32)
    s_mov_b64 vcc, s[68:69]
    v_cndmask_b32_dpp v48, v116, v112, vcc quad_perm:[1,0,3,2] row_mask:0xf bank_mask:0xf
    v_cndmask_b32_dpp v49, v117, v113, vcc quad_perm:[1,0,3,2] row_mask:0xf bank_mask:0xf
    v_cndmask_b32_dpp v50, v118, v114, vcc quad_perm:[1,0,3,2] row_mask:0xf bank_mask:0xf
    v_cndmask_b32_dpp v51, v119, v115, vcc quad_perm:[1,0,3,2] row_mask:0xf bank_mask:0xf
    v_cndmask_b32_dpp v56, v124, v120, vcc quad_perm:[1,0,3,2] row_mask:0xf bank_mask:0xf
    v_cndmask_b32_dpp v57, v125, v121, vcc quad_perm:[1,0,3,2] row_mask:0xf bank_mask:0xf
    v_cndmask_b32_dpp v58, v126, v122, vcc quad_perm:[1,0,3,2] row_mask:0xf bank_mask:0xf
    v_cndmask_b32_dpp v59, v127, v123, vcc quad_perm:[1,0,3,2] row_mask:0xf bank_mask:0xf
    s_mov_b64 vcc, s[70:71]
    v_cndmask_b32_dpp v52, v112, v116, vcc quad_perm:[1,0,3,2] row_mask:0xf bank_mask:0xf
    v_cndmask_b32_dpp v53, v113, v117, vcc quad_perm:[1,0,3,2] row_mask:0xf bank_mask:0xf
    v_cndmask_b32_dpp v54, v114, v118, vcc quad_perm:[1,0,3,2] row_mask:0xf bank_mask:0xf
    v_cndmask_b32_dpp v55, v115, v119, vcc quad_perm:[1,0,3,2] row_mask:0xf bank_mask:0xf
    v_cndmask_b32_dpp v60, v120, v124, vcc quad_perm:[1,0,3,2] row_mask:0xf bank_mask:0xf
    v_cndmask_b32_dpp v61, v121, v125, vcc quad_perm:[1,0,3,2] row_mask:0xf bank_mask:0xf
    v_cndmask_b32_dpp v62, v122, v126, vcc quad_perm:[1,0,3,2] row_mask:0xf bank_mask:0xf
    v_cndmask_b32_dpp v63, v123, v127, vcc quad_perm:[1,0,3,2] row_mask:0xf bank_mask:0xf
    s_mov_b64 vcc, s[72:73]
    v_cndmask_b32_dpp v112, v56, v48, vcc quad_perm:[2,3,0,1] row_mask:0xf bank_mask:0xf
    v_cndmask_b32_dpp v113, v57, v49, vcc quad_perm:[2,3,0,1] row_mask:0xf bank_mask:0xf
    v_cndmask_b32_dpp v114, v58, v50, vcc quad_perm:[2,3,0,1] row_mask:0xf bank_mask:0xf
    v_cndmask_b32_dpp v115, v59, v51, vcc quad_perm:[2,3,0,1] row_mask:0xf bank_mask:0xf
    v_cndmask_b32_dpp v116, v60, v52, vcc quad_perm:[2,3,0,1] row_mask:0xf bank_mask:0xf
    v_cndmask_b32_dpp v117, v61, v53, vcc quad_perm:[2,3,0,1] row_mask:0xf bank_mask:0xf
    v_cndmask_b32_dpp v118, v62, v54, vcc quad_perm:[2,3,0,1] row_mask:0xf bank_mask:0xf
    v_cndmask_b32_dpp v119, v63, v55, vcc quad_perm:[2,3,0,1] row_mask:0xf bank_mask:0xf
    s_mov_b64 vcc, s[74:75]
    v_cndmask_b32_dpp v120, v48, v56, vcc quad_perm:[2,3,0,1] row_mask:0xf bank_mask:0xf
    v_cndmask_b32_dpp v121, v49, v57, vcc quad_perm:[2,3,0,1] row_mask:0xf bank_mask:0xf
    v_cndmask_b32_dpp v122, v50, v58, vcc quad_perm:[2,3,0,1] row_mask:0xf bank_mask:0xf
    v_cndmask_b32_dpp v123, v51, v59, vcc quad_perm:[2,3,0,1] row_mask:0xf bank_mask:0xf
    v_cndmask_b32_dpp v124, v52, v60, vcc quad_perm:[2,3,0,1] row_mask:0xf bank_mask:0xf
    v_cndmask_b32_dpp v125, v53, v61, vcc quad_perm:[2,3,0,1] row_mask:0xf bank_mask:0xf
    v_cndmask_b32_dpp v126, v54, v62, vcc quad_perm:[2,3,0,1] row_mask:0xf bank_mask:0xf
    v_cndmask_b32_dpp v127, v55, v63, vcc quad_perm:[2,3,0,1] row_mask:0xf bank_mask:0xf
    buffer_load_dwordx4 v[160:163], v12, s[40:43], s80 offen offset:256
    buffer_load_dwordx4 v[164:167], v12, s[40:43], s81 offen offset:256
    buffer_load_dwordx4 v[168:171], v12, s[40:43], s82 offen offset:256
    buffer_load_dwordx4 v[172:175], v12, s[40:43], s83 offen offset:256
    s_waitcnt vmcnt(30)
    ds_read_b64_tr_b16 a[96:97], v16 offset:0
    ds_read_b64_tr_b16 a[98:99], v16 offset:256
    ds_read_b64_tr_b16 a[100:101], v17 offset:0
    ds_read_b64_tr_b16 a[102:103], v17 offset:256
    ds_read_b64_tr_b16 a[104:105], v16 offset:2048
    ds_read_b64_tr_b16 a[106:107], v16 offset:2304
    ds_read_b64_tr_b16 a[108:109], v17 offset:2048
    ds_read_b64_tr_b16 a[110:111], v17 offset:2304
    ds_read_b64_tr_b16 a[112:113], v16 offset:4096
    ds_read_b64_tr_b16 a[114:115], v16 offset:4352
    ds_read_b64_tr_b16 a[116:117], v17 offset:4096
    ds_read_b64_tr_b16 a[118:119], v17 offset:4352
    s_waitcnt lgkmcnt(0)
    v_mfma_f32_16x16x32_bf16 a[0:3], a[96:99], v[64:67], 0
    s_add_u32 m0, s9, 24576
    s_add_u32 s8, s76, 8192
    buffer_load_dwordx4 v14, s[44:47], s8 offen lds
    v_mfma_f32_16x16x32_bf16 a[4:7], a[96:99], v[80:83], 0
    buffer_load_dwordx4 v14, s[44:47], s8 offen offset:1024 lds
    s_add_u32 m0, s9, 26624
    s_add_u32 s8, s77, 8192
    buffer_load_dwordx4 v14, s[44:47], s8 offen lds
    v_mfma_f32_16x16x32_bf16 a[8:11], a[96:99], v[96:99], 0
    buffer_load_dwordx4 v14, s[44:47], s8 offen offset:1024 lds
    s_add_u32 m0, s9, 28672
    s_add_u32 s8, s78, 8192
    buffer_load_dwordx4 v14, s[44:47], s8 offen lds
    v_mfma_f32_16x16x32_bf16 a[12:15], a[96:99], v[112:115], 0
    buffer_load_dwordx4 v14, s[44:47], s8 offen offset:1024 lds
    v_mfma_f32_16x16x32_bf16 a[16:19], a[100:103], v[64:67], 0
    buffer_load_dwordx4 v[176:179], v13, s[40:43], s80 offen offset:256
    buffer_load_dwordx4 v[180:183], v13, s[40:43], s81 offen offset:256
    v_mfma_f32_16x16x32_bf16 a[20:23], a[100:103], v[80:83], 0
    buffer_load_dwordx4 v[184:187], v13, s[40:43], s82 offen offset:256
    buffer_load_dwordx4 v[188:191], v13, s[40:43], s83 offen offset:256
    v_mfma_f32_16x16x32_bf16 a[24:27], a[100:103], v[96:99], 0
    s_waitcnt vmcnt(34)
    ds_read_b64_tr_b16 a[120:121], v16 offset:6144
    v_mfma_f32_16x16x32_bf16 a[28:31], a[100:103], v[112:115], 0
    ds_read_b64_tr_b16 a[122:123], v16 offset:6400
    ds_read_b64_tr_b16 a[124:125], v17 offset:6144
    ds_read_b64_tr_b16 a[126:127], v17 offset:6400
    v_mfma_f32_16x16x32_bf16 a[32:35], a[104:107], v[64:67], 0
    ds_read_b64_tr_b16 a[128:129], v16 offset:8192
    ds_read_b64_tr_b16 a[130:131], v16 offset:8448
    ds_read_b64_tr_b16 a[132:133], v17 offset:8192
    v_mfma_f32_16x16x32_bf16 a[36:39], a[104:107], v[80:83], 0
    ds_read_b64_tr_b16 a[134:135], v17 offset:8448
    ds_read_b64_tr_b16 a[136:137], v16 offset:10240
    ds_read_b64_tr_b16 a[138:139], v16 offset:10496
    v_mfma_f32_16x16x32_bf16 a[40:43], a[104:107], v[96:99], 0
    ds_read_b64_tr_b16 a[140:141], v17 offset:10240
    ds_read_b64_tr_b16 a[142:143], v17 offset:10496
    v_mfma_f32_16x16x32_bf16 a[44:47], a[104:107], v[112:115], 0
    s_waitcnt vmcnt(30)
    s_mov_b64 vcc, s[68:69]
    v_cndmask_b32_dpp v32, v132, v128, vcc quad_perm:[1,0,3,2] row_mask:0xf bank_mask:0xf
    v_mfma_f32_16x16x32_bf16 a[48:51], a[108:111], v[64:67], 0
    v_cndmask_b32_dpp v33, v133, v129, vcc quad_perm:[1,0,3,2] row_mask:0xf bank_mask:0xf
    v_cndmask_b32_dpp v34, v134, v130, vcc quad_perm:[1,0,3,2] row_mask:0xf bank_mask:0xf
    v_cndmask_b32_dpp v35, v135, v131, vcc quad_perm:[1,0,3,2] row_mask:0xf bank_mask:0xf
    v_mfma_f32_16x16x32_bf16 a[52:55], a[108:111], v[80:83], 0
    v_cndmask_b32_dpp v40, v140, v136, vcc quad_perm:[1,0,3,2] row_mask:0xf bank_mask:0xf
    v_cndmask_b32_dpp v41, v141, v137, vcc quad_perm:[1,0,3,2] row_mask:0xf bank_mask:0xf
    v_cndmask_b32_dpp v42, v142, v138, vcc quad_perm:[1,0,3,2] row_mask:0xf bank_mask:0xf
    v_mfma_f32_16x16x32_bf16 a[56:59], a[108:111], v[96:99], 0
    v_cndmask_b32_dpp v43, v143, v139, vcc quad_perm:[1,0,3,2] row_mask:0xf bank_mask:0xf
    s_mov_b64 vcc, s[70:71]
    v_cndmask_b32_dpp v36, v128, v132, vcc quad_perm:[1,0,3,2] row_mask:0xf bank_mask:0xf
    v_mfma_f32_16x16x32_bf16 a[60:63], a[108:111], v[112:115], 0
    v_cndmask_b32_dpp v37, v129, v133, vcc quad_perm:[1,0,3,2] row_mask:0xf bank_mask:0xf
    v_cndmask_b32_dpp v38, v130, v134, vcc quad_perm:[1,0,3,2] row_mask:0xf bank_mask:0xf
    v_mfma_f32_16x16x32_bf16 a[64:67], a[112:115], v[64:67], 0
    v_cndmask_b32_dpp v39, v131, v135, vcc quad_perm:[1,0,3,2] row_mask:0xf bank_mask:0xf
    v_cndmask_b32_dpp v44, v136, v140, vcc quad_perm:[1,0,3,2] row_mask:0xf bank_mask:0xf
    v_cndmask_b32_dpp v45, v137, v141, vcc quad_perm:[1,0,3,2] row_mask:0xf bank_mask:0xf
    v_mfma_f32_16x16x32_bf16 a[68:71], a[112:115], v[80:83], 0
    v_cndmask_b32_dpp v46, v138, v142, vcc quad_perm:[1,0,3,2] row_mask:0xf bank_mask:0xf
    v_cndmask_b32_dpp v47, v139, v143, vcc quad_perm:[1,0,3,2] row_mask:0xf bank_mask:0xf
    s_mov_b64 vcc, s[72:73]
    v_mfma_f32_16x16x32_bf16 a[72:75], a[112:115], v[96:99], 0
    v_cndmask_b32_dpp v128, v40, v32, vcc quad_perm:[2,3,0,1] row_mask:0xf bank_mask:0xf
    v_cndmask_b32_dpp v129, v41, v33, vcc quad_perm:[2,3,0,1] row_mask:0xf bank_mask:0xf
    v_cndmask_b32_dpp v130, v42, v34, vcc quad_perm:[2,3,0,1] row_mask:0xf bank_mask:0xf
    v_mfma_f32_16x16x32_bf16 a[76:79], a[112:115], v[112:115], 0
    v_cndmask_b32_dpp v131, v43, v35, vcc quad_perm:[2,3,0,1] row_mask:0xf bank_mask:0xf
    v_cndmask_b32_dpp v132, v44, v36, vcc quad_perm:[2,3,0,1] row_mask:0xf bank_mask:0xf
    v_mfma_f32_16x16x32_bf16 a[80:83], a[116:119], v[64:67], 0
    v_cndmask_b32_dpp v133, v45, v37, vcc quad_perm:[2,3,0,1] row_mask:0xf bank_mask:0xf
    v_cndmask_b32_dpp v134, v46, v38, vcc quad_perm:[2,3,0,1] row_mask:0xf bank_mask:0xf
    v_cndmask_b32_dpp v135, v47, v39, vcc quad_perm:[2,3,0,1] row_mask:0xf bank_mask:0xf
    v_mfma_f32_16x16x32_bf16 a[84:87], a[116:119], v[80:83], 0
    s_mov_b64 vcc, s[74:75]
    v_cndmask_b32_dpp v136, v32, v40, vcc quad_perm:[2,3,0,1] row_mask:0xf bank_mask:0xf
    v_cndmask_b32_dpp v137, v33, v41, vcc quad_perm:[2,3,0,1] row_mask:0xf bank_mask:0xf
    v_mfma_f32_16x16x32_bf16 a[88:91], a[116:119], v[96:99], 0
    v_cndmask_b32_dpp v138, v34, v42, vcc quad_perm:[2,3,0,1] row_mask:0xf bank_mask:0xf
    v_cndmask_b32_dpp v139, v35, v43, vcc quad_perm:[2,3,0,1] row_mask:0xf bank_mask:0xf
    v_cndmask_b32_dpp v140, v36, v44, vcc quad_perm:[2,3,0,1] row_mask:0xf bank_mask:0xf
    v_mfma_f32_16x16x32_bf16 a[92:95], a[116:119], v[112:115], 0
    v_cndmask_b32_dpp v141, v37, v45, vcc quad_perm:[2,3,0,1] row_mask:0xf bank_mask:0xf
    v_cndmask_b32_dpp v142, v38, v46, vcc quad_perm:[2,3,0,1] row_mask:0xf bank_mask:0xf
    v_cndmask_b32_dpp v143, v39, v47, vcc quad_perm:[2,3,0,1] row_mask:0xf bank_mask:0xf
    s_nop 1
    s_waitcnt lgkmcnt(0)
    v_mfma_f32_16x16x32_bf16 a[0:3], a[120:123], v[68:71], a[0:3]
    s_add_u32 m0, s9, 0
    s_add_u32 s8, s76, 10240
    buffer_load_dwordx4 v14, s[44:47], s8 offen lds
    v_mfma_f32_16x16x32_bf16 a[4:7], a[120:123], v[84:87], a[4:7]
    buffer_load_dwordx4 v14, s[44:47], s8 offen offset:1024 lds
    s_add_u32 m0, s9, 2048
    s_add_u32 s8, s77, 10240
    buffer_load_dwordx4 v14, s[44:47], s8 offen lds
    v_mfma_f32_16x16x32_bf16 a[8:11], a[120:123], v[100:103], a[8:11]
    buffer_load_dwordx4 v14, s[44:47], s8 offen offset:1024 lds
    s_add_u32 m0, s9, 4096
    s_add_u32 s8, s78, 10240
    buffer_load_dwordx4 v14, s[44:47], s8 offen lds
    v_mfma_f32_16x16x32_bf16 a[12:15], a[120:123], v[116:119], a[12:15]
    buffer_load_dwordx4 v14, s[44:47], s8 offen offset:1024 lds
    v_mfma_f32_16x16x32_bf16 a[16:19], a[124:127], v[68:71], a[16:19]
    buffer_load_dwordx4 v[192:195], v10, s[40:43], s80 offen offset:512
    buffer_load_dwordx4 v[196:199], v10, s[40:43], s81 offen offset:512
    v_mfma_f32_16x16x32_bf16 a[20:23], a[124:127], v[84:87], a[20:23]
    buffer_load_dwordx4 v[200:203], v10, s[40:43], s82 offen offset:512
    buffer_load_dwordx4 v[204:207], v10, s[40:43], s83 offen offset:512
    v_mfma_f32_16x16x32_bf16 a[24:27], a[124:127], v[100:103], a[24:27]
    s_waitcnt vmcnt(34)
    ds_read_b64_tr_b16 a[96:97], v16 offset:12288
    v_mfma_f32_16x16x32_bf16 a[28:31], a[124:127], v[116:119], a[28:31]
    ds_read_b64_tr_b16 a[98:99], v16 offset:12544
    ds_read_b64_tr_b16 a[100:101], v17 offset:12288
    ds_read_b64_tr_b16 a[102:103], v17 offset:12544
    v_mfma_f32_16x16x32_bf16 a[32:35], a[128:131], v[68:71], a[32:35]
    ds_read_b64_tr_b16 a[104:105], v16 offset:14336
    ds_read_b64_tr_b16 a[106:107], v16 offset:14592
    ds_read_b64_tr_b16 a[108:109], v17 offset:14336
    v_mfma_f32_16x16x32_bf16 a[36:39], a[128:131], v[84:87], a[36:39]
    ds_read_b64_tr_b16 a[110:111], v17 offset:14592
    ds_read_b64_tr_b16 a[112:113], v16 offset:16384
    ds_read_b64_tr_b16 a[114:115], v16 offset:16640
    v_mfma_f32_16x16x32_bf16 a[40:43], a[128:131], v[100:103], a[40:43]
    ds_read_b64_tr_b16 a[116:117], v17 offset:16384
    ds_read_b64_tr_b16 a[118:119], v17 offset:16640
    v_mfma_f32_16x16x32_bf16 a[44:47], a[128:131], v[116:119], a[44:47]
    s_waitcnt vmcnt(30)
    s_mov_b64 vcc, s[68:69]
    v_cndmask_b32_dpp v48, v148, v144, vcc quad_perm:[1,0,3,2] row_mask:0xf bank_mask:0xf
    v_mfma_f32_16x16x32_bf16 a[48:51], a[132:135], v[68:71], a[48:51]
    v_cndmask_b32_dpp v49, v149, v145, vcc quad_perm:[1,0,3,2] row_mask:0xf bank_mask:0xf
    v_cndmask_b32_dpp v50, v150, v146, vcc quad_perm:[1,0,3,2] row_mask:0xf bank_mask:0xf
    v_cndmask_b32_dpp v51, v151, v147, vcc quad_perm:[1,0,3,2] row_mask:0xf bank_mask:0xf
    v_mfma_f32_16x16x32_bf16 a[52:55], a[132:135], v[84:87], a[52:55]
    v_cndmask_b32_dpp v56, v156, v152, vcc quad_perm:[1,0,3,2] row_mask:0xf bank_mask:0xf
    v_cndmask_b32_dpp v57, v157, v153, vcc quad_perm:[1,0,3,2] row_mask:0xf bank_mask:0xf
    v_cndmask_b32_dpp v58, v158, v154, vcc quad_perm:[1,0,3,2] row_mask:0xf bank_mask:0xf
    v_mfma_f32_16x16x32_bf16 a[56:59], a[132:135], v[100:103], a[56:59]
    v_cndmask_b32_dpp v59, v159, v155, vcc quad_perm:[1,0,3,2] row_mask:0xf bank_mask:0xf
    s_mov_b64 vcc, s[70:71]
    v_cndmask_b32_dpp v52, v144, v148, vcc quad_perm:[1,0,3,2] row_mask:0xf bank_mask:0xf
    v_mfma_f32_16x16x32_bf16 a[60:63], a[132:135], v[116:119], a[60:63]
    v_cndmask_b32_dpp v53, v145, v149, vcc quad_perm:[1,0,3,2] row_mask:0xf bank_mask:0xf
    v_cndmask_b32_dpp v54, v146, v150, vcc quad_perm:[1,0,3,2] row_mask:0xf bank_mask:0xf
    v_mfma_f32_16x16x32_bf16 a[64:67], a[136:139], v[68:71], a[64:67]
    v_cndmask_b32_dpp v55, v147, v151, vcc quad_perm:[1,0,3,2] row_mask:0xf bank_mask:0xf
    v_cndmask_b32_dpp v60, v152, v156, vcc quad_perm:[1,0,3,2] row_mask:0xf bank_mask:0xf
    v_cndmask_b32_dpp v61, v153, v157, vcc quad_perm:[1,0,3,2] row_mask:0xf bank_mask:0xf
    v_mfma_f32_16x16x32_bf16 a[68:71], a[136:139], v[84:87], a[68:71]
    v_cndmask_b32_dpp v62, v154, v158, vcc quad_perm:[1,0,3,2] row_mask:0xf bank_mask:0xf
    v_cndmask_b32_dpp v63, v155, v159, vcc quad_perm:[1,0,3,2] row_mask:0xf bank_mask:0xf
    s_mov_b64 vcc, s[72:73]
    v_mfma_f32_16x16x32_bf16 a[72:75], a[136:139], v[100:103], a[72:75]
    v_cndmask_b32_dpp v144, v56, v48, vcc quad_perm:[2,3,0,1] row_mask:0xf bank_mask:0xf
    v_cndmask_b32_dpp v145, v57, v49, vcc quad_perm:[2,3,0,1] row_mask:0xf bank_mask:0xf
    v_cndmask_b32_dpp v146, v58, v50, vcc quad_perm:[2,3,0,1] row_mask:0xf bank_mask:0xf
    v_mfma_f32_16x16x32_bf16 a[76:79], a[136:139], v[116:119], a[76:79]
    v_cndmask_b32_dpp v147, v59, v51, vcc quad_perm:[2,3,0,1] row_mask:0xf bank_mask:0xf
    v_cndmask_b32_dpp v148, v60, v52, vcc quad_perm:[2,3,0,1] row_mask:0xf bank_mask:0xf
    v_mfma_f32_16x16x32_bf16 a[80:83], a[140:143], v[68:71], a[80:83]
    v_cndmask_b32_dpp v149, v61, v53, vcc quad_perm:[2,3,0,1] row_mask:0xf bank_mask:0xf
    v_cndmask_b32_dpp v150, v62, v54, vcc quad_perm:[2,3,0,1] row_mask:0xf bank_mask:0xf
    v_cndmask_b32_dpp v151, v63, v55, vcc quad_perm:[2,3,0,1] row_mask:0xf bank_mask:0xf
    v_mfma_f32_16x16x32_bf16 a[84:87], a[140:143], v[84:87], a[84:87]
    s_mov_b64 vcc, s[74:75]
    v_cndmask_b32_dpp v152, v48, v56, vcc quad_perm:[2,3,0,1] row_mask:0xf bank_mask:0xf
    v_cndmask_b32_dpp v153, v49, v57, vcc quad_perm:[2,3,0,1] row_mask:0xf bank_mask:0xf
    v_mfma_f32_16x16x32_bf16 a[88:91], a[140:143], v[100:103], a[88:91]
    v_cndmask_b32_dpp v154, v50, v58, vcc quad_perm:[2,3,0,1] row_mask:0xf bank_mask:0xf
    v_cndmask_b32_dpp v155, v51, v59, vcc quad_perm:[2,3,0,1] row_mask:0xf bank_mask:0xf
    v_cndmask_b32_dpp v156, v52, v60, vcc quad_perm:[2,3,0,1] row_mask:0xf bank_mask:0xf
    v_mfma_f32_16x16x32_bf16 a[92:95], a[140:143], v[116:119], a[92:95]
    v_cndmask_b32_dpp v157, v53, v61, vcc quad_perm:[2,3,0,1] row_mask:0xf bank_mask:0xf
    v_cndmask_b32_dpp v158, v54, v62, vcc quad_perm:[2,3,0,1] row_mask:0xf bank_mask:0xf
    v_cndmask_b32_dpp v159, v55, v63, vcc quad_perm:[2,3,0,1] row_mask:0xf bank_mask:0xf
    s_nop 1
    s_waitcnt lgkmcnt(0)
    v_mfma_f32_16x16x32_bf16 a[0:3], a[96:99], v[72:75], a[0:3]
    s_add_u32 m0, s9, 6144
    s_add_u32 s8, s76, 12288
    buffer_load_dwordx4 v14, s[44:47], s8 offen lds
    v_mfma_f32_16x16x32_bf16 a[4:7], a[96:99], v[88:91], a[4:7]
    buffer_load_dwordx4 v14, s[44:47], s8 offen offset:1024 lds
    s_add_u32 m0, s9, 8192
    s_add_u32 s8, s77, 12288
    buffer_load_dwordx4 v14, s[44:47], s8 offen lds
    v_mfma_f32_16x16x32_bf16 a[8:11], a[96:99], v[104:107], a[8:11]
    buffer_load_dwordx4 v14, s[44:47], s8 offen offset:1024 lds
    s_add_u32 m0, s9, 10240
    s_add_u32 s8, s78, 12288
    buffer_load_dwordx4 v14, s[44:47], s8 offen lds
    v_mfma_f32_16x16x32_bf16 a[12:15], a[96:99], v[120:123], a[12:15]
    buffer_load_dwordx4 v14, s[44:47], s8 offen offset:1024 lds
    v_mfma_f32_16x16x32_bf16 a[16:19], a[100:103], v[72:75], a[16:19]
    buffer_load_dwordx4 v[208:211], v11, s[40:43], s80 offen offset:512
    buffer_load_dwordx4 v[212:215], v11, s[40:43], s81 offen offset:512
    v_mfma_f32_16x16x32_bf16 a[20:23], a[100:103], v[88:91], a[20:23]
    buffer_load_dwordx4 v[216:219], v11, s[40:43], s82 offen offset:512
    buffer_load_dwordx4 v[220:223], v11, s[40:43], s83 offen offset:512
    v_mfma_f32_16x16x32_bf16 a[24:27], a[100:103], v[104:107], a[24:27]
    s_waitcnt vmcnt(34)
    ds_read_b64_tr_b16 a[120:121], v16 offset:18432
    v_mfma_f32_16x16x32_bf16 a[28:31], a[100:103], v[120:123], a[28:31]
    ds_read_b64_tr_b16 a[122:123], v16 offset:18688
    ds_read_b64_tr_b16 a[124:125], v17 offset:18432
    ds_read_b64_tr_b16 a[126:127], v17 offset:18688
    v_mfma_f32_16x16x32_bf16 a[32:35], a[104:107], v[72:75], a[32:35]
    ds_read_b64_tr_b16 a[128:129], v16 offset:20480
    ds_read_b64_tr_b16 a[130:131], v16 offset:20736
    ds_read_b64_tr_b16 a[132:133], v17 offset:20480
    v_mfma_f32_16x16x32_bf16 a[36:39], a[104:107], v[88:91], a[36:39]
    ds_read_b64_tr_b16 a[134:135], v17 offset:20736
    ds_read_b64_tr_b16 a[136:137], v16 offset:22528
    ds_read_b64_tr_b16 a[138:139], v16 offset:22784
    v_mfma_f32_16x16x32_bf16 a[40:43], a[104:107], v[104:107], a[40:43]
    ds_read_b64_tr_b16 a[140:141], v17 offset:22528
    ds_read_b64_tr_b16 a[142:143], v17 offset:22784
    v_mfma_f32_16x16x32_bf16 a[44:47], a[104:107], v[120:123], a[44:47]
    s_waitcnt vmcnt(30)
    s_mov_b64 vcc, s[68:69]
    v_cndmask_b32_dpp v32, v164, v160, vcc quad_perm:[1,0,3,2] row_mask:0xf bank_mask:0xf
    v_mfma_f32_16x16x32_bf16 a[48:51], a[108:111], v[72:75], a[48:51]
    v_cndmask_b32_dpp v33, v165, v161, vcc quad_perm:[1,0,3,2] row_mask:0xf bank_mask:0xf
    v_cndmask_b32_dpp v34, v166, v162, vcc quad_perm:[1,0,3,2] row_mask:0xf bank_mask:0xf
    v_cndmask_b32_dpp v35, v167, v163, vcc quad_perm:[1,0,3,2] row_mask:0xf bank_mask:0xf
    v_mfma_f32_16x16x32_bf16 a[52:55], a[108:111], v[88:91], a[52:55]
    v_cndmask_b32_dpp v40, v172, v168, vcc quad_perm:[1,0,3,2] row_mask:0xf bank_mask:0xf
    v_cndmask_b32_dpp v41, v173, v169, vcc quad_perm:[1,0,3,2] row_mask:0xf bank_mask:0xf
    v_cndmask_b32_dpp v42, v174, v170, vcc quad_perm:[1,0,3,2] row_mask:0xf bank_mask:0xf
    v_mfma_f32_16x16x32_bf16 a[56:59], a[108:111], v[104:107], a[56:59]
    v_cndmask_b32_dpp v43, v175, v171, vcc quad_perm:[1,0,3,2] row_mask:0xf bank_mask:0xf
    s_mov_b64 vcc, s[70:71]
    v_cndmask_b32_dpp v36, v160, v164, vcc quad_perm:[1,0,3,2] row_mask:0xf bank_mask:0xf
    v_mfma_f32_16x16x32_bf16 a[60:63], a[108:111], v[120:123], a[60:63]
    v_cndmask_b32_dpp v37, v161, v165, vcc quad_perm:[1,0,3,2] row_mask:0xf bank_mask:0xf
    v_cndmask_b32_dpp v38, v162, v166, vcc quad_perm:[1,0,3,2] row_mask:0xf bank_mask:0xf
    v_mfma_f32_16x16x32_bf16 a[64:67], a[112:115], v[72:75], a[64:67]
    v_cndmask_b32_dpp v39, v163, v167, vcc quad_perm:[1,0,3,2] row_mask:0xf bank_mask:0xf
    v_cndmask_b32_dpp v44, v168, v172, vcc quad_perm:[1,0,3,2] row_mask:0xf bank_mask:0xf
    v_cndmask_b32_dpp v45, v169, v173, vcc quad_perm:[1,0,3,2] row_mask:0xf bank_mask:0xf
    v_mfma_f32_16x16x32_bf16 a[68:71], a[112:115], v[88:91], a[68:71]
    v_cndmask_b32_dpp v46, v170, v174, vcc quad_perm:[1,0,3,2] row_mask:0xf bank_mask:0xf
    v_cndmask_b32_dpp v47, v171, v175, vcc quad_perm:[1,0,3,2] row_mask:0xf bank_mask:0xf
    s_mov_b64 vcc, s[72:73]
    v_mfma_f32_16x16x32_bf16 a[72:75], a[112:115], v[104:107], a[72:75]
    v_cndmask_b32_dpp v160, v40, v32, vcc quad_perm:[2,3,0,1] row_mask:0xf bank_mask:0xf
    v_cndmask_b32_dpp v161, v41, v33, vcc quad_perm:[2,3,0,1] row_mask:0xf bank_mask:0xf
    v_cndmask_b32_dpp v162, v42, v34, vcc quad_perm:[2,3,0,1] row_mask:0xf bank_mask:0xf
    v_mfma_f32_16x16x32_bf16 a[76:79], a[112:115], v[120:123], a[76:79]
    v_cndmask_b32_dpp v163, v43, v35, vcc quad_perm:[2,3,0,1] row_mask:0xf bank_mask:0xf
    v_cndmask_b32_dpp v164, v44, v36, vcc quad_perm:[2,3,0,1] row_mask:0xf bank_mask:0xf
    v_mfma_f32_16x16x32_bf16 a[80:83], a[116:119], v[72:75], a[80:83]
    v_cndmask_b32_dpp v165, v45, v37, vcc quad_perm:[2,3,0,1] row_mask:0xf bank_mask:0xf
    v_cndmask_b32_dpp v166, v46, v38, vcc quad_perm:[2,3,0,1] row_mask:0xf bank_mask:0xf
    v_cndmask_b32_dpp v167, v47, v39, vcc quad_perm:[2,3,0,1] row_mask:0xf bank_mask:0xf
    v_mfma_f32_16x16x32_bf16 a[84:87], a[116:119], v[88:91], a[84:87]
    s_mov_b64 vcc, s[74:75]
    v_cndmask_b32_dpp v168, v32, v40, vcc quad_perm:[2,3,0,1] row_mask:0xf bank_mask:0xf
    v_cndmask_b32_dpp v169, v33, v41, vcc quad_perm:[2,3,0,1] row_mask:0xf bank_mask:0xf
    v_mfma_f32_16x16x32_bf16 a[88:91], a[116:119], v[104:107], a[88:91]
    v_cndmask_b32_dpp v170, v34, v42, vcc quad_perm:[2,3,0,1] row_mask:0xf bank_mask:0xf
    v_cndmask_b32_dpp v171, v35, v43, vcc quad_perm:[2,3,0,1] row_mask:0xf bank_mask:0xf
    v_cndmask_b32_dpp v172, v36, v44, vcc quad_perm:[2,3,0,1] row_mask:0xf bank_mask:0xf
    v_mfma_f32_16x16x32_bf16 a[92:95], a[116:119], v[120:123], a[92:95]
    v_cndmask_b32_dpp v173, v37, v45, vcc quad_perm:[2,3,0,1] row_mask:0xf bank_mask:0xf
    v_cndmask_b32_dpp v174, v38, v46, vcc quad_perm:[2,3,0,1] row_mask:0xf bank_mask:0xf
    v_cndmask_b32_dpp v175, v39, v47, vcc quad_perm:[2,3,0,1] row_mask:0xf bank_mask:0xf
    s_nop 1
    s_waitcnt lgkmcnt(0)
    v_mfma_f32_16x16x32_bf16 a[0:3], a[120:123], v[76:79], a[0:3]
    s_add_u32 m0, s9, 12288
    s_add_u32 s8, s76, 14336
    buffer_load_dwordx4 v14, s[44:47], s8 offen lds
    v_mfma_f32_16x16x32_bf16 a[4:7], a[120:123], v[92:95], a[4:7]
    buffer_load_dwordx4 v14, s[44:47], s8 offen offset:1024 lds
    s_add_u32 m0, s9, 14336
    s_add_u32 s8, s77, 14336
    buffer_load_dwordx4 v14, s[44:47], s8 offen lds
    v_mfma_f32_16x16x32_bf16 a[8:11], a[120:123], v[108:111], a[8:11]
    buffer_load_dwordx4 v14, s[44:47], s8 offen offset:1024 lds
    s_add_u32 m0, s9, 16384
    s_add_u32 s8, s78, 14336
    buffer_load_dwordx4 v14, s[44:47], s8 offen lds
    v_mfma_f32_16x16x32_bf16 a[12:15], a[120:123], v[124:127], a[12:15]
    buffer_load_dwordx4 v14, s[44:47], s8 offen offset:1024 lds
    v_mfma_f32_16x16x32_bf16 a[16:19], a[124:127], v[76:79], a[16:19]
    buffer_load_dwordx4 v[224:227], v12, s[40:43], s80 offen offset:512
    buffer_load_dwordx4 v[228:231], v12, s[40:43], s81 offen offset:512
    v_mfma_f32_16x16x32_bf16 a[20:23], a[124:127], v[92:95], a[20:23]
    buffer_load_dwordx4 v[232:235], v12, s[40:43], s82 offen offset:512
    buffer_load_dwordx4 v[236:239], v12, s[40:43], s83 offen offset:512
    v_mfma_f32_16x16x32_bf16 a[24:27], a[124:127], v[108:111], a[24:27]
    s_waitcnt vmcnt(34)
    ds_read_b64_tr_b16 a[96:97], v16 offset:24576
    v_mfma_f32_16x16x32_bf16 a[28:31], a[124:127], v[124:127], a[28:31]
    ds_read_b64_tr_b16 a[98:99], v16 offset:24832
    ds_read_b64_tr_b16 a[100:101], v17 offset:24576
    ds_read_b64_tr_b16 a[102:103], v17 offset:24832
    v_mfma_f32_16x16x32_bf16 a[32:35], a[128:131], v[76:79], a[32:35]
    ds_read_b64_tr_b16 a[104:105], v16 offset:26624
    ds_read_b64_tr_b16 a[106:107], v16 offset:26880
    ds_read_b64_tr_b16 a[108:109], v17 offset:26624
    v_mfma_f32_16x16x32_bf16 a[36:39], a[128:131], v[92:95], a[36:39]
    ds_read_b64_tr_b16 a[110:111], v17 offset:26880
    ds_read_b64_tr_b16 a[112:113], v16 offset:28672
    ds_read_b64_tr_b16 a[114:115], v16 offset:28928
    v_mfma_f32_16x16x32_bf16 a[40:43], a[128:131], v[108:111], a[40:43]
    ds_read_b64_tr_b16 a[116:117], v17 offset:28672
    ds_read_b64_tr_b16 a[118:119], v17 offset:28928
    v_mfma_f32_16x16x32_bf16 a[44:47], a[128:131], v[124:127], a[44:47]
    s_waitcnt vmcnt(30)
    s_mov_b64 vcc, s[68:69]
    v_cndmask_b32_dpp v48, v180, v176, vcc quad_perm:[1,0,3,2] row_mask:0xf bank_mask:0xf
    v_mfma_f32_16x16x32_bf16 a[48:51], a[132:135], v[76:79], a[48:51]
    v_cndmask_b32_dpp v49, v181, v177, vcc quad_perm:[1,0,3,2] row_mask:0xf bank_mask:0xf
    v_cndmask_b32_dpp v50, v182, v178, vcc quad_perm:[1,0,3,2] row_mask:0xf bank_mask:0xf
    v_cndmask_b32_dpp v51, v183, v179, vcc quad_perm:[1,0,3,2] row_mask:0xf bank_mask:0xf
    v_mfma_f32_16x16x32_bf16 a[52:55], a[132:135], v[92:95], a[52:55]
    v_cndmask_b32_dpp v56, v188, v184, vcc quad_perm:[1,0,3,2] row_mask:0xf bank_mask:0xf
    v_cndmask_b32_dpp v57, v189, v185, vcc quad_perm:[1,0,3,2] row_mask:0xf bank_mask:0xf
    v_cndmask_b32_dpp v58, v190, v186, vcc quad_perm:[1,0,3,2] row_mask:0xf bank_mask:0xf
    v_mfma_f32_16x16x32_bf16 a[56:59], a[132:135], v[108:111], a[56:59]
    v_cndmask_b32_dpp v59, v191, v187, vcc quad_perm:[1,0,3,2] row_mask:0xf bank_mask:0xf
    s_mov_b64 vcc, s[70:71]
    v_cndmask_b32_dpp v52, v176, v180, vcc quad_perm:[1,0,3,2] row_mask:0xf bank_mask:0xf
    v_mfma_f32_16x16x32_bf16 a[60:63], a[132:135], v[124:127], a[60:63]
    v_cndmask_b32_dpp v53, v177, v181, vcc quad_perm:[1,0,3,2] row_mask:0xf bank_mask:0xf
    v_cndmask_b32_dpp v54, v178, v182, vcc quad_perm:[1,0,3,2] row_mask:0xf bank_mask:0xf
    v_mfma_f32_16x16x32_bf16 a[64:67], a[136:139], v[76:79], a[64:67]
    v_cndmask_b32_dpp v55, v179, v183, vcc quad_perm:[1,0,3,2] row_mask:0xf bank_mask:0xf
    v_cndmask_b32_dpp v60, v184, v188, vcc quad_perm:[1,0,3,2] row_mask:0xf bank_mask:0xf
    v_cndmask_b32_dpp v61, v185, v189, vcc quad_perm:[1,0,3,2] row_mask:0xf bank_mask:0xf
    v_mfma_f32_16x16x32_bf16 a[68:71], a[136:139], v[92:95], a[68:71]
    v_cndmask_b32_dpp v62, v186, v190, vcc quad_perm:[1,0,3,2] row_mask:0xf bank_mask:0xf
    v_cndmask_b32_dpp v63, v187, v191, vcc quad_perm:[1,0,3,2] row_mask:0xf bank_mask:0xf
    s_mov_b64 vcc, s[72:73]
    v_mfma_f32_16x16x32_bf16 a[72:75], a[136:139], v[108:111], a[72:75]
    v_cndmask_b32_dpp v176, v56, v48, vcc quad_perm:[2,3,0,1] row_mask:0xf bank_mask:0xf
    v_cndmask_b32_dpp v177, v57, v49, vcc quad_perm:[2,3,0,1] row_mask:0xf bank_mask:0xf
    v_cndmask_b32_dpp v178, v58, v50, vcc quad_perm:[2,3,0,1] row_mask:0xf bank_mask:0xf
    v_mfma_f32_16x16x32_bf16 a[76:79], a[136:139], v[124:127], a[76:79]
    v_cndmask_b32_dpp v179, v59, v51, vcc quad_perm:[2,3,0,1] row_mask:0xf bank_mask:0xf
    v_cndmask_b32_dpp v180, v60, v52, vcc quad_perm:[2,3,0,1] row_mask:0xf bank_mask:0xf
    v_mfma_f32_16x16x32_bf16 a[80:83], a[140:143], v[76:79], a[80:83]
    v_cndmask_b32_dpp v181, v61, v53, vcc quad_perm:[2,3,0,1] row_mask:0xf bank_mask:0xf
    v_cndmask_b32_dpp v182, v62, v54, vcc quad_perm:[2,3,0,1] row_mask:0xf bank_mask:0xf
    v_cndmask_b32_dpp v183, v63, v55, vcc quad_perm:[2,3,0,1] row_mask:0xf bank_mask:0xf
    v_mfma_f32_16x16x32_bf16 a[84:87], a[140:143], v[92:95], a[84:87]
    s_mov_b64 vcc, s[74:75]
    v_cndmask_b32_dpp v184, v48, v56, vcc quad_perm:[2,3,0,1] row_mask:0xf bank_mask:0xf
    v_cndmask_b32_dpp v185, v49, v57, vcc quad_perm:[2,3,0,1] row_mask:0xf bank_mask:0xf
    v_mfma_f32_16x16x32_bf16 a[88:91], a[140:143], v[108:111], a[88:91]
    v_cndmask_b32_dpp v186, v50, v58, vcc quad_perm:[2,3,0,1] row_mask:0xf bank_mask:0xf
    v_cndmask_b32_dpp v187, v51, v59, vcc quad_perm:[2,3,0,1] row_mask:0xf bank_mask:0xf
    v_cndmask_b32_dpp v188, v52, v60, vcc quad_perm:[2,3,0,1] row_mask:0xf bank_mask:0xf
    v_mfma_f32_16x16x32_bf16 a[92:95], a[140:143], v[124:127], a[92:95]
    v_cndmask_b32_dpp v189, v53, v61, vcc quad_perm:[2,3,0,1] row_mask:0xf bank_mask:0xf
    v_cndmask_b32_dpp v190, v54, v62, vcc quad_perm:[2,3,0,1] row_mask:0xf bank_mask:0xf
    v_cndmask_b32_dpp v191, v55, v63, vcc quad_perm:[2,3,0,1] row_mask:0xf bank_mask:0xf
    s_nop 1
    s_waitcnt lgkmcnt(0)
    v_mfma_f32_16x16x32_bf16 a[0:3], a[96:99], v[128:131], a[0:3]
    s_add_u32 m0, s9, 18432
    s_add_u32 s8, s76, 16384
    buffer_load_dwordx4 v14, s[44:47], s8 offen lds
    buffer_load_dwordx4 v14, s[44:47], s8 offen offset:1024 lds
    v_mfma_f32_16x16x32_bf16 a[4:7], a[96:99], v[144:147], a[4:7]
    s_add_u32 m0, s9, 20480
    s_add_u32 s8, s77, 16384
    buffer_load_dwordx4 v14, s[44:47], s8 offen lds
    buffer_load_dwordx4 v14, s[44:47], s8 offen offset:1024 lds
    v_mfma_f32_16x16x32_bf16 a[8:11], a[96:99], v[160:163], a[8:11]
    s_add_u32 m0, s9, 22528
    s_add_u32 s8, s78, 16384
    buffer_load_dwordx4 v14, s[44:47], s8 offen lds
    buffer_load_dwordx4 v14, s[44:47], s8 offen offset:1024 lds
    buffer_load_dwordx4 v[240:243], v13, s[40:43], s80 offen offset:512
    v_mfma_f32_16x16x32_bf16 a[12:15], a[96:99], v[176:179], a[12:15]
    buffer_load_dwordx4 v[244:247], v13, s[40:43], s81 offen offset:512
    buffer_load_dwordx4 v[248:251], v13, s[40:43], s82 offen offset:512
    v_mfma_f32_16x16x32_bf16 a[16:19], a[100:103], v[128:131], a[16:19]
    buffer_load_dwordx4 v[252:255], v13, s[40:43], s83 offen offset:512
    buffer_load_dwordx4 v[64:67], v10, s[40:43], s80 offen offset:768
    v_mfma_f32_16x16x32_bf16 a[20:23], a[100:103], v[144:147], a[20:23]
    buffer_load_dwordx4 v[68:71], v10, s[40:43], s81 offen offset:768
    buffer_load_dwordx4 v[72:75], v10, s[40:43], s82 offen offset:768
    buffer_load_dwordx4 v[76:79], v10, s[40:43], s83 offen offset:768
    v_mfma_f32_16x16x32_bf16 a[24:27], a[100:103], v[160:163], a[24:27]
    s_waitcnt vmcnt(38)
    ds_read_b64_tr_b16 a[120:121], v16 offset:0
    v_mfma_f32_16x16x32_bf16 a[28:31], a[100:103], v[176:179], a[28:31]
    ds_read_b64_tr_b16 a[122:123], v16 offset:256
    ds_read_b64_tr_b16 a[124:125], v17 offset:0
    ds_read_b64_tr_b16 a[126:127], v17 offset:256
    v_mfma_f32_16x16x32_bf16 a[32:35], a[104:107], v[128:131], a[32:35]
    ds_read_b64_tr_b16 a[128:129], v16 offset:2048
    ds_read_b64_tr_b16 a[130:131], v16 offset:2304
    ds_read_b64_tr_b16 a[132:133], v17 offset:2048
    v_mfma_f32_16x16x32_bf16 a[36:39], a[104:107], v[144:147], a[36:39]
    ds_read_b64_tr_b16 a[134:135], v17 offset:2304
    ds_read_b64_tr_b16 a[136:137], v16 offset:4096
    ds_read_b64_tr_b16 a[138:139], v16 offset:4352
    v_mfma_f32_16x16x32_bf16 a[40:43], a[104:107], v[160:163], a[40:43]
    ds_read_b64_tr_b16 a[140:141], v17 offset:4096
    ds_read_b64_tr_b16 a[142:143], v17 offset:4352
    v_mfma_f32_16x16x32_bf16 a[44:47], a[104:107], v[176:179], a[44:47]
    s_waitcnt vmcnt(34)
    s_mov_b64 vcc, s[68:69]
    v_cndmask_b32_dpp v32, v196, v192, vcc quad_perm:[1,0,3,2] row_mask:0xf bank_mask:0xf
    v_mfma_f32_16x16x32_bf16 a[48:51], a[108:111], v[128:131], a[48:51]
    v_cndmask_b32_dpp v33, v197, v193, vcc quad_perm:[1,0,3,2] row_mask:0xf bank_mask:0xf
    v_cndmask_b32_dpp v34, v198, v194, vcc quad_perm:[1,0,3,2] row_mask:0xf bank_mask:0xf
    v_cndmask_b32_dpp v35, v199, v195, vcc quad_perm:[1,0,3,2] row_mask:0xf bank_mask:0xf
    v_mfma_f32_16x16x32_bf16 a[52:55], a[108:111], v[144:147], a[52:55]
    v_cndmask_b32_dpp v40, v204, v200, vcc quad_perm:[1,0,3,2] row_mask:0xf bank_mask:0xf
    v_cndmask_b32_dpp v41, v205, v201, vcc quad_perm:[1,0,3,2] row_mask:0xf bank_mask:0xf
    v_cndmask_b32_dpp v42, v206, v202, vcc quad_perm:[1,0,3,2] row_mask:0xf bank_mask:0xf
    v_mfma_f32_16x16x32_bf16 a[56:59], a[108:111], v[160:163], a[56:59]
    v_cndmask_b32_dpp v43, v207, v203, vcc quad_perm:[1,0,3,2] row_mask:0xf bank_mask:0xf
    s_mov_b64 vcc, s[70:71]
    v_cndmask_b32_dpp v36, v192, v196, vcc quad_perm:[1,0,3,2] row_mask:0xf bank_mask:0xf
    v_mfma_f32_16x16x32_bf16 a[60:63], a[108:111], v[176:179], a[60:63]
    v_cndmask_b32_dpp v37, v193, v197, vcc quad_perm:[1,0,3,2] row_mask:0xf bank_mask:0xf
    v_cndmask_b32_dpp v38, v194, v198, vcc quad_perm:[1,0,3,2] row_mask:0xf bank_mask:0xf
    v_mfma_f32_16x16x32_bf16 a[64:67], a[112:115], v[128:131], a[64:67]
    v_cndmask_b32_dpp v39, v195, v199, vcc quad_perm:[1,0,3,2] row_mask:0xf bank_mask:0xf
    v_cndmask_b32_dpp v44, v200, v204, vcc quad_perm:[1,0,3,2] row_mask:0xf bank_mask:0xf
    v_cndmask_b32_dpp v45, v201, v205, vcc quad_perm:[1,0,3,2] row_mask:0xf bank_mask:0xf
    v_mfma_f32_16x16x32_bf16 a[68:71], a[112:115], v[144:147], a[68:71]
    v_cndmask_b32_dpp v46, v202, v206, vcc quad_perm:[1,0,3,2] row_mask:0xf bank_mask:0xf
    v_cndmask_b32_dpp v47, v203, v207, vcc quad_perm:[1,0,3,2] row_mask:0xf bank_mask:0xf
    s_mov_b64 vcc, s[72:73]
    v_mfma_f32_16x16x32_bf16 a[72:75], a[112:115], v[160:163], a[72:75]
    v_cndmask_b32_dpp v192, v40, v32, vcc quad_perm:[2,3,0,1] row_mask:0xf bank_mask:0xf
    v_cndmask_b32_dpp v193, v41, v33, vcc quad_perm:[2,3,0,1] row_mask:0xf bank_mask:0xf
    v_cndmask_b32_dpp v194, v42, v34, vcc quad_perm:[2,3,0,1] row_mask:0xf bank_mask:0xf
    v_mfma_f32_16x16x32_bf16 a[76:79], a[112:115], v[176:179], a[76:79]
    v_cndmask_b32_dpp v195, v43, v35, vcc quad_perm:[2,3,0,1] row_mask:0xf bank_mask:0xf
    v_cndmask_b32_dpp v196, v44, v36, vcc quad_perm:[2,3,0,1] row_mask:0xf bank_mask:0xf
    v_mfma_f32_16x16x32_bf16 a[80:83], a[116:119], v[128:131], a[80:83]
    v_cndmask_b32_dpp v197, v45, v37, vcc quad_perm:[2,3,0,1] row_mask:0xf bank_mask:0xf
    v_cndmask_b32_dpp v198, v46, v38, vcc quad_perm:[2,3,0,1] row_mask:0xf bank_mask:0xf
    v_cndmask_b32_dpp v199, v47, v39, vcc quad_perm:[2,3,0,1] row_mask:0xf bank_mask:0xf
    v_mfma_f32_16x16x32_bf16 a[84:87], a[116:119], v[144:147], a[84:87]
    s_mov_b64 vcc, s[74:75]
    v_cndmask_b32_dpp v200, v32, v40, vcc quad_perm:[2,3,0,1] row_mask:0xf bank_mask:0xf
    v_cndmask_b32_dpp v201, v33, v41, vcc quad_perm:[2,3,0,1] row_mask:0xf bank_mask:0xf
    v_mfma_f32_16x16x32_bf16 a[88:91], a[116:119], v[160:163], a[88:91]
    v_cndmask_b32_dpp v202, v34, v42, vcc quad_perm:[2,3,0,1] row_mask:0xf bank_mask:0xf
    v_cndmask_b32_dpp v203, v35, v43, vcc quad_perm:[2,3,0,1] row_mask:0xf bank_mask:0xf
    v_cndmask_b32_dpp v204, v36, v44, vcc quad_perm:[2,3,0,1] row_mask:0xf bank_mask:0xf
    v_mfma_f32_16x16x32_bf16 a[92:95], a[116:119], v[176:179], a[92:95]
    v_cndmask_b32_dpp v205, v37, v45, vcc quad_perm:[2,3,0,1] row_mask:0xf bank_mask:0xf
    v_cndmask_b32_dpp v206, v38, v46, vcc quad_perm:[2,3,0,1] row_mask:0xf bank_mask:0xf
    v_cndmask_b32_dpp v207, v39, v47, vcc quad_perm:[2,3,0,1] row_mask:0xf bank_mask:0xf
    s_nop 1
    s_waitcnt lgkmcnt(0)
    v_mfma_f32_16x16x32_bf16 a[0:3], a[120:123], v[132:135], a[0:3]
    s_add_u32 m0, s9, 24576
    s_add_u32 s8, s76, 18432
    buffer_load_dwordx4 v14, s[44:47], s8 offen lds
    v_mfma_f32_16x16x32_bf16 a[4:7], a[120:123], v[148:151], a[4:7]
    buffer_load_dwordx4 v14, s[44:47], s8 offen offset:1024 lds
    s_add_u32 m0, s9, 26624
    s_add_u32 s8, s77, 18432
    buffer_load_dwordx4 v14, s[44:47], s8 offen lds
    v_mfma_f32_16x16x32_bf16 a[8:11], a[120:123], v[164:167], a[8:11]
    buffer_load_dwordx4 v14, s[44:47], s8 offen offset:1024 lds
    s_add_u32 m0, s9, 28672
    s_add_u32 s8, s78, 18432
    buffer_load_dwordx4 v14, s[44:47], s8 offen lds
    v_mfma_f32_16x16x32_bf16 a[12:15], a[120:123], v[180:183], a[12:15]
    buffer_load_dwordx4 v14, s[44:47], s8 offen offset:1024 lds
    v_mfma_f32_16x16x32_bf16 a[16:19], a[124:127], v[132:135], a[16:19]
    buffer_load_dwordx4 v[80:83], v11, s[40:43], s80 offen offset:768
    buffer_load_dwordx4 v[84:87], v11, s[40:43], s81 offen offset:768
    v_mfma_f32_16x16x32_bf16 a[20:23], a[124:127], v[148:151], a[20:23]
    buffer_load_dwordx4 v[88:91], v11, s[40:43], s82 offen offset:768
    buffer_load_dwordx4 v[92:95], v11, s[40:43], s83 offen offset:768
    v_mfma_f32_16x16x32_bf16 a[24:27], a[124:127], v[164:167], a[24:27]
    s_waitcnt vmcnt(38)
    ds_read_b64_tr_b16 a[96:97], v16 offset:6144
    v_mfma_f32_16x16x32_bf16 a[28:31], a[124:127], v[180:183], a[28:31]
    ds_read_b64_tr_b16 a[98:99], v16 offset:6400
    ds_read_b64_tr_b16 a[100:101], v17 offset:6144
    ds_read_b64_tr_b16 a[102:103], v17 offset:6400
    v_mfma_f32_16x16x32_bf16 a[32:35], a[128:131], v[132:135], a[32:35]
    ds_read_b64_tr_b16 a[104:105], v16 offset:8192
    ds_read_b64_tr_b16 a[106:107], v16 offset:8448
    ds_read_b64_tr_b16 a[108:109], v17 offset:8192
    v_mfma_f32_16x16x32_bf16 a[36:39], a[128:131], v[148:151], a[36:39]
    ds_read_b64_tr_b16 a[110:111], v17 offset:8448
    ds_read_b64_tr_b16 a[112:113], v16 offset:10240
    ds_read_b64_tr_b16 a[114:115], v16 offset:10496
    v_mfma_f32_16x16x32_bf16 a[40:43], a[128:131], v[164:167], a[40:43]
    ds_read_b64_tr_b16 a[116:117], v17 offset:10240
    ds_read_b64_tr_b16 a[118:119], v17 offset:10496
    v_mfma_f32_16x16x32_bf16 a[44:47], a[128:131], v[180:183], a[44:47]
    s_waitcnt vmcnt(34)
    s_mov_b64 vcc, s[68:69]
    v_cndmask_b32_dpp v48, v212, v208, vcc quad_perm:[1,0,3,2] row_mask:0xf bank_mask:0xf
    v_mfma_f32_16x16x32_bf16 a[48:51], a[132:135], v[132:135], a[48:51]
    v_cndmask_b32_dpp v49, v213, v209, vcc quad_perm:[1,0,3,2] row_mask:0xf bank_mask:0xf
    v_cndmask_b32_dpp v50, v214, v210, vcc quad_perm:[1,0,3,2] row_mask:0xf bank_mask:0xf
    v_cndmask_b32_dpp v51, v215, v211, vcc quad_perm:[1,0,3,2] row_mask:0xf bank_mask:0xf
    v_mfma_f32_16x16x32_bf16 a[52:55], a[132:135], v[148:151], a[52:55]
    v_cndmask_b32_dpp v56, v220, v216, vcc quad_perm:[1,0,3,2] row_mask:0xf bank_mask:0xf
    v_cndmask_b32_dpp v57, v221, v217, vcc quad_perm:[1,0,3,2] row_mask:0xf bank_mask:0xf
    v_cndmask_b32_dpp v58, v222, v218, vcc quad_perm:[1,0,3,2] row_mask:0xf bank_mask:0xf
    v_mfma_f32_16x16x32_bf16 a[56:59], a[132:135], v[164:167], a[56:59]
    v_cndmask_b32_dpp v59, v223, v219, vcc quad_perm:[1,0,3,2] row_mask:0xf bank_mask:0xf
    s_mov_b64 vcc, s[70:71]
    v_cndmask_b32_dpp v52, v208, v212, vcc quad_perm:[1,0,3,2] row_mask:0xf bank_mask:0xf
    v_mfma_f32_16x16x32_bf16 a[60:63], a[132:135], v[180:183], a[60:63]
    v_cndmask_b32_dpp v53, v209, v213, vcc quad_perm:[1,0,3,2] row_mask:0xf bank_mask:0xf
    v_cndmask_b32_dpp v54, v210, v214, vcc quad_perm:[1,0,3,2] row_mask:0xf bank_mask:0xf
    v_mfma_f32_16x16x32_bf16 a[64:67], a[136:139], v[132:135], a[64:67]
    v_cndmask_b32_dpp v55, v211, v215, vcc quad_perm:[1,0,3,2] row_mask:0xf bank_mask:0xf
    v_cndmask_b32_dpp v60, v216, v220, vcc quad_perm:[1,0,3,2] row_mask:0xf bank_mask:0xf
    v_cndmask_b32_dpp v61, v217, v221, vcc quad_perm:[1,0,3,2] row_mask:0xf bank_mask:0xf
    v_mfma_f32_16x16x32_bf16 a[68:71], a[136:139], v[148:151], a[68:71]
    v_cndmask_b32_dpp v62, v218, v222, vcc quad_perm:[1,0,3,2] row_mask:0xf bank_mask:0xf
    v_cndmask_b32_dpp v63, v219, v223, vcc quad_perm:[1,0,3,2] row_mask:0xf bank_mask:0xf
    s_mov_b64 vcc, s[72:73]
    v_mfma_f32_16x16x32_bf16 a[72:75], a[136:139], v[164:167], a[72:75]
    v_cndmask_b32_dpp v208, v56, v48, vcc quad_perm:[2,3,0,1] row_mask:0xf bank_mask:0xf
    v_cndmask_b32_dpp v209, v57, v49, vcc quad_perm:[2,3,0,1] row_mask:0xf bank_mask:0xf
    v_cndmask_b32_dpp v210, v58, v50, vcc quad_perm:[2,3,0,1] row_mask:0xf bank_mask:0xf
    v_mfma_f32_16x16x32_bf16 a[76:79], a[136:139], v[180:183], a[76:79]
    v_cndmask_b32_dpp v211, v59, v51, vcc quad_perm:[2,3,0,1] row_mask:0xf bank_mask:0xf
    v_cndmask_b32_dpp v212, v60, v52, vcc quad_perm:[2,3,0,1] row_mask:0xf bank_mask:0xf
    v_mfma_f32_16x16x32_bf16 a[80:83], a[140:143], v[132:135], a[80:83]
    v_cndmask_b32_dpp v213, v61, v53, vcc quad_perm:[2,3,0,1] row_mask:0xf bank_mask:0xf
    v_cndmask_b32_dpp v214, v62, v54, vcc quad_perm:[2,3,0,1] row_mask:0xf bank_mask:0xf
    v_cndmask_b32_dpp v215, v63, v55, vcc quad_perm:[2,3,0,1] row_mask:0xf bank_mask:0xf
    v_mfma_f32_16x16x32_bf16 a[84:87], a[140:143], v[148:151], a[84:87]
    s_mov_b64 vcc, s[74:75]
    v_cndmask_b32_dpp v216, v48, v56, vcc quad_perm:[2,3,0,1] row_mask:0xf bank_mask:0xf
    v_cndmask_b32_dpp v217, v49, v57, vcc quad_perm:[2,3,0,1] row_mask:0xf bank_mask:0xf
    v_mfma_f32_16x16x32_bf16 a[88:91], a[140:143], v[164:167], a[88:91]
    v_cndmask_b32_dpp v218, v50, v58, vcc quad_perm:[2,3,0,1] row_mask:0xf bank_mask:0xf
    v_cndmask_b32_dpp v219, v51, v59, vcc quad_perm:[2,3,0,1] row_mask:0xf bank_mask:0xf
    v_cndmask_b32_dpp v220, v52, v60, vcc quad_perm:[2,3,0,1] row_mask:0xf bank_mask:0xf
    v_mfma_f32_16x16x32_bf16 a[92:95], a[140:143], v[180:183], a[92:95]
    v_cndmask_b32_dpp v221, v53, v61, vcc quad_perm:[2,3,0,1] row_mask:0xf bank_mask:0xf
    v_cndmask_b32_dpp v222, v54, v62, vcc quad_perm:[2,3,0,1] row_mask:0xf bank_mask:0xf
    v_cndmask_b32_dpp v223, v55, v63, vcc quad_perm:[2,3,0,1] row_mask:0xf bank_mask:0xf
    s_nop 1
    s_waitcnt lgkmcnt(0)
    v_mfma_f32_16x16x32_bf16 a[0:3], a[96:99], v[136:139], a[0:3]
    s_add_u32 m0, s9, 0
    s_add_u32 s8, s76, 20480
    buffer_load_dwordx4 v14, s[44:47], s8 offen lds
    v_mfma_f32_16x16x32_bf16 a[4:7], a[96:99], v[152:155], a[4:7]
    buffer_load_dwordx4 v14, s[44:47], s8 offen offset:1024 lds
    s_add_u32 m0, s9, 2048
    s_add_u32 s8, s77, 20480
    buffer_load_dwordx4 v14, s[44:47], s8 offen lds
    v_mfma_f32_16x16x32_bf16 a[8:11], a[96:99], v[168:171], a[8:11]
    buffer_load_dwordx4 v14, s[44:47], s8 offen offset:1024 lds
    s_add_u32 m0, s9, 4096
    s_add_u32 s8, s78, 20480
    buffer_load_dwordx4 v14, s[44:47], s8 offen lds
    v_mfma_f32_16x16x32_bf16 a[12:15], a[96:99], v[184:187], a[12:15]
    buffer_load_dwordx4 v14, s[44:47], s8 offen offset:1024 lds
    v_mfma_f32_16x16x32_bf16 a[16:19], a[100:103], v[136:139], a[16:19]
    buffer_load_dwordx4 v[96:99], v12, s[40:43], s80 offen offset:768
    buffer_load_dwordx4 v[100:103], v12, s[40:43], s81 offen offset:768
    v_mfma_f32_16x16x32_bf16 a[20:23], a[100:103], v[152:155], a[20:23]
    buffer_load_dwordx4 v[104:107], v12, s[40:43], s82 offen offset:768
    buffer_load_dwordx4 v[108:111], v12, s[40:43], s83 offen offset:768
    v_mfma_f32_16x16x32_bf16 a[24:27], a[100:103], v[168:171], a[24:27]
    s_waitcnt vmcnt(38)
    ds_read_b64_tr_b16 a[120:121], v16 offset:12288
    v_mfma_f32_16x16x32_bf16 a[28:31], a[100:103], v[184:187], a[28:31]
    ds_read_b64_tr_b16 a[122:123], v16 offset:12544
    ds_read_b64_tr_b16 a[124:125], v17 offset:12288
    ds_read_b64_tr_b16 a[126:127], v17 offset:12544
    v_mfma_f32_16x16x32_bf16 a[32:35], a[104:107], v[136:139], a[32:35]
    ds_read_b64_tr_b16 a[128:129], v16 offset:14336
    ds_read_b64_tr_b16 a[130:131], v16 offset:14592
    ds_read_b64_tr_b16 a[132:133], v17 offset:14336
    v_mfma_f32_16x16x32_bf16 a[36:39], a[104:107], v[152:155], a[36:39]
    ds_read_b64_tr_b16 a[134:135], v17 offset:14592
    ds_read_b64_tr_b16 a[136:137], v16 offset:16384
    ds_read_b64_tr_b16 a[138:139], v16 offset:16640
    v_mfma_f32_16x16x32_bf16 a[40:43], a[104:107], v[168:171], a[40:43]
    ds_read_b64_tr_b16 a[140:141], v17 offset:16384
    ds_read_b64_tr_b16 a[142:143], v17 offset:16640
    v_mfma_f32_16x16x32_bf16 a[44:47], a[104:107], v[184:187], a[44:47]
    s_waitcnt vmcnt(34)
    s_mov_b64 vcc, s[68:69]
    v_cndmask_b32_dpp v32, v228, v224, vcc quad_perm:[1,0,3,2] row_mask:0xf bank_mask:0xf
    v_mfma_f32_16x16x32_bf16 a[48:51], a[108:111], v[136:139], a[48:51]
    v_cndmask_b32_dpp v33, v229, v225, vcc quad_perm:[1,0,3,2] row_mask:0xf bank_mask:0xf
    v_cndmask_b32_dpp v34, v230, v226, vcc quad_perm:[1,0,3,2] row_mask:0xf bank_mask:0xf
    v_cndmask_b32_dpp v35, v231, v227, vcc quad_perm:[1,0,3,2] row_mask:0xf bank_mask:0xf
    v_mfma_f32_16x16x32_bf16 a[52:55], a[108:111], v[152:155], a[52:55]
    v_cndmask_b32_dpp v40, v236, v232, vcc quad_perm:[1,0,3,2] row_mask:0xf bank_mask:0xf
    v_cndmask_b32_dpp v41, v237, v233, vcc quad_perm:[1,0,3,2] row_mask:0xf bank_mask:0xf
    v_cndmask_b32_dpp v42, v238, v234, vcc quad_perm:[1,0,3,2] row_mask:0xf bank_mask:0xf
    v_mfma_f32_16x16x32_bf16 a[56:59], a[108:111], v[168:171], a[56:59]
    v_cndmask_b32_dpp v43, v239, v235, vcc quad_perm:[1,0,3,2] row_mask:0xf bank_mask:0xf
    s_mov_b64 vcc, s[70:71]
    v_cndmask_b32_dpp v36, v224, v228, vcc quad_perm:[1,0,3,2] row_mask:0xf bank_mask:0xf
    v_mfma_f32_16x16x32_bf16 a[60:63], a[108:111], v[184:187], a[60:63]
    v_cndmask_b32_dpp v37, v225, v229, vcc quad_perm:[1,0,3,2] row_mask:0xf bank_mask:0xf
    v_cndmask_b32_dpp v38, v226, v230, vcc quad_perm:[1,0,3,2] row_mask:0xf bank_mask:0xf
    v_mfma_f32_16x16x32_bf16 a[64:67], a[112:115], v[136:139], a[64:67]
    v_cndmask_b32_dpp v39, v227, v231, vcc quad_perm:[1,0,3,2] row_mask:0xf bank_mask:0xf
    v_cndmask_b32_dpp v44, v232, v236, vcc quad_perm:[1,0,3,2] row_mask:0xf bank_mask:0xf
    v_cndmask_b32_dpp v45, v233, v237, vcc quad_perm:[1,0,3,2] row_mask:0xf bank_mask:0xf
    v_mfma_f32_16x16x32_bf16 a[68:71], a[112:115], v[152:155], a[68:71]
    v_cndmask_b32_dpp v46, v234, v238, vcc quad_perm:[1,0,3,2] row_mask:0xf bank_mask:0xf
    v_cndmask_b32_dpp v47, v235, v239, vcc quad_perm:[1,0,3,2] row_mask:0xf bank_mask:0xf
    s_mov_b64 vcc, s[72:73]
    v_mfma_f32_16x16x32_bf16 a[72:75], a[112:115], v[168:171], a[72:75]
    v_cndmask_b32_dpp v224, v40, v32, vcc quad_perm:[2,3,0,1] row_mask:0xf bank_mask:0xf
    v_cndmask_b32_dpp v225, v41, v33, vcc quad_perm:[2,3,0,1] row_mask:0xf bank_mask:0xf
    v_cndmask_b32_dpp v226, v42, v34, vcc quad_perm:[2,3,0,1] row_mask:0xf bank_mask:0xf
    v_mfma_f32_16x16x32_bf16 a[76:79], a[112:115], v[184:187], a[76:79]
    v_cndmask_b32_dpp v227, v43, v35, vcc quad_perm:[2,3,0,1] row_mask:0xf bank_mask:0xf
    v_cndmask_b32_dpp v228, v44, v36, vcc quad_perm:[2,3,0,1] row_mask:0xf bank_mask:0xf
    v_mfma_f32_16x16x32_bf16 a[80:83], a[116:119], v[136:139], a[80:83]
    v_cndmask_b32_dpp v229, v45, v37, vcc quad_perm:[2,3,0,1] row_mask:0xf bank_mask:0xf
    v_cndmask_b32_dpp v230, v46, v38, vcc quad_perm:[2,3,0,1] row_mask:0xf bank_mask:0xf
    v_cndmask_b32_dpp v231, v47, v39, vcc quad_perm:[2,3,0,1] row_mask:0xf bank_mask:0xf
    v_mfma_f32_16x16x32_bf16 a[84:87], a[116:119], v[152:155], a[84:87]
    s_mov_b64 vcc, s[74:75]
    v_cndmask_b32_dpp v232, v32, v40, vcc quad_perm:[2,3,0,1] row_mask:0xf bank_mask:0xf
    v_cndmask_b32_dpp v233, v33, v41, vcc quad_perm:[2,3,0,1] row_mask:0xf bank_mask:0xf
    v_mfma_f32_16x16x32_bf16 a[88:91], a[116:119], v[168:171], a[88:91]
    v_cndmask_b32_dpp v234, v34, v42, vcc quad_perm:[2,3,0,1] row_mask:0xf bank_mask:0xf
    v_cndmask_b32_dpp v235, v35, v43, vcc quad_perm:[2,3,0,1] row_mask:0xf bank_mask:0xf
    v_cndmask_b32_dpp v236, v36, v44, vcc quad_perm:[2,3,0,1] row_mask:0xf bank_mask:0xf
    v_mfma_f32_16x16x32_bf16 a[92:95], a[116:119], v[184:187], a[92:95]
    v_cndmask_b32_dpp v237, v37, v45, vcc quad_perm:[2,3,0,1] row_mask:0xf bank_mask:0xf
    v_cndmask_b32_dpp v238, v38, v46, vcc quad_perm:[2,3,0,1] row_mask:0xf bank_mask:0xf
    v_cndmask_b32_dpp v239, v39, v47, vcc quad_perm:[2,3,0,1] row_mask:0xf bank_mask:0xf
    s_nop 1
    s_waitcnt lgkmcnt(0)
    v_mfma_f32_16x16x32_bf16 a[0:3], a[120:123], v[140:143], a[0:3]
    s_add_u32 m0, s9, 6144
    s_add_u32 s8, s76, 22528
    buffer_load_dwordx4 v14, s[44:47], s8 offen lds
    v_mfma_f32_16x16x32_bf16 a[4:7], a[120:123], v[156:159], a[4:7]
    buffer_load_dwordx4 v14, s[44:47], s8 offen offset:1024 lds
    s_add_u32 m0, s9, 8192
    s_add_u32 s8, s77, 22528
    buffer_load_dwordx4 v14, s[44:47], s8 offen lds
    v_mfma_f32_16x16x32_bf16 a[8:11], a[120:123], v[172:175], a[8:11]
    buffer_load_dwordx4 v14, s[44:47], s8 offen offset:1024 lds
    s_add_u32 m0, s9, 10240
    s_add_u32 s8, s78, 22528
    buffer_load_dwordx4 v14, s[44:47], s8 offen lds
    v_mfma_f32_16x16x32_bf16 a[12:15], a[120:123], v[188:191], a[12:15]
    buffer_load_dwordx4 v14, s[44:47], s8 offen offset:1024 lds
    v_mfma_f32_16x16x32_bf16 a[16:19], a[124:127], v[140:143], a[16:19]
    buffer_load_dwordx4 v[112:115], v13, s[40:43], s80 offen offset:768
    buffer_load_dwordx4 v[116:119], v13, s[40:43], s81 offen offset:768
    v_mfma_f32_16x16x32_bf16 a[20:23], a[124:127], v[156:159], a[20:23]
    buffer_load_dwordx4 v[120:123], v13, s[40:43], s82 offen offset:768
    buffer_load_dwordx4 v[124:127], v13, s[40:43], s83 offen offset:768
    v_mfma_f32_16x16x32_bf16 a[24:27], a[124:127], v[172:175], a[24:27]
    s_waitcnt vmcnt(38)
    ds_read_b64_tr_b16 a[96:97], v16 offset:18432
    v_mfma_f32_16x16x32_bf16 a[28:31], a[124:127], v[188:191], a[28:31]
    ds_read_b64_tr_b16 a[98:99], v16 offset:18688
    ds_read_b64_tr_b16 a[100:101], v17 offset:18432
    ds_read_b64_tr_b16 a[102:103], v17 offset:18688
    v_mfma_f32_16x16x32_bf16 a[32:35], a[128:131], v[140:143], a[32:35]
    ds_read_b64_tr_b16 a[104:105], v16 offset:20480
    ds_read_b64_tr_b16 a[106:107], v16 offset:20736
    ds_read_b64_tr_b16 a[108:109], v17 offset:20480
    v_mfma_f32_16x16x32_bf16 a[36:39], a[128:131], v[156:159], a[36:39]
    ds_read_b64_tr_b16 a[110:111], v17 offset:20736
    ds_read_b64_tr_b16 a[112:113], v16 offset:22528
    ds_read_b64_tr_b16 a[114:115], v16 offset:22784
    v_mfma_f32_16x16x32_bf16 a[40:43], a[128:131], v[172:175], a[40:43]
    ds_read_b64_tr_b16 a[116:117], v17 offset:22528
    ds_read_b64_tr_b16 a[118:119], v17 offset:22784
    v_mfma_f32_16x16x32_bf16 a[44:47], a[128:131], v[188:191], a[44:47]
    s_waitcnt vmcnt(34)
    s_mov_b64 vcc, s[68:69]
    v_cndmask_b32_dpp v48, v244, v240, vcc quad_perm:[1,0,3,2] row_mask:0xf bank_mask:0xf
    v_mfma_f32_16x16x32_bf16 a[48:51], a[132:135], v[140:143], a[48:51]
    v_cndmask_b32_dpp v49, v245, v241, vcc quad_perm:[1,0,3,2] row_mask:0xf bank_mask:0xf
    v_cndmask_b32_dpp v50, v246, v242, vcc quad_perm:[1,0,3,2] row_mask:0xf bank_mask:0xf
    v_cndmask_b32_dpp v51, v247, v243, vcc quad_perm:[1,0,3,2] row_mask:0xf bank_mask:0xf
    v_mfma_f32_16x16x32_bf16 a[52:55], a[132:135], v[156:159], a[52:55]
    v_cndmask_b32_dpp v56, v252, v248, vcc quad_perm:[1,0,3,2] row_mask:0xf bank_mask:0xf
    v_cndmask_b32_dpp v57, v253, v249, vcc quad_perm:[1,0,3,2] row_mask:0xf bank_mask:0xf
    v_cndmask_b32_dpp v58, v254, v250, vcc quad_perm:[1,0,3,2] row_mask:0xf bank_mask:0xf
    v_mfma_f32_16x16x32_bf16 a[56:59], a[132:135], v[172:175], a[56:59]
    v_cndmask_b32_dpp v59, v255, v251, vcc quad_perm:[1,0,3,2] row_mask:0xf bank_mask:0xf
    s_mov_b64 vcc, s[70:71]
    v_cndmask_b32_dpp v52, v240, v244, vcc quad_perm:[1,0,3,2] row_mask:0xf bank_mask:0xf
    v_mfma_f32_16x16x32_bf16 a[60:63], a[132:135], v[188:191], a[60:63]
    v_cndmask_b32_dpp v53, v241, v245, vcc quad_perm:[1,0,3,2] row_mask:0xf bank_mask:0xf
    v_cndmask_b32_dpp v54, v242, v246, vcc quad_perm:[1,0,3,2] row_mask:0xf bank_mask:0xf
    v_mfma_f32_16x16x32_bf16 a[64:67], a[136:139], v[140:143], a[64:67]
    v_cndmask_b32_dpp v55, v243, v247, vcc quad_perm:[1,0,3,2] row_mask:0xf bank_mask:0xf
    v_cndmask_b32_dpp v60, v248, v252, vcc quad_perm:[1,0,3,2] row_mask:0xf bank_mask:0xf
    v_cndmask_b32_dpp v61, v249, v253, vcc quad_perm:[1,0,3,2] row_mask:0xf bank_mask:0xf
    v_mfma_f32_16x16x32_bf16 a[68:71], a[136:139], v[156:159], a[68:71]
    v_cndmask_b32_dpp v62, v250, v254, vcc quad_perm:[1,0,3,2] row_mask:0xf bank_mask:0xf
    v_cndmask_b32_dpp v63, v251, v255, vcc quad_perm:[1,0,3,2] row_mask:0xf bank_mask:0xf
    s_mov_b64 vcc, s[72:73]
    v_mfma_f32_16x16x32_bf16 a[72:75], a[136:139], v[172:175], a[72:75]
    v_cndmask_b32_dpp v240, v56, v48, vcc quad_perm:[2,3,0,1] row_mask:0xf bank_mask:0xf
    v_cndmask_b32_dpp v241, v57, v49, vcc quad_perm:[2,3,0,1] row_mask:0xf bank_mask:0xf
    v_cndmask_b32_dpp v242, v58, v50, vcc quad_perm:[2,3,0,1] row_mask:0xf bank_mask:0xf
    v_mfma_f32_16x16x32_bf16 a[76:79], a[136:139], v[188:191], a[76:79]
    v_cndmask_b32_dpp v243, v59, v51, vcc quad_perm:[2,3,0,1] row_mask:0xf bank_mask:0xf
    v_cndmask_b32_dpp v244, v60, v52, vcc quad_perm:[2,3,0,1] row_mask:0xf bank_mask:0xf
    v_mfma_f32_16x16x32_bf16 a[80:83], a[140:143], v[140:143], a[80:83]
    v_cndmask_b32_dpp v245, v61, v53, vcc quad_perm:[2,3,0,1] row_mask:0xf bank_mask:0xf
    v_cndmask_b32_dpp v246, v62, v54, vcc quad_perm:[2,3,0,1] row_mask:0xf bank_mask:0xf
    v_cndmask_b32_dpp v247, v63, v55, vcc quad_perm:[2,3,0,1] row_mask:0xf bank_mask:0xf
    v_mfma_f32_16x16x32_bf16 a[84:87], a[140:143], v[156:159], a[84:87]
    s_mov_b64 vcc, s[74:75]
    v_cndmask_b32_dpp v248, v48, v56, vcc quad_perm:[2,3,0,1] row_mask:0xf bank_mask:0xf
    v_cndmask_b32_dpp v249, v49, v57, vcc quad_perm:[2,3,0,1] row_mask:0xf bank_mask:0xf
    v_mfma_f32_16x16x32_bf16 a[88:91], a[140:143], v[172:175], a[88:91]
    v_cndmask_b32_dpp v250, v50, v58, vcc quad_perm:[2,3,0,1] row_mask:0xf bank_mask:0xf
    v_cndmask_b32_dpp v251, v51, v59, vcc quad_perm:[2,3,0,1] row_mask:0xf bank_mask:0xf
    v_cndmask_b32_dpp v252, v52, v60, vcc quad_perm:[2,3,0,1] row_mask:0xf bank_mask:0xf
    v_mfma_f32_16x16x32_bf16 a[92:95], a[140:143], v[188:191], a[92:95]
    v_cndmask_b32_dpp v253, v53, v61, vcc quad_perm:[2,3,0,1] row_mask:0xf bank_mask:0xf
    v_cndmask_b32_dpp v254, v54, v62, vcc quad_perm:[2,3,0,1] row_mask:0xf bank_mask:0xf
    v_cndmask_b32_dpp v255, v55, v63, vcc quad_perm:[2,3,0,1] row_mask:0xf bank_mask:0xf
    s_nop 1
    s_waitcnt lgkmcnt(0)
    v_mfma_f32_16x16x32_bf16 a[0:3], a[96:99], v[192:195], a[0:3]
    s_add_u32 m0, s9, 12288
    s_add_u32 s8, s76, 24576
    buffer_load_dwordx4 v14, s[44:47], s8 offen lds
    v_mfma_f32_16x16x32_bf16 a[4:7], a[96:99], v[208:211], a[4:7]
    buffer_load_dwordx4 v14, s[44:47], s8 offen offset:1024 lds
    v_mfma_f32_16x16x32_bf16 a[8:11], a[96:99], v[224:227], a[8:11]
    s_add_u32 m0, s9, 14336
    s_add_u32 s8, s77, 24576
    buffer_load_dwordx4 v14, s[44:47], s8 offen lds
    v_mfma_f32_16x16x32_bf16 a[12:15], a[96:99], v[240:243], a[12:15]
    buffer_load_dwordx4 v14, s[44:47], s8 offen offset:1024 lds
    v_mfma_f32_16x16x32_bf16 a[16:19], a[100:103], v[192:195], a[16:19]
    s_add_u32 m0, s9, 16384
    s_add_u32 s8, s78, 24576
    buffer_load_dwordx4 v14, s[44:47], s8 offen lds
    v_mfma_f32_16x16x32_bf16 a[20:23], a[100:103], v[208:211], a[20:23]
    buffer_load_dwordx4 v14, s[44:47], s8 offen offset:1024 lds
    v_mfma_f32_16x16x32_bf16 a[24:27], a[100:103], v[224:227], a[24:27]
    s_waitcnt vmcnt(30)
    ds_read_b64_tr_b16 a[120:121], v16 offset:24576
    v_mfma_f32_16x16x32_bf16 a[28:31], a[100:103], v[240:243], a[28:31]
    ds_read_b64_tr_b16 a[122:123], v16 offset:24832
    ds_read_b64_tr_b16 a[124:125], v17 offset:24576
    ds_read_b64_tr_b16 a[126:127], v17 offset:24832
    v_mfma_f32_16x16x32_bf16 a[32:35], a[104:107], v[192:195], a[32:35]
    ds_read_b64_tr_b16 a[128:129], v16 offset:26624
    ds_read_b64_tr_b16 a[130:131], v16 offset:26880
    ds_read_b64_tr_b16 a[132:133], v17 offset:26624
    v_mfma_f32_16x16x32_bf16 a[36:39], a[104:107], v[208:211], a[36:39]
    ds_read_b64_tr_b16 a[134:135], v17 offset:26880
    ds_read_b64_tr_b16 a[136:137], v16 offset:28672
    ds_read_b64_tr_b16 a[138:139], v16 offset:28928
    v_mfma_f32_16x16x32_bf16 a[40:43], a[104:107], v[224:227], a[40:43]
    ds_read_b64_tr_b16 a[140:141], v17 offset:28672
    ds_read_b64_tr_b16 a[142:143], v17 offset:28928
    v_mfma_f32_16x16x32_bf16 a[44:47], a[104:107], v[240:243], a[44:47]
    s_waitcnt vmcnt(36)
    s_mov_b64 vcc, s[68:69]
    v_cndmask_b32_dpp v32, v68, v64, vcc quad_perm:[1,0,3,2] row_mask:0xf bank_mask:0xf
    v_mfma_f32_16x16x32_bf16 a[48:51], a[108:111], v[192:195], a[48:51]
    v_cndmask_b32_dpp v33, v69, v65, vcc quad_perm:[1,0,3,2] row_mask:0xf bank_mask:0xf
    v_cndmask_b32_dpp v34, v70, v66, vcc quad_perm:[1,0,3,2] row_mask:0xf bank_mask:0xf
    v_cndmask_b32_dpp v35, v71, v67, vcc quad_perm:[1,0,3,2] row_mask:0xf bank_mask:0xf
    v_mfma_f32_16x16x32_bf16 a[52:55], a[108:111], v[208:211], a[52:55]
    v_cndmask_b32_dpp v40, v76, v72, vcc quad_perm:[1,0,3,2] row_mask:0xf bank_mask:0xf
    v_cndmask_b32_dpp v41, v77, v73, vcc quad_perm:[1,0,3,2] row_mask:0xf bank_mask:0xf
    v_cndmask_b32_dpp v42, v78, v74, vcc quad_perm:[1,0,3,2] row_mask:0xf bank_mask:0xf
    v_mfma_f32_16x16x32_bf16 a[56:59], a[108:111], v[224:227], a[56:59]
    v_cndmask_b32_dpp v43, v79, v75, vcc quad_perm:[1,0,3,2] row_mask:0xf bank_mask:0xf
    s_mov_b64 vcc, s[70:71]
    v_cndmask_b32_dpp v36, v64, v68, vcc quad_perm:[1,0,3,2] row_mask:0xf bank_mask:0xf
    v_mfma_f32_16x16x32_bf16 a[60:63], a[108:111], v[240:243], a[60:63]
    v_cndmask_b32_dpp v37, v65, v69, vcc quad_perm:[1,0,3,2] row_mask:0xf bank_mask:0xf
    v_cndmask_b32_dpp v38, v66, v70, vcc quad_perm:[1,0,3,2] row_mask:0xf bank_mask:0xf
    v_mfma_f32_16x16x32_bf16 a[64:67], a[112:115], v[192:195], a[64:67]
    v_cndmask_b32_dpp v39, v67, v71, vcc quad_perm:[1,0,3,2] row_mask:0xf bank_mask:0xf
    v_cndmask_b32_dpp v44, v72, v76, vcc quad_perm:[1,0,3,2] row_mask:0xf bank_mask:0xf
    v_cndmask_b32_dpp v45, v73, v77, vcc quad_perm:[1,0,3,2] row_mask:0xf bank_mask:0xf
    v_mfma_f32_16x16x32_bf16 a[68:71], a[112:115], v[208:211], a[68:71]
    v_cndmask_b32_dpp v46, v74, v78, vcc quad_perm:[1,0,3,2] row_mask:0xf bank_mask:0xf
    v_cndmask_b32_dpp v47, v75, v79, vcc quad_perm:[1,0,3,2] row_mask:0xf bank_mask:0xf
    s_mov_b64 vcc, s[72:73]
    v_mfma_f32_16x16x32_bf16 a[72:75], a[112:115], v[224:227], a[72:75]
    v_cndmask_b32_dpp v64, v40, v32, vcc quad_perm:[2,3,0,1] row_mask:0xf bank_mask:0xf
    v_cndmask_b32_dpp v65, v41, v33, vcc quad_perm:[2,3,0,1] row_mask:0xf bank_mask:0xf
    v_cndmask_b32_dpp v66, v42, v34, vcc quad_perm:[2,3,0,1] row_mask:0xf bank_mask:0xf
    v_mfma_f32_16x16x32_bf16 a[76:79], a[112:115], v[240:243], a[76:79]
    v_cndmask_b32_dpp v67, v43, v35, vcc quad_perm:[2,3,0,1] row_mask:0xf bank_mask:0xf
    v_cndmask_b32_dpp v68, v44, v36, vcc quad_perm:[2,3,0,1] row_mask:0xf bank_mask:0xf
    v_mfma_f32_16x16x32_bf16 a[80:83], a[116:119], v[192:195], a[80:83]
    v_cndmask_b32_dpp v69, v45, v37, vcc quad_perm:[2,3,0,1] row_mask:0xf bank_mask:0xf
    v_cndmask_b32_dpp v70, v46, v38, vcc quad_perm:[2,3,0,1] row_mask:0xf bank_mask:0xf
    v_cndmask_b32_dpp v71, v47, v39, vcc quad_perm:[2,3,0,1] row_mask:0xf bank_mask:0xf
    v_mfma_f32_16x16x32_bf16 a[84:87], a[116:119], v[208:211], a[84:87]
    s_mov_b64 vcc, s[74:75]
    v_cndmask_b32_dpp v72, v32, v40, vcc quad_perm:[2,3,0,1] row_mask:0xf bank_mask:0xf
    v_cndmask_b32_dpp v73, v33, v41, vcc quad_perm:[2,3,0,1] row_mask:0xf bank_mask:0xf
    v_mfma_f32_16x16x32_bf16 a[88:91], a[116:119], v[224:227], a[88:91]
    v_cndmask_b32_dpp v74, v34, v42, vcc quad_perm:[2,3,0,1] row_mask:0xf bank_mask:0xf
    v_cndmask_b32_dpp v75, v35, v43, vcc quad_perm:[2,3,0,1] row_mask:0xf bank_mask:0xf
    v_cndmask_b32_dpp v76, v36, v44, vcc quad_perm:[2,3,0,1] row_mask:0xf bank_mask:0xf
    v_mfma_f32_16x16x32_bf16 a[92:95], a[116:119], v[240:243], a[92:95]
    v_cndmask_b32_dpp v77, v37, v45, vcc quad_perm:[2,3,0,1] row_mask:0xf bank_mask:0xf
    v_cndmask_b32_dpp v78, v38, v46, vcc quad_perm:[2,3,0,1] row_mask:0xf bank_mask:0xf
    v_cndmask_b32_dpp v79, v39, v47, vcc quad_perm:[2,3,0,1] row_mask:0xf bank_mask:0xf
    s_nop 1
    s_waitcnt lgkmcnt(0)
    v_mfma_f32_16x16x32_bf16 a[0:3], a[120:123], v[196:199], a[0:3]
    s_add_u32 m0, s9, 18432
    s_add_u32 s8, s76, 26624
    buffer_load_dwordx4 v14, s[44:47], s8 offen lds
    v_mfma_f32_16x16x32_bf16 a[4:7], a[120:123], v[212:215], a[4:7]
    buffer_load_dwordx4 v14, s[44:47], s8 offen offset:1024 lds
    v_mfma_f32_16x16x32_bf16 a[8:11], a[120:123], v[228:231], a[8:11]
    s_add_u32 m0, s9, 20480
    s_add_u32 s8, s77, 26624
    buffer_load_dwordx4 v14, s[44:47], s8 offen lds
    v_mfma_f32_16x16x32_bf16 a[12:15], a[120:123], v[244:247], a[12:15]
    buffer_load_dwordx4 v14, s[44:47], s8 offen offset:1024 lds
    v_mfma_f32_16x16x32_bf16 a[16:19], a[124:127], v[196:199], a[16:19]
    s_add_u32 m0, s9, 22528
    s_add_u32 s8, s78, 26624
    buffer_load_dwordx4 v14, s[44:47], s8 offen lds
    v_mfma_f32_16x16x32_bf16 a[20:23], a[124:127], v[212:215], a[20:23]
    buffer_load_dwordx4 v14, s[44:47], s8 offen offset:1024 lds
    v_mfma_f32_16x16x32_bf16 a[24:27], a[124:127], v[228:231], a[24:27]
    s_waitcnt vmcnt(26)
    ds_read_b64_tr_b16 a[96:97], v16 offset:0
    v_mfma_f32_16x16x32_bf16 a[28:31], a[124:127], v[244:247], a[28:31]
    ds_read_b64_tr_b16 a[98:99], v16 offset:256
    ds_read_b64_tr_b16 a[100:101], v17 offset:0
    ds_read_b64_tr_b16 a[102:103], v17 offset:256
    v_mfma_f32_16x16x32_bf16 a[32:35], a[128:131], v[196:199], a[32:35]
    ds_read_b64_tr_b16 a[104:105], v16 offset:2048
    ds_read_b64_tr_b16 a[106:107], v16 offset:2304
    ds_read_b64_tr_b16 a[108:109], v17 offset:2048
    v_mfma_f32_16x16x32_bf16 a[36:39], a[128:131], v[212:215], a[36:39]
    ds_read_b64_tr_b16 a[110:111], v17 offset:2304
    ds_read_b64_tr_b16 a[112:113], v16 offset:4096
    ds_read_b64_tr_b16 a[114:115], v16 offset:4352
    v_mfma_f32_16x16x32_bf16 a[40:43], a[128:131], v[228:231], a[40:43]
    ds_read_b64_tr_b16 a[116:117], v17 offset:4096
    ds_read_b64_tr_b16 a[118:119], v17 offset:4352
    v_mfma_f32_16x16x32_bf16 a[44:47], a[128:131], v[244:247], a[44:47]
    s_waitcnt vmcnt(32)
    s_mov_b64 vcc, s[68:69]
    v_cndmask_b32_dpp v48, v84, v80, vcc quad_perm:[1,0,3,2] row_mask:0xf bank_mask:0xf
    v_mfma_f32_16x16x32_bf16 a[48:51], a[132:135], v[196:199], a[48:51]
    v_cndmask_b32_dpp v49, v85, v81, vcc quad_perm:[1,0,3,2] row_mask:0xf bank_mask:0xf
    v_cndmask_b32_dpp v50, v86, v82, vcc quad_perm:[1,0,3,2] row_mask:0xf bank_mask:0xf
    v_cndmask_b32_dpp v51, v87, v83, vcc quad_perm:[1,0,3,2] row_mask:0xf bank_mask:0xf
    v_mfma_f32_16x16x32_bf16 a[52:55], a[132:135], v[212:215], a[52:55]
    v_cndmask_b32_dpp v56, v92, v88, vcc quad_perm:[1,0,3,2] row_mask:0xf bank_mask:0xf
    v_cndmask_b32_dpp v57, v93, v89, vcc quad_perm:[1,0,3,2] row_mask:0xf bank_mask:0xf
    v_cndmask_b32_dpp v58, v94, v90, vcc quad_perm:[1,0,3,2] row_mask:0xf bank_mask:0xf
    v_mfma_f32_16x16x32_bf16 a[56:59], a[132:135], v[228:231], a[56:59]
    v_cndmask_b32_dpp v59, v95, v91, vcc quad_perm:[1,0,3,2] row_mask:0xf bank_mask:0xf
    s_mov_b64 vcc, s[70:71]
    v_cndmask_b32_dpp v52, v80, v84, vcc quad_perm:[1,0,3,2] row_mask:0xf bank_mask:0xf
    v_mfma_f32_16x16x32_bf16 a[60:63], a[132:135], v[244:247], a[60:63]
    v_cndmask_b32_dpp v53, v81, v85, vcc quad_perm:[1,0,3,2] row_mask:0xf bank_mask:0xf
    v_cndmask_b32_dpp v54, v82, v86, vcc quad_perm:[1,0,3,2] row_mask:0xf bank_mask:0xf
    v_mfma_f32_16x16x32_bf16 a[64:67], a[136:139], v[196:199], a[64:67]
    v_cndmask_b32_dpp v55, v83, v87, vcc quad_perm:[1,0,3,2] row_mask:0xf bank_mask:0xf
    v_cndmask_b32_dpp v60, v88, v92, vcc quad_perm:[1,0,3,2] row_mask:0xf bank_mask:0xf
    v_cndmask_b32_dpp v61, v89, v93, vcc quad_perm:[1,0,3,2] row_mask:0xf bank_mask:0xf
    v_mfma_f32_16x16x32_bf16 a[68:71], a[136:139], v[212:215], a[68:71]
    v_cndmask_b32_dpp v62, v90, v94, vcc quad_perm:[1,0,3,2] row_mask:0xf bank_mask:0xf
    v_cndmask_b32_dpp v63, v91, v95, vcc quad_perm:[1,0,3,2] row_mask:0xf bank_mask:0xf
    s_mov_b64 vcc, s[72:73]
    v_mfma_f32_16x16x32_bf16 a[72:75], a[136:139], v[228:231], a[72:75]
    v_cndmask_b32_dpp v80, v56, v48, vcc quad_perm:[2,3,0,1] row_mask:0xf bank_mask:0xf
    v_cndmask_b32_dpp v81, v57, v49, vcc quad_perm:[2,3,0,1] row_mask:0xf bank_mask:0xf
    v_cndmask_b32_dpp v82, v58, v50, vcc quad_perm:[2,3,0,1] row_mask:0xf bank_mask:0xf
    v_mfma_f32_16x16x32_bf16 a[76:79], a[136:139], v[244:247], a[76:79]
    v_cndmask_b32_dpp v83, v59, v51, vcc quad_perm:[2,3,0,1] row_mask:0xf bank_mask:0xf
    v_cndmask_b32_dpp v84, v60, v52, vcc quad_perm:[2,3,0,1] row_mask:0xf bank_mask:0xf
    v_mfma_f32_16x16x32_bf16 a[80:83], a[140:143], v[196:199], a[80:83]
    v_cndmask_b32_dpp v85, v61, v53, vcc quad_perm:[2,3,0,1] row_mask:0xf bank_mask:0xf
    v_cndmask_b32_dpp v86, v62, v54, vcc quad_perm:[2,3,0,1] row_mask:0xf bank_mask:0xf
    v_cndmask_b32_dpp v87, v63, v55, vcc quad_perm:[2,3,0,1] row_mask:0xf bank_mask:0xf
    v_mfma_f32_16x16x32_bf16 a[84:87], a[140:143], v[212:215], a[84:87]
    s_mov_b64 vcc, s[74:75]
    v_cndmask_b32_dpp v88, v48, v56, vcc quad_perm:[2,3,0,1] row_mask:0xf bank_mask:0xf
    v_cndmask_b32_dpp v89, v49, v57, vcc quad_perm:[2,3,0,1] row_mask:0xf bank_mask:0xf
    v_mfma_f32_16x16x32_bf16 a[88:91], a[140:143], v[228:231], a[88:91]
    v_cndmask_b32_dpp v90, v50, v58, vcc quad_perm:[2,3,0,1] row_mask:0xf bank_mask:0xf
    v_cndmask_b32_dpp v91, v51, v59, vcc quad_perm:[2,3,0,1] row_mask:0xf bank_mask:0xf
    v_cndmask_b32_dpp v92, v52, v60, vcc quad_perm:[2,3,0,1] row_mask:0xf bank_mask:0xf
    v_mfma_f32_16x16x32_bf16 a[92:95], a[140:143], v[244:247], a[92:95]
    v_cndmask_b32_dpp v93, v53, v61, vcc quad_perm:[2,3,0,1] row_mask:0xf bank_mask:0xf
    v_cndmask_b32_dpp v94, v54, v62, vcc quad_perm:[2,3,0,1] row_mask:0xf bank_mask:0xf
    v_cndmask_b32_dpp v95, v55, v63, vcc quad_perm:[2,3,0,1] row_mask:0xf bank_mask:0xf
    s_nop 1
    s_waitcnt lgkmcnt(0)
    v_mfma_f32_16x16x32_bf16 a[0:3], a[96:99], v[200:203], a[0:3]
    s_add_u32 m0, s9, 24576
    s_add_u32 s8, s76, 28672
    buffer_load_dwordx4 v14, s[44:47], s8 offen lds
    v_mfma_f32_16x16x32_bf16 a[4:7], a[96:99], v[216:219], a[4:7]
    buffer_load_dwordx4 v14, s[44:47], s8 offen offset:1024 lds
    v_mfma_f32_16x16x32_bf16 a[8:11], a[96:99], v[232:235], a[8:11]
    s_add_u32 m0, s9, 26624
    s_add_u32 s8, s77, 28672
    buffer_load_dwordx4 v14, s[44:47], s8 offen lds
    v_mfma_f32_16x16x32_bf16 a[12:15], a[96:99], v[248:251], a[12:15]
    buffer_load_dwordx4 v14, s[44:47], s8 offen offset:1024 lds
    v_mfma_f32_16x16x32_bf16 a[16:19], a[100:103], v[200:203], a[16:19]
    s_add_u32 m0, s9, 28672
    s_add_u32 s8, s78, 28672
    buffer_load_dwordx4 v14, s[44:47], s8 offen lds
    v_mfma_f32_16x16x32_bf16 a[20:23], a[100:103], v[216:219], a[20:23]
    buffer_load_dwordx4 v14, s[44:47], s8 offen offset:1024 lds
    v_mfma_f32_16x16x32_bf16 a[24:27], a[100:103], v[232:235], a[24:27]
    s_waitcnt vmcnt(22)
    ds_read_b64_tr_b16 a[120:121], v16 offset:6144
    v_mfma_f32_16x16x32_bf16 a[28:31], a[100:103], v[248:251], a[28:31]
    ds_read_b64_tr_b16 a[122:123], v16 offset:6400
    ds_read_b64_tr_b16 a[124:125], v17 offset:6144
    ds_read_b64_tr_b16 a[126:127], v17 offset:6400
    v_mfma_f32_16x16x32_bf16 a[32:35], a[104:107], v[200:203], a[32:35]
    ds_read_b64_tr_b16 a[128:129], v16 offset:8192
    ds_read_b64_tr_b16 a[130:131], v16 offset:8448
    ds_read_b64_tr_b16 a[132:133], v17 offset:8192
    v_mfma_f32_16x16x32_bf16 a[36:39], a[104:107], v[216:219], a[36:39]
    ds_read_b64_tr_b16 a[134:135], v17 offset:8448
    ds_read_b64_tr_b16 a[136:137], v16 offset:10240
    ds_read_b64_tr_b16 a[138:139], v16 offset:10496
    v_mfma_f32_16x16x32_bf16 a[40:43], a[104:107], v[232:235], a[40:43]
    ds_read_b64_tr_b16 a[140:141], v17 offset:10240
    ds_read_b64_tr_b16 a[142:143], v17 offset:10496
    v_mfma_f32_16x16x32_bf16 a[44:47], a[104:107], v[248:251], a[44:47]
    s_waitcnt vmcnt(28)
    s_mov_b64 vcc, s[68:69]
    v_cndmask_b32_dpp v32, v100, v96, vcc quad_perm:[1,0,3,2] row_mask:0xf bank_mask:0xf
    v_mfma_f32_16x16x32_bf16 a[48:51], a[108:111], v[200:203], a[48:51]
    v_cndmask_b32_dpp v33, v101, v97, vcc quad_perm:[1,0,3,2] row_mask:0xf bank_mask:0xf
    v_cndmask_b32_dpp v34, v102, v98, vcc quad_perm:[1,0,3,2] row_mask:0xf bank_mask:0xf
    v_cndmask_b32_dpp v35, v103, v99, vcc quad_perm:[1,0,3,2] row_mask:0xf bank_mask:0xf
    v_mfma_f32_16x16x32_bf16 a[52:55], a[108:111], v[216:219], a[52:55]
    v_cndmask_b32_dpp v40, v108, v104, vcc quad_perm:[1,0,3,2] row_mask:0xf bank_mask:0xf
    v_cndmask_b32_dpp v41, v109, v105, vcc quad_perm:[1,0,3,2] row_mask:0xf bank_mask:0xf
    v_cndmask_b32_dpp v42, v110, v106, vcc quad_perm:[1,0,3,2] row_mask:0xf bank_mask:0xf
    v_mfma_f32_16x16x32_bf16 a[56:59], a[108:111], v[232:235], a[56:59]
    v_cndmask_b32_dpp v43, v111, v107, vcc quad_perm:[1,0,3,2] row_mask:0xf bank_mask:0xf
    s_mov_b64 vcc, s[70:71]
    v_cndmask_b32_dpp v36, v96, v100, vcc quad_perm:[1,0,3,2] row_mask:0xf bank_mask:0xf
    v_mfma_f32_16x16x32_bf16 a[60:63], a[108:111], v[248:251], a[60:63]
    v_cndmask_b32_dpp v37, v97, v101, vcc quad_perm:[1,0,3,2] row_mask:0xf bank_mask:0xf
    v_cndmask_b32_dpp v38, v98, v102, vcc quad_perm:[1,0,3,2] row_mask:0xf bank_mask:0xf
    v_mfma_f32_16x16x32_bf16 a[64:67], a[112:115], v[200:203], a[64:67]
    v_cndmask_b32_dpp v39, v99, v103, vcc quad_perm:[1,0,3,2] row_mask:0xf bank_mask:0xf
    v_cndmask_b32_dpp v44, v104, v108, vcc quad_perm:[1,0,3,2] row_mask:0xf bank_mask:0xf
    v_cndmask_b32_dpp v45, v105, v109, vcc quad_perm:[1,0,3,2] row_mask:0xf bank_mask:0xf
    v_mfma_f32_16x16x32_bf16 a[68:71], a[112:115], v[216:219], a[68:71]
    v_cndmask_b32_dpp v46, v106, v110, vcc quad_perm:[1,0,3,2] row_mask:0xf bank_mask:0xf
    v_cndmask_b32_dpp v47, v107, v111, vcc quad_perm:[1,0,3,2] row_mask:0xf bank_mask:0xf
    s_mov_b64 vcc, s[72:73]
    v_mfma_f32_16x16x32_bf16 a[72:75], a[112:115], v[232:235], a[72:75]
    v_cndmask_b32_dpp v96, v40, v32, vcc quad_perm:[2,3,0,1] row_mask:0xf bank_mask:0xf
    v_cndmask_b32_dpp v97, v41, v33, vcc quad_perm:[2,3,0,1] row_mask:0xf bank_mask:0xf
    v_cndmask_b32_dpp v98, v42, v34, vcc quad_perm:[2,3,0,1] row_mask:0xf bank_mask:0xf
    v_mfma_f32_16x16x32_bf16 a[76:79], a[112:115], v[248:251], a[76:79]
    v_cndmask_b32_dpp v99, v43, v35, vcc quad_perm:[2,3,0,1] row_mask:0xf bank_mask:0xf
    v_cndmask_b32_dpp v100, v44, v36, vcc quad_perm:[2,3,0,1] row_mask:0xf bank_mask:0xf
    v_mfma_f32_16x16x32_bf16 a[80:83], a[116:119], v[200:203], a[80:83]
    v_cndmask_b32_dpp v101, v45, v37, vcc quad_perm:[2,3,0,1] row_mask:0xf bank_mask:0xf
    v_cndmask_b32_dpp v102, v46, v38, vcc quad_perm:[2,3,0,1] row_mask:0xf bank_mask:0xf
    v_cndmask_b32_dpp v103, v47, v39, vcc quad_perm:[2,3,0,1] row_mask:0xf bank_mask:0xf
    v_mfma_f32_16x16x32_bf16 a[84:87], a[116:119], v[216:219], a[84:87]
    s_mov_b64 vcc, s[74:75]
    v_cndmask_b32_dpp v104, v32, v40, vcc quad_perm:[2,3,0,1] row_mask:0xf bank_mask:0xf
    v_cndmask_b32_dpp v105, v33, v41, vcc quad_perm:[2,3,0,1] row_mask:0xf bank_mask:0xf
    v_mfma_f32_16x16x32_bf16 a[88:91], a[116:119], v[232:235], a[88:91]
    v_cndmask_b32_dpp v106, v34, v42, vcc quad_perm:[2,3,0,1] row_mask:0xf bank_mask:0xf
    v_cndmask_b32_dpp v107, v35, v43, vcc quad_perm:[2,3,0,1] row_mask:0xf bank_mask:0xf
    v_cndmask_b32_dpp v108, v36, v44, vcc quad_perm:[2,3,0,1] row_mask:0xf bank_mask:0xf
    v_mfma_f32_16x16x32_bf16 a[92:95], a[116:119], v[248:251], a[92:95]
    v_cndmask_b32_dpp v109, v37, v45, vcc quad_perm:[2,3,0,1] row_mask:0xf bank_mask:0xf
    v_cndmask_b32_dpp v110, v38, v46, vcc quad_perm:[2,3,0,1] row_mask:0xf bank_mask:0xf
    v_cndmask_b32_dpp v111, v39, v47, vcc quad_perm:[2,3,0,1] row_mask:0xf bank_mask:0xf
    s_nop 1
    s_waitcnt lgkmcnt(0)
    v_mfma_f32_16x16x32_bf16 a[0:3], a[120:123], v[204:207], a[0:3]
    s_add_u32 m0, s9, 0
    s_add_u32 s8, s76, 30720
    buffer_load_dwordx4 v14, s[44:47], s8 offen lds
    v_mfma_f32_16x16x32_bf16 a[4:7], a[120:123], v[220:223], a[4:7]
    buffer_load_dwordx4 v14, s[44:47], s8 offen offset:1024 lds
    v_mfma_f32_16x16x32_bf16 a[8:11], a[120:123], v[236:239], a[8:11]
    s_add_u32 m0, s9, 2048
    s_add_u32 s8, s77, 30720
    buffer_load_dwordx4 v14, s[44:47], s8 offen lds
    v_mfma_f32_16x16x32_bf16 a[12:15], a[120:123], v[252:255], a[12:15]
    buffer_load_dwordx4 v14, s[44:47], s8 offen offset:1024 lds
    v_mfma_f32_16x16x32_bf16 a[16:19], a[124:127], v[204:207], a[16:19]
    s_add_u32 m0, s9, 4096
    s_add_u32 s8, s78, 30720
    buffer_load_dwordx4 v14, s[44:47], s8 offen lds
    v_mfma_f32_16x16x32_bf16 a[20:23], a[124:127], v[220:223], a[20:23]
    buffer_load_dwordx4 v14, s[44:47], s8 offen offset:1024 lds
    v_mfma_f32_16x16x32_bf16 a[24:27], a[124:127], v[236:239], a[24:27]
    s_waitcnt vmcnt(18)
    ds_read_b64_tr_b16 a[96:97], v16 offset:12288
    v_mfma_f32_16x16x32_bf16 a[28:31], a[124:127], v[252:255], a[28:31]
    ds_read_b64_tr_b16 a[98:99], v16 offset:12544
    ds_read_b64_tr_b16 a[100:101], v17 offset:12288
    ds_read_b64_tr_b16 a[102:103], v17 offset:12544
    v_mfma_f32_16x16x32_bf16 a[32:35], a[128:131], v[204:207], a[32:35]
    ds_read_b64_tr_b16 a[104:105], v16 offset:14336
    ds_read_b64_tr_b16 a[106:107], v16 offset:14592
    ds_read_b64_tr_b16 a[108:109], v17 offset:14336
    v_mfma_f32_16x16x32_bf16 a[36:39], a[128:131], v[220:223], a[36:39]
    ds_read_b64_tr_b16 a[110:111], v17 offset:14592
    ds_read_b64_tr_b16 a[112:113], v16 offset:16384
    ds_read_b64_tr_b16 a[114:115], v16 offset:16640
    v_mfma_f32_16x16x32_bf16 a[40:43], a[128:131], v[236:239], a[40:43]
    ds_read_b64_tr_b16 a[116:117], v17 offset:16384
    ds_read_b64_tr_b16 a[118:119], v17 offset:16640
    v_mfma_f32_16x16x32_bf16 a[44:47], a[128:131], v[252:255], a[44:47]
    s_waitcnt vmcnt(24)
    s_mov_b64 vcc, s[68:69]
    v_cndmask_b32_dpp v48, v116, v112, vcc quad_perm:[1,0,3,2] row_mask:0xf bank_mask:0xf
    v_mfma_f32_16x16x32_bf16 a[48:51], a[132:135], v[204:207], a[48:51]
    v_cndmask_b32_dpp v49, v117, v113, vcc quad_perm:[1,0,3,2] row_mask:0xf bank_mask:0xf
    v_cndmask_b32_dpp v50, v118, v114, vcc quad_perm:[1,0,3,2] row_mask:0xf bank_mask:0xf
    v_cndmask_b32_dpp v51, v119, v115, vcc quad_perm:[1,0,3,2] row_mask:0xf bank_mask:0xf
    v_mfma_f32_16x16x32_bf16 a[52:55], a[132:135], v[220:223], a[52:55]
    v_cndmask_b32_dpp v56, v124, v120, vcc quad_perm:[1,0,3,2] row_mask:0xf bank_mask:0xf
    v_cndmask_b32_dpp v57, v125, v121, vcc quad_perm:[1,0,3,2] row_mask:0xf bank_mask:0xf
    v_cndmask_b32_dpp v58, v126, v122, vcc quad_perm:[1,0,3,2] row_mask:0xf bank_mask:0xf
    v_mfma_f32_16x16x32_bf16 a[56:59], a[132:135], v[236:239], a[56:59]
    v_cndmask_b32_dpp v59, v127, v123, vcc quad_perm:[1,0,3,2] row_mask:0xf bank_mask:0xf
    s_mov_b64 vcc, s[70:71]
    v_cndmask_b32_dpp v52, v112, v116, vcc quad_perm:[1,0,3,2] row_mask:0xf bank_mask:0xf
    v_mfma_f32_16x16x32_bf16 a[60:63], a[132:135], v[252:255], a[60:63]
    v_cndmask_b32_dpp v53, v113, v117, vcc quad_perm:[1,0,3,2] row_mask:0xf bank_mask:0xf
    v_cndmask_b32_dpp v54, v114, v118, vcc quad_perm:[1,0,3,2] row_mask:0xf bank_mask:0xf
    v_mfma_f32_16x16x32_bf16 a[64:67], a[136:139], v[204:207], a[64:67]
    v_cndmask_b32_dpp v55, v115, v119, vcc quad_perm:[1,0,3,2] row_mask:0xf bank_mask:0xf
    v_cndmask_b32_dpp v60, v120, v124, vcc quad_perm:[1,0,3,2] row_mask:0xf bank_mask:0xf
    v_cndmask_b32_dpp v61, v121, v125, vcc quad_perm:[1,0,3,2] row_mask:0xf bank_mask:0xf
    v_mfma_f32_16x16x32_bf16 a[68:71], a[136:139], v[220:223], a[68:71]
    v_cndmask_b32_dpp v62, v122, v126, vcc quad_perm:[1,0,3,2] row_mask:0xf bank_mask:0xf
    v_cndmask_b32_dpp v63, v123, v127, vcc quad_perm:[1,0,3,2] row_mask:0xf bank_mask:0xf
    s_mov_b64 vcc, s[72:73]
    v_mfma_f32_16x16x32_bf16 a[72:75], a[136:139], v[236:239], a[72:75]
    v_cndmask_b32_dpp v112, v56, v48, vcc quad_perm:[2,3,0,1] row_mask:0xf bank_mask:0xf
    v_cndmask_b32_dpp v113, v57, v49, vcc quad_perm:[2,3,0,1] row_mask:0xf bank_mask:0xf
    v_cndmask_b32_dpp v114, v58, v50, vcc quad_perm:[2,3,0,1] row_mask:0xf bank_mask:0xf
    v_mfma_f32_16x16x32_bf16 a[76:79], a[136:139], v[252:255], a[76:79]
    v_cndmask_b32_dpp v115, v59, v51, vcc quad_perm:[2,3,0,1] row_mask:0xf bank_mask:0xf
    v_cndmask_b32_dpp v116, v60, v52, vcc quad_perm:[2,3,0,1] row_mask:0xf bank_mask:0xf
    v_mfma_f32_16x16x32_bf16 a[80:83], a[140:143], v[204:207], a[80:83]
    v_cndmask_b32_dpp v117, v61, v53, vcc quad_perm:[2,3,0,1] row_mask:0xf bank_mask:0xf
    v_cndmask_b32_dpp v118, v62, v54, vcc quad_perm:[2,3,0,1] row_mask:0xf bank_mask:0xf
    v_cndmask_b32_dpp v119, v63, v55, vcc quad_perm:[2,3,0,1] row_mask:0xf bank_mask:0xf
    v_mfma_f32_16x16x32_bf16 a[84:87], a[140:143], v[220:223], a[84:87]
    s_mov_b64 vcc, s[74:75]
    v_cndmask_b32_dpp v120, v48, v56, vcc quad_perm:[2,3,0,1] row_mask:0xf bank_mask:0xf
    v_cndmask_b32_dpp v121, v49, v57, vcc quad_perm:[2,3,0,1] row_mask:0xf bank_mask:0xf
    v_mfma_f32_16x16x32_bf16 a[88:91], a[140:143], v[236:239], a[88:91]
    v_cndmask_b32_dpp v122, v50, v58, vcc quad_perm:[2,3,0,1] row_mask:0xf bank_mask:0xf
    v_cndmask_b32_dpp v123, v51, v59, vcc quad_perm:[2,3,0,1] row_mask:0xf bank_mask:0xf
    v_cndmask_b32_dpp v124, v52, v60, vcc quad_perm:[2,3,0,1] row_mask:0xf bank_mask:0xf
    v_mfma_f32_16x16x32_bf16 a[92:95], a[140:143], v[252:255], a[92:95]
    v_cndmask_b32_dpp v125, v53, v61, vcc quad_perm:[2,3,0,1] row_mask:0xf bank_mask:0xf
    v_cndmask_b32_dpp v126, v54, v62, vcc quad_perm:[2,3,0,1] row_mask:0xf bank_mask:0xf
    v_cndmask_b32_dpp v127, v55, v63, vcc quad_perm:[2,3,0,1] row_mask:0xf bank_mask:0xf
    s_nop 1
    s_waitcnt lgkmcnt(0)
    v_mfma_f32_16x16x32_bf16 a[0:3], a[96:99], v[64:67], a[0:3]
    buffer_load_ushort v13, v15, s[56:59], 0 offen
    v_mfma_f32_16x16x32_bf16 a[4:7], a[96:99], v[80:83], a[4:7]
    buffer_load_dwordx2 v[20:21], v18, s[48:51], 0 offen offset:0
    v_mfma_f32_16x16x32_bf16 a[8:11], a[96:99], v[96:99], a[8:11]
    buffer_load_dwordx2 v[22:23], v18, s[48:51], 0 offen offset:512
    v_mfma_f32_16x16x32_bf16 a[12:15], a[96:99], v[112:115], a[12:15]
    buffer_load_dwordx2 v[24:25], v18, s[48:51], 0 offen offset:1024
    v_mfma_f32_16x16x32_bf16 a[16:19], a[100:103], v[64:67], a[16:19]
    buffer_load_dwordx2 v[26:27], v18, s[48:51], 0 offen offset:1536
    v_mfma_f32_16x16x32_bf16 a[20:23], a[100:103], v[80:83], a[20:23]
    buffer_load_dwordx2 v[28:29], v18, s[48:51], 0 offen offset:2048
    buffer_load_dwordx2 v[30:31], v18, s[48:51], 0 offen offset:2560
    v_mfma_f32_16x16x32_bf16 a[24:27], a[100:103], v[96:99], a[24:27]
    v_mfma_f32_16x16x32_bf16 a[28:31], a[100:103], v[112:115], a[28:31]
    s_waitcnt vmcnt(19)
    v_mfma_f32_16x16x32_bf16 a[32:35], a[104:107], v[64:67], a[32:35]
    ds_read_b64_tr_b16 a[120:121], v16 offset:18432
    v_mfma_f32_16x16x32_bf16 a[36:39], a[104:107], v[80:83], a[36:39]
    v_mfma_f32_16x16x32_bf16 a[40:43], a[104:107], v[96:99], a[40:43]
    ds_read_b64_tr_b16 a[122:123], v16 offset:18688
    v_mfma_f32_16x16x32_bf16 a[44:47], a[104:107], v[112:115], a[44:47]
    ds_read_b64_tr_b16 a[124:125], v17 offset:18432
    v_mfma_f32_16x16x32_bf16 a[48:51], a[108:111], v[64:67], a[48:51]
    ds_read_b64_tr_b16 a[126:127], v17 offset:18688
    v_mfma_f32_16x16x32_bf16 a[52:55], a[108:111], v[80:83], a[52:55]
    v_mfma_f32_16x16x32_bf16 a[56:59], a[108:111], v[96:99], a[56:59]
    ds_read_b64_tr_b16 a[128:129], v16 offset:20480
    v_mfma_f32_16x16x32_bf16 a[60:63], a[108:111], v[112:115], a[60:63]
    ds_read_b64_tr_b16 a[130:131], v16 offset:20736
    v_mfma_f32_16x16x32_bf16 a[64:67], a[112:115], v[64:67], a[64:67]
    v_mfma_f32_16x16x32_bf16 a[68:71], a[112:115], v[80:83], a[68:71]
    ds_read_b64_tr_b16 a[132:133], v17 offset:20480
    v_mfma_f32_16x16x32_bf16 a[72:75], a[112:115], v[96:99], a[72:75]
    ds_read_b64_tr_b16 a[134:135], v17 offset:20736
    v_mfma_f32_16x16x32_bf16 a[76:79], a[112:115], v[112:115], a[76:79]
    ds_read_b64_tr_b16 a[136:137], v16 offset:22528
    v_mfma_f32_16x16x32_bf16 a[80:83], a[116:119], v[64:67], a[80:83]
    v_mfma_f32_16x16x32_bf16 a[84:87], a[116:119], v[80:83], a[84:87]
    ds_read_b64_tr_b16 a[138:139], v16 offset:22784
    v_mfma_f32_16x16x32_bf16 a[88:91], a[116:119], v[96:99], a[88:91]
    ds_read_b64_tr_b16 a[140:141], v17 offset:22528
    v_mfma_f32_16x16x32_bf16 a[92:95], a[116:119], v[112:115], a[92:95]
    ds_read_b64_tr_b16 a[142:143], v17 offset:22784
    s_nop 1
    s_waitcnt lgkmcnt(0)
    v_mfma_f32_16x16x32_bf16 a[0:3], a[120:123], v[68:71], a[0:3]
    v_mfma_f32_16x16x32_bf16 a[4:7], a[120:123], v[84:87], a[4:7]
    v_mfma_f32_16x16x32_bf16 a[8:11], a[120:123], v[100:103], a[8:11]
    v_mfma_f32_16x16x32_bf16 a[12:15], a[120:123], v[116:119], a[12:15]
    v_mfma_f32_16x16x32_bf16 a[16:19], a[124:127], v[68:71], a[16:19]
    v_mfma_f32_16x16x32_bf16 a[20:23], a[124:127], v[84:87], a[20:23]
    v_mfma_f32_16x16x32_bf16 a[24:27], a[124:127], v[100:103], a[24:27]
    v_mfma_f32_16x16x32_bf16 a[28:31], a[124:127], v[116:119], a[28:31]
    s_waitcnt vmcnt(13)
    v_mfma_f32_16x16x32_bf16 a[32:35], a[128:131], v[68:71], a[32:35]
    ds_read_b64_tr_b16 a[96:97], v16 offset:24576
    v_mfma_f32_16x16x32_bf16 a[36:39], a[128:131], v[84:87], a[36:39]
    v_mfma_f32_16x16x32_bf16 a[40:43], a[128:131], v[100:103], a[40:43]
    ds_read_b64_tr_b16 a[98:99], v16 offset:24832
    v_mfma_f32_16x16x32_bf16 a[44:47], a[128:131], v[116:119], a[44:47]
    ds_read_b64_tr_b16 a[100:101], v17 offset:24576
    v_mfma_f32_16x16x32_bf16 a[48:51], a[132:135], v[68:71], a[48:51]
    ds_read_b64_tr_b16 a[102:103], v17 offset:24832
    v_mfma_f32_16x16x32_bf16 a[52:55], a[132:135], v[84:87], a[52:55]
    v_mfma_f32_16x16x32_bf16 a[56:59], a[132:135], v[100:103], a[56:59]
    ds_read_b64_tr_b16 a[104:105], v16 offset:26624
    v_mfma_f32_16x16x32_bf16 a[60:63], a[132:135], v[116:119], a[60:63]
    ds_read_b64_tr_b16 a[106:107], v16 offset:26880
    v_mfma_f32_16x16x32_bf16 a[64:67], a[136:139], v[68:71], a[64:67]
    v_mfma_f32_16x16x32_bf16 a[68:71], a[136:139], v[84:87], a[68:71]
    ds_read_b64_tr_b16 a[108:109], v17 offset:26624
    v_mfma_f32_16x16x32_bf16 a[72:75], a[136:139], v[100:103], a[72:75]
    ds_read_b64_tr_b16 a[110:111], v17 offset:26880
    v_mfma_f32_16x16x32_bf16 a[76:79], a[136:139], v[116:119], a[76:79]
    ds_read_b64_tr_b16 a[112:113], v16 offset:28672
    v_mfma_f32_16x16x32_bf16 a[80:83], a[140:143], v[68:71], a[80:83]
    v_mfma_f32_16x16x32_bf16 a[84:87], a[140:143], v[84:87], a[84:87]
    ds_read_b64_tr_b16 a[114:115], v16 offset:28928
    v_mfma_f32_16x16x32_bf16 a[88:91], a[140:143], v[100:103], a[88:91]
    ds_read_b64_tr_b16 a[116:117], v17 offset:28672
    v_mfma_f32_16x16x32_bf16 a[92:95], a[140:143], v[116:119], a[92:95]
    ds_read_b64_tr_b16 a[118:119], v17 offset:28928
    s_nop 1
    s_waitcnt lgkmcnt(0)
    v_mfma_f32_16x16x32_bf16 a[0:3], a[96:99], v[72:75], a[0:3]
    v_mfma_f32_16x16x32_bf16 a[4:7], a[96:99], v[88:91], a[4:7]
    v_mfma_f32_16x16x32_bf16 a[8:11], a[96:99], v[104:107], a[8:11]
    v_mfma_f32_16x16x32_bf16 a[12:15], a[96:99], v[120:123], a[12:15]
    v_mfma_f32_16x16x32_bf16 a[16:19], a[100:103], v[72:75], a[16:19]
    v_mfma_f32_16x16x32_bf16 a[20:23], a[100:103], v[88:91], a[20:23]
    v_mfma_f32_16x16x32_bf16 a[24:27], a[100:103], v[104:107], a[24:27]
    v_mfma_f32_16x16x32_bf16 a[28:31], a[100:103], v[120:123], a[28:31]
    s_waitcnt vmcnt(7)
    v_mfma_f32_16x16x32_bf16 a[32:35], a[104:107], v[72:75], a[32:35]
    ds_read_b64_tr_b16 a[120:121], v16 offset:0
    v_mfma_f32_16x16x32_bf16 a[36:39], a[104:107], v[88:91], a[36:39]
    v_mfma_f32_16x16x32_bf16 a[40:43], a[104:107], v[104:107], a[40:43]
    ds_read_b64_tr_b16 a[122:123], v16 offset:256
    v_mfma_f32_16x16x32_bf16 a[44:47], a[104:107], v[120:123], a[44:47]
    ds_read_b64_tr_b16 a[124:125], v17 offset:0
    v_mfma_f32_16x16x32_bf16 a[48:51], a[108:111], v[72:75], a[48:51]
    ds_read_b64_tr_b16 a[126:127], v17 offset:256
    v_mfma_f32_16x16x32_bf16 a[52:55], a[108:111], v[88:91], a[52:55]
    v_mfma_f32_16x16x32_bf16 a[56:59], a[108:111], v[104:107], a[56:59]
    ds_read_b64_tr_b16 a[128:129], v16 offset:2048
    v_mfma_f32_16x16x32_bf16 a[60:63], a[108:111], v[120:123], a[60:63]
    ds_read_b64_tr_b16 a[130:131], v16 offset:2304
    v_mfma_f32_16x16x32_bf16 a[64:67], a[112:115], v[72:75], a[64:67]
    v_mfma_f32_16x16x32_bf16 a[68:71], a[112:115], v[88:91], a[68:71]
    ds_read_b64_tr_b16 a[132:133], v17 offset:2048
    v_mfma_f32_16x16x32_bf16 a[72:75], a[112:115], v[104:107], a[72:75]
    ds_read_b64_tr_b16 a[134:135], v17 offset:2304
    v_mfma_f32_16x16x32_bf16 a[76:79], a[112:115], v[120:123], a[76:79]
    ds_read_b64_tr_b16 a[136:137], v16 offset:4096
    v_mfma_f32_16x16x32_bf16 a[80:83], a[116:119], v[72:75], a[80:83]
    v_mfma_f32_16x16x32_bf16 a[84:87], a[116:119], v[88:91], a[84:87]
    ds_read_b64_tr_b16 a[138:139], v16 offset:4352
    v_mfma_f32_16x16x32_bf16 a[88:91], a[116:119], v[104:107], a[88:91]
    ds_read_b64_tr_b16 a[140:141], v17 offset:4096
    v_mfma_f32_16x16x32_bf16 a[92:95], a[116:119], v[120:123], a[92:95]
    ds_read_b64_tr_b16 a[142:143], v17 offset:4352
    s_nop 1
    s_waitcnt lgkmcnt(0)
    v_mfma_f32_16x16x32_bf16 a[0:3], a[120:123], v[76:79], a[0:3]
    v_mfma_f32_16x16x32_bf16 a[4:7], a[120:123], v[92:95], a[4:7]
    v_mfma_f32_16x16x32_bf16 a[8:11], a[120:123], v[108:111], a[8:11]
    v_mfma_f32_16x16x32_bf16 a[12:15], a[120:123], v[124:127], a[12:15]
    v_mfma_f32_16x16x32_bf16 a[16:19], a[124:127], v[76:79], a[16:19]
    v_mfma_f32_16x16x32_bf16 a[20:23], a[124:127], v[92:95], a[20:23]
    v_mfma_f32_16x16x32_bf16 a[24:27], a[124:127], v[108:111], a[24:27]
    v_mfma_f32_16x16x32_bf16 a[28:31], a[124:127], v[124:127], a[28:31]
    v_mfma_f32_16x16x32_bf16 a[32:35], a[128:131], v[76:79], a[32:35]
    v_mfma_f32_16x16x32_bf16 a[36:39], a[128:131], v[92:95], a[36:39]
    v_mfma_f32_16x16x32_bf16 a[40:43], a[128:131], v[108:111], a[40:43]
    v_mfma_f32_16x16x32_bf16 a[44:47], a[128:131], v[124:127], a[44:47]
    v_mfma_f32_16x16x32_bf16 a[48:51], a[132:135], v[76:79], a[48:51]
    v_mfma_f32_16x16x32_bf16 a[52:55], a[132:135], v[92:95], a[52:55]
    v_mfma_f32_16x16x32_bf16 a[56:59], a[132:135], v[108:111], a[56:59]
    v_mfma_f32_16x16x32_bf16 a[60:63], a[132:135], v[124:127], a[60:63]
    v_mfma_f32_16x16x32_bf16 a[64:67], a[136:139], v[76:79], a[64:67]
    v_mfma_f32_16x16x32_bf16 a[68:71], a[136:139], v[92:95], a[68:71]
    v_mfma_f32_16x16x32_bf16 a[72:75], a[136:139], v[108:111], a[72:75]
    v_mfma_f32_16x16x32_bf16 a[76:79], a[136:139], v[124:127], a[76:79]
    v_mfma_f32_16x16x32_bf16 a[80:83], a[140:143], v[76:79], a[80:83]
    v_mfma_f32_16x16x32_bf16 a[84:87], a[140:143], v[92:95], a[84:87]
    v_mfma_f32_16x16x32_bf16 a[88:91], a[140:143], v[108:111], a[88:91]
    v_mfma_f32_16x16x32_bf16 a[92:95], a[140:143], v[124:127], a[92:95]
    s_nop 1
    s_barrier
    s_mul_i32 s7, s3, 24576
    v_add_u32 v5, s7, v14
    s_mul_i32 s7, s3, 6144
    v_add_u32 v6, s7, v14
    v_add_u32 v7, 0xc000, v6
    s_nop 4
    ds_write_b128 v5, a[0:3] offset:0
    ds_write_b128 v5, a[4:7] offset:6144
    ds_write_b128 v5, a[8:11] offset:12288
    ds_write_b128 v5, a[12:15] offset:18432
    ds_write_b128 v5, a[16:19] offset:1024
    ds_write_b128 v5, a[20:23] offset:7168
    ds_write_b128 v5, a[24:27] offset:13312
    ds_write_b128 v5, a[28:31] offset:19456
    ds_write_b128 v5, a[32:35] offset:2048
    ds_write_b128 v5, a[36:39] offset:8192
    ds_write_b128 v5, a[40:43] offset:14336
    ds_write_b128 v5, a[44:47] offset:20480
    ds_write_b128 v5, a[48:51] offset:3072
    ds_write_b128 v5, a[52:55] offset:9216
    ds_write_b128 v5, a[56:59] offset:15360
    ds_write_b128 v5, a[60:63] offset:21504
    ds_write_b128 v5, a[64:67] offset:4096
    ds_write_b128 v5, a[68:71] offset:10240
    ds_write_b128 v5, a[72:75] offset:16384
    ds_write_b128 v5, a[76:79] offset:22528
    ds_write_b128 v5, a[80:83] offset:5120
    ds_write_b128 v5, a[84:87] offset:11264
    ds_write_b128 v5, a[88:91] offset:17408
    ds_write_b128 v5, a[92:95] offset:23552
    s_waitcnt lgkmcnt(0)
    s_barrier
    s_waitcnt vmcnt(0)
    ds_read_b128 v[64:67], v6 offset:0
    ds_read_b128 v[88:91], v6 offset:24576
    ds_read_b128 v[112:115], v7 offset:0
    ds_read_b128 v[136:139], v7 offset:24576
    v_lshlrev_b32 v12, 16, v13
    v_lshlrev_b32 v13, 16, v13
    v_lshlrev_b32 v32, 16, v20
    v_and_b32 v33, 0xffff0000, v20
    v_lshlrev_b32 v34, 16, v21
    v_and_b32 v35, 0xffff0000, v21
    ds_read_b128 v[68:71], v6 offset:1024
    ds_read_b128 v[92:95], v6 offset:25600
    ds_read_b128 v[116:119], v7 offset:1024
    ds_read_b128 v[140:143], v7 offset:25600
    v_lshlrev_b32 v36, 16, v22
    v_and_b32 v37, 0xffff0000, v22
    v_lshlrev_b32 v38, 16, v23
    v_and_b32 v39, 0xffff0000, v23
    ds_read_b128 v[72:75], v6 offset:2048
    ds_read_b128 v[96:99], v6 offset:26624
    ds_read_b128 v[120:123], v7 offset:2048
    ds_read_b128 v[144:147], v7 offset:26624
    v_lshlrev_b32 v40, 16, v24
    v_and_b32 v41, 0xffff0000, v24
    v_lshlrev_b32 v42, 16, v25
    v_and_b32 v43, 0xffff0000, v25
    ds_read_b128 v[76:79], v6 offset:3072
    ds_read_b128 v[100:103], v6 offset:27648
    ds_read_b128 v[124:127], v7 offset:3072
    ds_read_b128 v[148:151], v7 offset:27648
    v_lshlrev_b32 v44, 16, v26
    v_and_b32 v45, 0xffff0000, v26
    v_lshlrev_b32 v46, 16, v27
    v_and_b32 v47, 0xffff0000, v27
    ds_read_b128 v[80:83], v6 offset:4096
    ds_read_b128 v[104:107], v6 offset:28672
    ds_read_b128 v[128:131], v7 offset:4096
    ds_read_b128 v[152:155], v7 offset:28672
    v_lshlrev_b32 v48, 16, v28
    v_and_b32 v49, 0xffff0000, v28
    v_lshlrev_b32 v50, 16, v29
    v_and_b32 v51, 0xffff0000, v29
    ds_read_b128 v[84:87], v6 offset:5120
    ds_read_b128 v[108:111], v6 offset:29696
    ds_read_b128 v[132:135], v7 offset:5120
    ds_read_b128 v[156:159], v7 offset:29696
    v_lshlrev_b32 v52, 16, v30
    v_and_b32 v53, 0xffff0000, v30
    v_lshlrev_b32 v54, 16, v31
    v_and_b32 v55, 0xffff0000, v31
    s_waitcnt lgkmcnt(15)
    v_pk_add_f32 v[64:65], v[64:65], v[88:89]
    v_pk_add_f32 v[112:113], v[112:113], v[136:137]
    v_pk_add_f32 v[66:67], v[66:67], v[90:91]
    v_pk_add_f32 v[114:115], v[114:115], v[138:139]
    v_pk_add_f32 v[64:65], v[64:65], v[112:113]
    v_pk_add_f32 v[66:67], v[66:67], v[114:115]
    v_pk_add_f32 v[64:65], v[64:65], v[12:13]
    v_pk_add_f32 v[66:67], v[66:67], v[12:13]
    v_pk_mul_f32 v[64:65], v[64:65], v[32:33]
    v_pk_mul_f32 v[66:67], v[66:67], v[34:35]
    v_cvt_pk_bf16_f32 v64, v64, v65
    v_cvt_pk_bf16_f32 v65, v66, v67
    buffer_store_dwordx2 v[64:65], v18, s[52:55], 0 offen offset:0
    s_cmp_eq_u32 s5, 7
    s_cbranch_scc1 k3_kernel_fin
    s_waitcnt lgkmcnt(15)
    v_pk_add_f32 v[68:69], v[68:69], v[92:93]
    v_pk_add_f32 v[116:117], v[116:117], v[140:141]
    v_pk_add_f32 v[70:71], v[70:71], v[94:95]
    v_pk_add_f32 v[118:119], v[118:119], v[142:143]
    v_pk_add_f32 v[68:69], v[68:69], v[116:117]
    v_pk_add_f32 v[70:71], v[70:71], v[118:119]
    v_pk_add_f32 v[68:69], v[68:69], v[12:13]
    v_pk_add_f32 v[70:71], v[70:71], v[12:13]
    v_pk_mul_f32 v[68:69], v[68:69], v[36:37]
    v_pk_mul_f32 v[70:71], v[70:71], v[38:39]
    v_cvt_pk_bf16_f32 v68, v68, v69
    v_cvt_pk_bf16_f32 v69, v70, v71
    buffer_store_dwordx2 v[68:69], v18, s[52:55], 0 offen offset:512
    s_waitcnt lgkmcnt(12)
    v_pk_add_f32 v[72:73], v[72:73], v[96:97]
    v_pk_add_f32 v[120:121], v[120:121], v[144:145]
    v_pk_add_f32 v[74:75], v[74:75], v[98:99]
    v_pk_add_f32 v[122:123], v[122:123], v[146:147]
    v_pk_add_f32 v[72:73], v[72:73], v[120:121]
    v_pk_add_f32 v[74:75], v[74:75], v[122:123]
    v_pk_add_f32 v[72:73], v[72:73], v[12:13]
    v_pk_add_f32 v[74:75], v[74:75], v[12:13]
    v_pk_mul_f32 v[72:73], v[72:73], v[40:41]
    v_pk_mul_f32 v[74:75], v[74:75], v[42:43]
    v_cvt_pk_bf16_f32 v72, v72, v73
    v_cvt_pk_bf16_f32 v73, v74, v75
    buffer_store_dwordx2 v[72:73], v18, s[52:55], 0 offen offset:1024
    s_waitcnt lgkmcnt(8)
    v_pk_add_f32 v[76:77], v[76:77], v[100:101]
    v_pk_add_f32 v[124:125], v[124:125], v[148:149]
    v_pk_add_f32 v[78:79], v[78:79], v[102:103]
    v_pk_add_f32 v[126:127], v[126:127], v[150:151]
    v_pk_add_f32 v[76:77], v[76:77], v[124:125]
    v_pk_add_f32 v[78:79], v[78:79], v[126:127]
    v_pk_add_f32 v[76:77], v[76:77], v[12:13]
    v_pk_add_f32 v[78:79], v[78:79], v[12:13]
    v_pk_mul_f32 v[76:77], v[76:77], v[44:45]
    v_pk_mul_f32 v[78:79], v[78:79], v[46:47]
    v_cvt_pk_bf16_f32 v76, v76, v77
    v_cvt_pk_bf16_f32 v77, v78, v79
    buffer_store_dwordx2 v[76:77], v18, s[52:55], 0 offen offset:1536
    s_waitcnt lgkmcnt(4)
    v_pk_add_f32 v[80:81], v[80:81], v[104:105]
    v_pk_add_f32 v[128:129], v[128:129], v[152:153]
    v_pk_add_f32 v[82:83], v[82:83], v[106:107]
    v_pk_add_f32 v[130:131], v[130:131], v[154:155]
    v_pk_add_f32 v[80:81], v[80:81], v[128:129]
    v_pk_add_f32 v[82:83], v[82:83], v[130:131]
    v_pk_add_f32 v[80:81], v[80:81], v[12:13]
    v_pk_add_f32 v[82:83], v[82:83], v[12:13]
    v_pk_mul_f32 v[80:81], v[80:81], v[48:49]
    v_pk_mul_f32 v[82:83], v[82:83], v[50:51]
    v_cvt_pk_bf16_f32 v80, v80, v81
    v_cvt_pk_bf16_f32 v81, v82, v83
    buffer_store_dwordx2 v[80:81], v18, s[52:55], 0 offen offset:2048
    s_waitcnt lgkmcnt(0)
    v_pk_add_f32 v[84:85], v[84:85], v[108:109]
    v_pk_add_f32 v[132:133], v[132:133], v[156:157]
    v_pk_add_f32 v[86:87], v[86:87], v[110:111]
    v_pk_add_f32 v[134:135], v[134:135], v[158:159]
    v_pk_add_f32 v[84:85], v[84:85], v[132:133]
    v_pk_add_f32 v[86:87], v[86:87], v[134:135]
    v_pk_add_f32 v[84:85], v[84:85], v[12:13]
    v_pk_add_f32 v[86:87], v[86:87], v[12:13]
    v_pk_mul_f32 v[84:85], v[84:85], v[52:53]
    v_pk_mul_f32 v[86:87], v[86:87], v[54:55]
    v_cvt_pk_bf16_f32 v84, v84, v85
    v_cvt_pk_bf16_f32 v85, v86, v87
    buffer_store_dwordx2 v[84:85], v18, s[52:55], 0 offen offset:2560
k3_kernel_fin:
k3_kernel_end:
    s_endpgm
.globl k4_kernel
.p2align 8
.type k4_kernel,@function
k4_kernel:
    s_cmp_ge_u32 s2, 256
    s_cbranch_scc1 k4_kernel_end
    s_load_dwordx16 s[16:31], s[0:1], 0
    s_load_dwordx8 s[32:39], s[0:1], 64
    v_and_b32 v1, 63, v0
    v_lshrrev_b32 v2, 6, v0
    v_and_b32 v3, 15, v0
    v_readfirstlane_b32 s3, v2
    v_lshrrev_b32 v4, 4, v1
    s_and_b32 s4, s2, 7
    s_lshl_b32 s4, s4, 1
    s_bfe_u32 s5, s2, 0x10003
    s_add_u32 s4, s4, s5
    s_lshr_b32 s5, s2, 4
    s_lshl_b32 s6, s4, 7
    s_lshl_b32 s7, s3, 5
    s_add_u32 s6, s6, s7
    s_waitcnt lgkmcnt(0)
    s_add_u32 s40, s38, 12582912
    s_addc_u32 s41, s39, 0
    s_mov_b32 s42, 2883584
    s_mov_b32 s43, 0x20000
    s_add_u32 s44, s38, 20971520
    s_addc_u32 s45, s39, 0
    s_mov_b32 s46, 720896
    s_mov_b32 s47, 0x20000
    s_add_u32 s48, s38, 4194304
    s_addc_u32 s49, s39, 0
    s_mov_b32 s50, 2097152
    s_mov_b32 s51, 0x20000
    s_mov_b32 s52, s34
    s_mov_b32 s53, s35
    s_mov_b32 s54, 2097152
    s_mov_b32 s55, 0x20000
    s_lshl_b32 s64, s5, 6
    s_lshl_b32 s9, s3, 10
    s_mul_i32 s10, s5, 45056
    s_add_u32 s10, s10, s9
    v_lshlrev_b32 v12, 4, v1
    s_lshr_b32 s7, s6, 4
    s_mul_i32 s7, s7, 22528
    v_lshlrev_b32 v10, 4, v1
    v_add_u32 v10, s7, v10
    s_add_u32 m0, s9, 0
    s_add_u32 s8, s10, 0
    buffer_load_dwordx4 v12, s[44:47], s8 offen lds
    s_add_u32 m0, s9, 4096
    s_add_u32 s8, s10, 4096
    buffer_load_dwordx4 v12, s[44:47], s8 offen lds
    s_add_u32 m0, s9, 8192
    s_add_u32 s8, s10, 8192
    buffer_load_dwordx4 v12, s[44:47], s8 offen lds
    s_add_u32 m0, s9, 12288
    s_add_u32 s8, s10, 12288
    buffer_load_dwordx4 v12, s[44:47], s8 offen lds
    s_add_u32 m0, s9, 16384
    s_add_u32 s8, s10, 16384
    buffer_load_dwordx4 v12, s[44:47], s8 offen lds
    s_add_u32 m0, s9, 20480
    s_add_u32 s8, s10, 20480
    buffer_load_dwordx4 v12, s[44:47], s8 offen lds
    s_add_u32 m0, s9, 24576
    s_add_u32 s8, s10, 24576
    buffer_load_dwordx4 v12, s[44:47], s8 offen lds
    s_add_u32 m0, s9, 28672
    s_add_u32 s8, s10, 28672
    buffer_load_dwordx4 v12, s[44:47], s8 offen lds
    s_add_u32 m0, s9, 32768
    s_add_u32 s8, s10, 32768
    buffer_load_dwordx4 v12, s[44:47], s8 offen lds
    s_add_u32 m0, s9, 36864
    s_add_u32 s8, s10, 36864
    buffer_load_dwordx4 v12, s[44:47], s8 offen lds
    s_add_u32 m0, s9, 40960
    s_add_u32 s8, s10, 40960
    buffer_load_dwordx4 v12, s[44:47], s8 offen lds
    s_mov_b32 s76, 0
    buffer_load_dwordx4 v[80:83], v10, s[40:43], s76 offen offset:0
    s_mov_b32 s77, 22528
    buffer_load_dwordx4 v[84:87], v10, s[40:43], s77 offen offset:0
    buffer_load_dwordx4 v[88:91], v10, s[40:43], s76 offen offset:1024
    buffer_load_dwordx4 v[92:95], v10, s[40:43], s77 offen offset:1024
    buffer_load_dwordx4 v[96:99], v10, s[40:43], s76 offen offset:2048
    buffer_load_dwordx4 v[100:103], v10, s[40:43], s77 offen offset:2048
    buffer_load_dwordx4 v[104:107], v10, s[40:43], s76 offen offset:3072
    buffer_load_dwordx4 v[108:111], v10, s[40:43], s77 offen offset:3072
    s_mov_b32 s76, 4096
    buffer_load_dwordx4 v[112:115], v10, s[40:43], s76 offen offset:0
    s_mov_b32 s77, 26624
    buffer_load_dwordx4 v[116:119], v10, s[40:43], s77 offen offset:0
    buffer_load_dwordx4 v[120:123], v10, s[40:43], s76 offen offset:1024
    buffer_load_dwordx4 v[124:127], v10, s[40:43], s77 offen offset:1024
    v_add_u32 v14, s6, v3
    s_movk_i32 s7, 1024
    v_mul_lo_u32 v14, v14, s7
    v_lshl_add_u32 v14, v4, 3, v14
    v_add_u32 v14, s64, v14
    v_add_u32 v15, 16384, v14
    s_lshl_b32 s66, s5, 10
    s_lshr_b32 s7, s6, 4
    s_mul_i32 s7, s7, 16384
    s_add_u32 s7, s7, s66
    v_lshrrev_b32 v18, 1, v4
    v_lshlrev_b32 v18, 8, v18
    v_lshl_add_u32 v18, v3, 4, v18
    v_and_b32 v19, 1, v4
    v_lshl_add_u32 v18, v19, 3, v18
    v_add_u32 v18, s7, v18
    v_add_u32 v19, 16384, v18
    v_bfe_u32 v6, v1, 2, 2
    v_lshl_add_u32 v6, v4, 3, v6
    v_lshlrev_b32 v6, 6, v6
    v_and_b32 v7, 3, v1
    v_lshl_add_u32 v6, v7, 3, v6
    v_and_b32 v7, 1, v4
    v_lshl_add_u32 v16, v7, 5, v6
    v_xor_b32 v17, 32, v16
    v_cmp_gt_u32 vcc, 2, v4
    s_waitcnt vmcnt(12)
    s_barrier
    ds_read_b64_tr_b16 v[48:49], v16 offset:0
    ds_read_b64_tr_b16 v[50:51], v16 offset:256
    ds_read_b64_tr_b16 v[52:53], v17 offset:0
    ds_read_b64_tr_b16 v[54:55], v17 offset:256
    s_waitcnt vmcnt(10)
    s_waitcnt lgkmcnt(0)
    ds_read_b64_tr_b16 v[56:57], v16 offset:2048
    ds_read_b64_tr_b16 v[58:59], v16 offset:2304
    v_mfma_f32_16x16x32_bf16 v[32:35], v[48:51], v[80:83], 0
    ds_read_b64_tr_b16 v[60:61], v17 offset:2048
    v_mfma_f32_16x16x32_bf16 v[36:39], v[48:51], v[84:87], 0
    ds_read_b64_tr_b16 v[62:63], v17 offset:2304
    v_mfma_f32_16x16x32_bf16 v[40:43], v[52:55], v[80:83], 0
    buffer_load_dwordx4 v[128:131], v10, s[40:43], s76 offen offset:2048
    v_mfma_f32_16x16x32_bf16 v[44:47], v[52:55], v[84:87], 0
    buffer_load_dwordx4 v[132:135], v10, s[40:43], s77 offen offset:2048
    s_waitcnt vmcnt(10)
    s_waitcnt lgkmcnt(0)
    ds_read_b64_tr_b16 v[48:49], v16 offset:4096
    ds_read_b64_tr_b16 v[50:51], v16 offset:4352
    v_mfma_f32_16x16x32_bf16 v[32:35], v[56:59], v[88:91], v[32:35]
    ds_read_b64_tr_b16 v[52:53], v17 offset:4096
    v_mfma_f32_16x16x32_bf16 v[36:39], v[56:59], v[92:95], v[36:39]
    ds_read_b64_tr_b16 v[54:55], v17 offset:4352
    v_mfma_f32_16x16x32_bf16 v[40:43], v[60:63], v[88:91], v[40:43]
    buffer_load_dwordx4 v[136:139], v10, s[40:43], s76 offen offset:3072
    v_mfma_f32_16x16x32_bf16 v[44:47], v[60:63], v[92:95], v[44:47]
    buffer_load_dwordx4 v[140:143], v10, s[40:43], s77 offen offset:3072
    s_waitcnt vmcnt(10)
    s_waitcnt lgkmcnt(0)
    ds_read_b64_tr_b16 v[56:57], v16 offset:6144
    ds_read_b64_tr_b16 v[58:59], v16 offset:6400
    v_mfma_f32_16x16x32_bf16 v[32:35], v[48:51], v[96:99], v[32:35]
    ds_read_b64_tr_b16 v[60:61], v17 offset:6144
    v_mfma_f32_16x16x32_bf16 v[36:39], v[48:51], v[100:103], v[36:39]
    ds_read_b64_tr_b16 v[62:63], v17 offset:6400
    s_mov_b32 s76, 8192
    v_mfma_f32_16x16x32_bf16 v[40:43], v[52:55], v[96:99], v[40:43]
    buffer_load_dwordx4 v[144:147], v10, s[40:43], s76 offen offset:0
    v_mfma_f32_16x16x32_bf16 v[44:47], v[52:55], v[100:103], v[44:47]
    s_mov_b32 s77, 30720
    buffer_load_dwordx4 v[148:151], v10, s[40:43], s77 offen offset:0
    s_waitcnt vmcnt(10)
    s_waitcnt lgkmcnt(0)
    ds_read_b64_tr_b16 v[48:49], v16 offset:8192
    ds_read_b64_tr_b16 v[50:51], v16 offset:8448
    v_mfma_f32_16x16x32_bf16 v[32:35], v[56:59], v[104:107], v[32:35]
    ds_read_b64_tr_b16 v[52:53], v17 offset:8192
    v_mfma_f32_16x16x32_bf16 v[36:39], v[56:59], v[108:111], v[36:39]
    ds_read_b64_tr_b16 v[54:55], v17 offset:8448
    v_mfma_f32_16x16x32_bf16 v[40:43], v[60:63], v[104:107], v[40:43]
    buffer_load_dwordx4 v[152:155], v10, s[40:43], s76 offen offset:1024
    v_mfma_f32_16x16x32_bf16 v[44:47], v[60:63], v[108:111], v[44:47]
    buffer_load_dwordx4 v[156:159], v10, s[40:43], s77 offen offset:1024
    s_waitcnt vmcnt(10)
    s_waitcnt lgkmcnt(0)
    ds_read_b64_tr_b16 v[56:57], v16 offset:10240
    ds_read_b64_tr_b16 v[58:59], v16 offset:10496
    v_mfma_f32_16x16x32_bf16 v[32:35], v[48:51], v[112:115], v[32:35]
    ds_read_b64_tr_b16 v[60:61], v17 offset:10240
    v_mfma_f32_16x16x32_bf16 v[36:39], v[48:51], v[116:119], v[36:39]
    ds_read_b64_tr_b16 v[62:63], v17 offset:10496
    v_mfma_f32_16x16x32_bf16 v[40:43], v[52:55], v[112:115], v[40:43]
    buffer_load_dwordx4 v[160:163], v10, s[40:43], s76 offen offset:2048
    v_mfma_f32_16x16x32_bf16 v[44:47], v[52:55], v[116:119], v[44:47]
    buffer_load_dwordx4 v[164:167], v10, s[40:43], s77 offen offset:2048
    s_waitcnt vmcnt(10)
    s_waitcnt lgkmcnt(0)
    ds_read_b64_tr_b16 v[48:49], v16 offset:12288
    ds_read_b64_tr_b16 v[50:51], v16 offset:12544
    v_mfma_f32_16x16x32_bf16 v[32:35], v[56:59], v[120:123], v[32:35]
    ds_read_b64_tr_b16 v[52:53], v17 offset:12288
    v_mfma_f32_16x16x32_bf16 v[36:39], v[56:59], v[124:127], v[36:39]
    ds_read_b64_tr_b16 v[54:55], v17 offset:12544
    v_mfma_f32_16x16x32_bf16 v[40:43], v[60:63], v[120:123], v[40:43]
    buffer_load_dwordx4 v[168:171], v10, s[40:43], s76 offen offset:3072
    v_mfma_f32_16x16x32_bf16 v[44:47], v[60:63], v[124:127], v[44:47]
    buffer_load_dwordx4 v[172:175], v10, s[40:43], s77 offen offset:3072
    s_waitcnt vmcnt(10)
    s_waitcnt lgkmcnt(0)
    ds_read_b64_tr_b16 v[56:57], v16 offset:14336
    ds_read_b64_tr_b16 v[58:59], v16 offset:14592
    v_mfma_f32_16x16x32_bf16 v[32:35], v[48:51], v[128:131], v[32:35]
    ds_read_b64_tr_b16 v[60:61], v17 offset:14336
    v_mfma_f32_16x16x32_bf16 v[36:39], v[48:51], v[132:135], v[36:39]
    ds_read_b64_tr_b16 v[62:63], v17 offset:14592
    s_mov_b32 s76, 12288
    v_mfma_f32_16x16x32_bf16 v[40:43], v[52:55], v[128:131], v[40:43]
    buffer_load_dwordx4 v[176:179], v10, s[40:43], s76 offen offset:0
    v_mfma_f32_16x16x32_bf16 v[44:47], v[52:55], v[132:135], v[44:47]
    s_mov_b32 s77, 34816
    buffer_load_dwordx4 v[180:183], v10, s[40:43], s77 offen offset:0
    s_waitcnt vmcnt(10)
    s_waitcnt lgkmcnt(0)
    ds_read_b64_tr_b16 v[48:49], v16 offset:16384
    ds_read_b64_tr_b16 v[50:51], v16 offset:16640
    v_mfma_f32_16x16x32_bf16 v[32:35], v[56:59], v[136:139], v[32:35]
    ds_read_b64_tr_b16 v[52:53], v17 offset:16384
    v_mfma_f32_16x16x32_bf16 v[36:39], v[56:59], v[140:143], v[36:39]
    ds_read_b64_tr_b16 v[54:55], v17 offset:16640
    v_mfma_f32_16x16x32_bf16 v[40:43], v[60:63], v[136:139], v[40:43]
    buffer_load_dwordx4 v[184:187], v10, s[40:43], s76 offen offset:1024
    v_mfma_f32_16x16x32_bf16 v[44:47], v[60:63], v[140:143], v[44:47]
    buffer_load_dwordx4 v[188:191], v10, s[40:43], s77 offen offset:1024
    s_waitcnt vmcnt(10)
    s_waitcnt lgkmcnt(0)
    ds_read_b64_tr_b16 v[56:57], v16 offset:18432
    ds_read_b64_tr_b16 v[58:59], v16 offset:18688
    v_mfma_f32_16x16x32_bf16 v[32:35], v[48:51], v[144:147], v[32:35]
    ds_read_b64_tr_b16 v[60:61], v17 offset:18432
    v_mfma_f32_16x16x32_bf16 v[36:39], v[48:51], v[148:151], v[36:39]
    ds_read_b64_tr_b16 v[62:63], v17 offset:18688
    v_mfma_f32_16x16x32_bf16 v[40:43], v[52:55], v[144:147], v[40:43]
    buffer_load_dwordx4 v[192:195], v10, s[40:43], s76 offen offset:2048
    v_mfma_f32_16x16x32_bf16 v[44:47], v[52:55], v[148:151], v[44:47]
    buffer_load_dwordx4 v[196:199], v10, s[40:43], s77 offen offset:2048
    s_waitcnt vmcnt(10)
    s_waitcnt lgkmcnt(0)
    ds_read_b64_tr_b16 v[48:49], v16 offset:20480
    ds_read_b64_tr_b16 v[50:51], v16 offset:20736
    v_mfma_f32_16x16x32_bf16 v[32:35], v[56:59], v[152:155], v[32:35]
    ds_read_b64_tr_b16 v[52:53], v17 offset:20480
    v_mfma_f32_16x16x32_bf16 v[36:39], v[56:59], v[156:159], v[36:39]
    ds_read_b64_tr_b16 v[54:55], v17 offset:20736
    v_mfma_f32_16x16x32_bf16 v[40:43], v[60:63], v[152:155], v[40:43]
    buffer_load_dwordx4 v[200:203], v10, s[40:43], s76 offen offset:3072
    v_mfma_f32_16x16x32_bf16 v[44:47], v[60:63], v[156:159], v[44:47]
    buffer_load_dwordx4 v[204:207], v10, s[40:43], s77 offen offset:3072
    s_waitcnt vmcnt(10)
    s_waitcnt lgkmcnt(0)
    ds_read_b64_tr_b16 v[56:57], v16 offset:22528
    ds_read_b64_tr_b16 v[58:59], v16 offset:22784
    v_mfma_f32_16x16x32_bf16 v[32:35], v[48:51], v[160:163], v[32:35]
    ds_read_b64_tr_b16 v[60:61], v17 offset:22528
    v_mfma_f32_16x16x32_bf16 v[36:39], v[48:51], v[164:167], v[36:39]
    ds_read_b64_tr_b16 v[62:63], v17 offset:22784
    s_mov_b32 s76, 16384
    v_mfma_f32_16x16x32_bf16 v[40:43], v[52:55], v[160:163], v[40:43]
    buffer_load_dwordx4 v[208:211], v10, s[40:43], s76 offen offset:0
    v_mfma_f32_16x16x32_bf16 v[44:47], v[52:55], v[164:167], v[44:47]
    s_mov_b32 s77, 38912
    buffer_load_dwordx4 v[212:215], v10, s[40:43], s77 offen offset:0
    s_waitcnt vmcnt(10)
    s_waitcnt lgkmcnt(0)
    ds_read_b64_tr_b16 v[48:49], v16 offset:24576
    ds_read_b64_tr_b16 v[50:51], v16 offset:24832
    v_mfma_f32_16x16x32_bf16 v[32:35], v[56:59], v[168:171], v[32:35]
    ds_read_b64_tr_b16 v[52:53], v17 offset:24576
    v_mfma_f32_16x16x32_bf16 v[36:39], v[56:59], v[172:175], v[36:39]
    ds_read_b64_tr_b16 v[54:55], v17 offset:24832
    v_mfma_f32_16x16x32_bf16 v[40:43], v[60:63], v[168:171], v[40:43]
    buffer_load_dwordx4 v[216:219], v10, s[40:43], s76 offen offset:1024
    v_mfma_f32_16x16x32_bf16 v[44:47], v[60:63], v[172:175], v[44:47]
    buffer_load_dwordx4 v[220:223], v10, s[40:43], s77 offen offset:1024
    s_waitcnt vmcnt(10)
    s_waitcnt lgkmcnt(0)
    ds_read_b64_tr_b16 v[56:57], v16 offset:26624
    ds_read_b64_tr_b16 v[58:59], v16 offset:26880
    v_mfma_f32_16x16x32_bf16 v[32:35], v[48:51], v[176:179], v[32:35]
    ds_read_b64_tr_b16 v[60:61], v17 offset:26624
    v_mfma_f32_16x16x32_bf16 v[36:39], v[48:51], v[180:183], v[36:39]
    ds_read_b64_tr_b16 v[62:63], v17 offset:26880
    v_mfma_f32_16x16x32_bf16 v[40:43], v[52:55], v[176:179], v[40:43]
    buffer_load_dwordx4 v[224:227], v10, s[40:43], s76 offen offset:2048
    v_mfma_f32_16x16x32_bf16 v[44:47], v[52:55], v[180:183], v[44:47]
    buffer_load_dwordx4 v[228:231], v10, s[40:43], s77 offen offset:2048
    s_waitcnt vmcnt(10)
    s_waitcnt lgkmcnt(0)
    ds_read_b64_tr_b16 v[48:49], v16 offset:28672
    ds_read_b64_tr_b16 v[50:51], v16 offset:28928
    v_mfma_f32_16x16x32_bf16 v[32:35], v[56:59], v[184:187], v[32:35]
    ds_read_b64_tr_b16 v[52:53], v17 offset:28672
    v_mfma_f32_16x16x32_bf16 v[36:39], v[56:59], v[188:191], v[36:39]
    ds_read_b64_tr_b16 v[54:55], v17 offset:28928
    v_mfma_f32_16x16x32_bf16 v[40:43], v[60:63], v[184:187], v[40:43]
    buffer_load_dwordx4 v[232:235], v10, s[40:43], s76 offen offset:3072
    v_mfma_f32_16x16x32_bf16 v[44:47], v[60:63], v[188:191], v[44:47]
    buffer_load_dwordx4 v[236:239], v10, s[40:43], s77 offen offset:3072
    s_waitcnt vmcnt(10)
    s_waitcnt lgkmcnt(0)
    ds_read_b64_tr_b16 v[56:57], v16 offset:30720
    ds_read_b64_tr_b16 v[58:59], v16 offset:30976
    v_mfma_f32_16x16x32_bf16 v[32:35], v[48:51], v[192:195], v[32:35]
    ds_read_b64_tr_b16 v[60:61], v17 offset:30720
    v_mfma_f32_16x16x32_bf16 v[36:39], v[48:51], v[196:199], v[36:39]
    ds_read_b64_tr_b16 v[62:63], v17 offset:30976
    s_mov_b32 s76, 20480
    v_mfma_f32_16x16x32_bf16 v[40:43], v[52:55], v[192:195], v[40:43]
    buffer_load_dwordx4 v[240:243], v10, s[40:43], s76 offen offset:0
    v_mfma_f32_16x16x32_bf16 v[44:47], v[52:55], v[196:199], v[44:47]
    s_mov_b32 s77, 43008
    buffer_load_dwordx4 v[244:247], v10, s[40:43], s77 offen offset:0
    s_waitcnt vmcnt(10)
    s_waitcnt lgkmcnt(0)
    ds_read_b64_tr_b16 v[48:49], v16 offset:32768
    ds_read_b64_tr_b16 v[50:51], v16 offset:33024
    v_mfma_f32_16x16x32_bf16 v[32:35], v[56:59], v[200:203], v[32:35]
    ds_read_b64_tr_b16 v[52:53], v17 offset:32768
    v_mfma_f32_16x16x32_bf16 v[36:39], v[56:59], v[204:207], v[36:39]
    ds_read_b64_tr_b16 v[54:55], v17 offset:33024
    v_mfma_f32_16x16x32_bf16 v[40:43], v[60:63], v[200:203], v[40:43]
    buffer_load_dwordx4 v[248:251], v10, s[40:43], s76 offen offset:1024
    v_mfma_f32_16x16x32_bf16 v[44:47], v[60:63], v[204:207], v[44:47]
    buffer_load_dwordx4 v[252:255], v10, s[40:43], s77 offen offset:1024
    s_waitcnt vmcnt(10)
    s_waitcnt lgkmcnt(0)
    ds_read_b64_tr_b16 v[56:57], v16 offset:34816
    ds_read_b64_tr_b16 v[58:59], v16 offset:35072
    v_mfma_f32_16x16x32_bf16 v[32:35], v[48:51], v[208:211], v[32:35]
    ds_read_b64_tr_b16 v[60:61], v17 offset:34816
    v_mfma_f32_16x16x32_bf16 v[36:39], v[48:51], v[212:215], v[36:39]
    ds_read_b64_tr_b16 v[62:63], v17 offset:35072
    buffer_load_dwordx2 v[20:21], v18, s[48:51], 0 offen offset:0
    v_mfma_f32_16x16x32_bf16 v[40:43], v[52:55], v[208:211], v[40:43]
    buffer_load_dwordx2 v[22:23], v19, s[48:51], 0 offen offset:0
    v_mfma_f32_16x16x32_bf16 v[44:47], v[52:55], v[212:215], v[44:47]
    buffer_load_dwordx2 v[24:25], v18, s[48:51], 0 offen offset:512
    buffer_load_dwordx2 v[26:27], v19, s[48:51], 0 offen offset:512
    s_waitcnt vmcnt(12)
    s_waitcnt lgkmcnt(0)
    ds_read_b64_tr_b16 v[48:49], v16 offset:36864
    ds_read_b64_tr_b16 v[50:51], v16 offset:37120
    v_mfma_f32_16x16x32_bf16 v[32:35], v[56:59], v[216:219], v[32:35]
    v_mfma_f32_16x16x32_bf16 v[36:39], v[56:59], v[220:223], v[36:39]
    ds_read_b64_tr_b16 v[52:53], v17 offset:36864
    v_mfma_f32_16x16x32_bf16 v[40:43], v[60:63], v[216:219], v[40:43]
    v_mfma_f32_16x16x32_bf16 v[44:47], v[60:63], v[220:223], v[44:47]
    ds_read_b64_tr_b16 v[54:55], v17 offset:37120
    s_waitcnt vmcnt(10)
    s_waitcnt lgkmcnt(0)
    ds_read_b64_tr_b16 v[56:57], v16 offset:38912
    ds_read_b64_tr_b16 v[58:59], v16 offset:39168
    v_mfma_f32_16x16x32_bf16 v[32:35], v[48:51], v[224:227], v[32:35]
    v_mfma_f32_16x16x32_bf16 v[36:39], v[48:51], v[228:231], v[36:39]
    ds_read_b64_tr_b16 v[60:61], v17 offset:38912
    v_mfma_f32_16x16x32_bf16 v[40:43], v[52:55], v[224:227], v[40:43]
    v_mfma_f32_16x16x32_bf16 v[44:47], v[52:55], v[228:231], v[44:47]
    ds_read_b64_tr_b16 v[62:63], v17 offset:39168
    s_waitcnt vmcnt(8)
    s_waitcnt lgkmcnt(0)
    ds_read_b64_tr_b16 v[48:49], v16 offset:40960
    ds_read_b64_tr_b16 v[50:51], v16 offset:41216
    v_mfma_f32_16x16x32_bf16 v[32:35], v[56:59], v[232:235], v[32:35]
    v_mfma_f32_16x16x32_bf16 v[36:39], v[56:59], v[236:239], v[36:39]
    ds_read_b64_tr_b16 v[52:53], v17 offset:40960
    v_mfma_f32_16x16x32_bf16 v[40:43], v[60:63], v[232:235], v[40:43]
    v_mfma_f32_16x16x32_bf16 v[44:47], v[60:63], v[236:239], v[44:47]
    ds_read_b64_tr_b16 v[54:55], v17 offset:41216
    s_waitcnt vmcnt(6)
    s_waitcnt lgkmcnt(0)
    ds_read_b64_tr_b16 v[56:57], v16 offset:43008
    ds_read_b64_tr_b16 v[58:59], v16 offset:43264
    v_mfma_f32_16x16x32_bf16 v[32:35], v[48:51], v[240:243], v[32:35]
    v_mfma_f32_16x16x32_bf16 v[36:39], v[48:51], v[244:247], v[36:39]
    ds_read_b64_tr_b16 v[60:61], v17 offset:43008
    v_mfma_f32_16x16x32_bf16 v[40:43], v[52:55], v[240:243], v[40:43]
    v_mfma_f32_16x16x32_bf16 v[44:47], v[52:55], v[244:247], v[44:47]
    ds_read_b64_tr_b16 v[62:63], v17 offset:43264
    s_waitcnt vmcnt(4)
    s_waitcnt lgkmcnt(0)
    v_cndmask_b32 v248, 0, v248, vcc
    v_cndmask_b32 v249, 0, v249, vcc
    v_cndmask_b32 v250, 0, v250, vcc
    v_cndmask_b32 v251, 0, v251, vcc
    v_cndmask_b32 v252, 0, v252, vcc
    v_cndmask_b32 v253, 0, v253, vcc
    v_cndmask_b32 v254, 0, v254, vcc
    v_cndmask_b32 v255, 0, v255, vcc
    s_nop 1
    v_mfma_f32_16x16x32_bf16 v[32:35], v[56:59], v[248:251], v[32:35]
    v_mfma_f32_16x16x32_bf16 v[36:39], v[56:59], v[252:255], v[36:39]
    v_mfma_f32_16x16x32_bf16 v[40:43], v[60:63], v[248:251], v[40:43]
    v_mfma_f32_16x16x32_bf16 v[44:47], v[60:63], v[252:255], v[44:47]
    s_waitcnt vmcnt(0)
    s_nop 7
    v_lshlrev_b32 v64, 16, v20
    v_lshlrev_b32 v68, 16, v22
    v_lshlrev_b32 v72, 16, v24
    v_lshlrev_b32 v76, 16, v26
    v_and_b32 v65, 0xffff0000, v20
    v_and_b32 v69, 0xffff0000, v22
    v_and_b32 v73, 0xffff0000, v24
    v_and_b32 v77, 0xffff0000, v26
    v_lshlrev_b32 v66, 16, v21
    v_lshlrev_b32 v70, 16, v23
    v_lshlrev_b32 v74, 16, v25
    v_lshlrev_b32 v78, 16, v27
    v_and_b32 v67, 0xffff0000, v21
    v_and_b32 v71, 0xffff0000, v23
    v_and_b32 v75, 0xffff0000, v25
    v_and_b32 v79, 0xffff0000, v27
    v_add_f32 v32, v32, v64
    v_add_f32 v36, v36, v68
    v_add_f32 v40, v40, v72
    v_add_f32 v44, v44, v76
    v_add_f32 v33, v33, v65
    v_add_f32 v37, v37, v69
    v_add_f32 v41, v41, v73
    v_add_f32 v45, v45, v77
    v_add_f32 v34, v34, v66
    v_add_f32 v38, v38, v70
    v_add_f32 v42, v42, v74
    v_add_f32 v46, v46, v78
    v_add_f32 v35, v35, v67
    v_add_f32 v39, v39, v71
    v_add_f32 v43, v43, v75
    v_add_f32 v47, v47, v79
    v_cvt_pk_bf16_f32 v32, v32, v33
    v_cvt_pk_bf16_f32 v36, v36, v37
    v_cvt_pk_bf16_f32 v40, v40, v41
    v_cvt_pk_bf16_f32 v44, v44, v45
    v_cvt_pk_bf16_f32 v33, v34, v35
    v_cvt_pk_bf16_f32 v37, v38, v39
    v_cvt_pk_bf16_f32 v41, v42, v43
    v_cvt_pk_bf16_f32 v45, v46, v47
    buffer_store_dwordx2 v[32:33], v14, s[52:55], 0 offen offset:0
    buffer_store_dwordx2 v[36:37], v15, s[52:55], 0 offen offset:0
    buffer_store_dwordx2 v[40:41], v14, s[52:55], 0 offen offset:32
    buffer_store_dwordx2 v[44:45], v15, s[52:55], 0 offen offset:32
k4_kernel_fin:
k4_kernel_end:
    s_endpgm
.section .rodata,"a"
.p2align 6
.amdhsa_kernel k1_kernel
  .amdhsa_next_free_vgpr 256
  .amdhsa_next_free_sgpr 102
  .amdhsa_accum_offset 256
  .amdhsa_group_segment_fixed_size 0
  .amdhsa_kernarg_size 96
  .amdhsa_user_sgpr_count 2
  .amdhsa_user_sgpr_kernarg_segment_ptr 1
  .amdhsa_system_sgpr_workgroup_id_x 1
.end_amdhsa_kernel
.p2align 6
.amdhsa_kernel k2a_kernel
  .amdhsa_next_free_vgpr 208
  .amdhsa_next_free_sgpr 102
  .amdhsa_accum_offset 208
  .amdhsa_group_segment_fixed_size 0
  .amdhsa_kernarg_size 96
  .amdhsa_user_sgpr_count 2
  .amdhsa_user_sgpr_kernarg_segment_ptr 1
  .amdhsa_system_sgpr_workgroup_id_x 1
.end_amdhsa_kernel
.p2align 6
.amdhsa_kernel k2b_kernel
  .amdhsa_next_free_vgpr 256
  .amdhsa_next_free_sgpr 102
  .amdhsa_accum_offset 256
  .amdhsa_group_segment_fixed_size 0
  .amdhsa_kernarg_size 96
  .amdhsa_user_sgpr_count 2
  .amdhsa_user_sgpr_kernarg_segment_ptr 1
  .amdhsa_system_sgpr_workgroup_id_x 1
.end_amdhsa_kernel
.p2align 6
.amdhsa_kernel k3_kernel
  .amdhsa_next_free_vgpr 400
  .amdhsa_next_free_sgpr 102
  .amdhsa_accum_offset 256
  .amdhsa_group_segment_fixed_size 0
  .amdhsa_kernarg_size 96
  .amdhsa_user_sgpr_count 2
  .amdhsa_user_sgpr_kernarg_segment_ptr 1
  .amdhsa_system_sgpr_workgroup_id_x 1
.end_amdhsa_kernel
.p2align 6
.amdhsa_kernel k4_kernel
  .amdhsa_next_free_vgpr 256
  .amdhsa_next_free_sgpr 102
  .amdhsa_accum_offset 256
  .amdhsa_group_segment_fixed_size 0
  .amdhsa_kernarg_size 96
  .amdhsa_user_sgpr_count 2
  .amdhsa_user_sgpr_kernarg_segment_ptr 1
  .amdhsa_system_sgpr_workgroup_id_x 1
.end_amdhsa_kernel
```
